```python
import torch

def _softmax(x, axis=-1):
    return torch.softmax(x, dim=axis)
def _gelu(x):
    return torch.nn.functional.gelu(x, approximate="tanh")
def _silu(x):
    return torch.nn.functional.silu(x)
def _sigmoid(x):
    return torch.sigmoid(x)
def _layernorm(x, axis=-1, eps=1e-5):
    m = x.mean(dim=axis, keepdim=True)
    v = x.var(dim=axis, keepdim=True, unbiased=False)
    return (x - m) / torch.sqrt(v + eps)
def _scatter_add(tgt, idx, src, axis=0):
    return tgt.clone().index_add_(axis, idx, src)
def _segment_sum(src, seg, n):
    out = torch.zeros((n,) + src.shape[1:], dtype=src.dtype)
    return out.index_add_(0, seg, src)
def _pad(x, pw):
    flat = tuple(v for pair in reversed(pw) for v in pair)
    return torch.nn.functional.pad(x, flat)

kernel_name = 'parallel_sum__sliding_block__dense_activation_relu__prompt'

def setup_inputs():

    _w = (lambda a: (lambda t: t.to(torch.bfloat16) if t.is_floating_point() else t)(torch.as_tensor(a)))
    def _A_setup():
        B, S, D = 1, 2048, 512
        return {
            "x": _w((lambda *s: torch.randn(*s, dtype=torch.bfloat16) * 0.05)(B, S, D)),
            "wqkv": _w((lambda *s: torch.randn(*s, dtype=torch.bfloat16) * 0.05)(D, 3 * D)),
            "wo": _w((lambda *s: torch.randn(*s, dtype=torch.bfloat16) * 0.05)(D, D)),
        }
    _A_in = _A_setup()

    def _B_setup():
        B, S, D, Dff = 1, 2048, 512, 1376
        return {
            "x": _w((lambda *s: torch.randn(*s, dtype=torch.bfloat16) * 0.05)(B, S, D)),
            "w1": _w((lambda *s: torch.randn(*s, dtype=torch.bfloat16) * 0.05)(D, Dff)),
            "w2": _w((lambda *s: torch.randn(*s, dtype=torch.bfloat16) * 0.05)(Dff, D)),
        }
    _B_in = _B_setup()

    return {
        "A_x": _A_in["x"],
        "A_wqkv": _A_in["wqkv"],
        "A_wo": _A_in["wo"],
        "B_x": _B_in["x"],
        "B_w1": _B_in["w1"],
        "B_w2": _B_in["w2"],
    }

def reference(A_x, A_wqkv, A_wo, B_x, B_w1, B_w2):
    def _A_ref(x, wqkv, wo):
        B, S, D = x.shape
        H = 32; Dh = D // H; W = 256
        qkv = (lambda x, *d: x.permute(*d))((x @ wqkv).reshape(B, S, 3, H, Dh), 2, 0, 3, 1, 4)
        q, k, v = qkv[0], qkv[1], qkv[2]
        scores = torch.einsum("bhqd,bhkd->bhqk", q, k) * (Dh ** -0.5)
        idx = torch.arange(S)
        mask = (idx[:, None] - idx[None, :] >= 0) & (idx[:, None] - idx[None, :] < W)
        scores = torch.where(mask[None, None], scores, -1e9)
        p = _softmax(scores, axis=-1)
        o = torch.einsum("bhqk,bhkd->bhqd", p, v)
        return (lambda x, *d: x.permute(*d))(o, 0, 2, 1, 3).reshape(B, S, D) @ wo

    def _B_ref(x, w1, w2):
        h = torch.einsum("bsd,df->bsf", x, w1)
        zero = torch.zeros_like(h)
        h = torch.maximum(h, zero)
        return torch.einsum("bsf,fd->bsd", h, w2)

    x = A_x
    xn = _layernorm(x, axis=-1)
    return x + _A_ref(xn, A_wqkv, A_wo) + _B_ref(xn, B_w1, B_w2)
```

```asm
; @launch grid=(256,1,1) block=(512,1,1) lds=163840
.amdgcn_target "amdgcn-amd-amdhsa--gfx950"
.text
.globl parallel_sum__sliding_block__dense_activation_relu__prompt_kernel
.p2align 8
.type parallel_sum__sliding_block__dense_activation_relu__prompt_kernel,@function
parallel_sum__sliding_block__dense_activation_relu__prompt_kernel:
 s_cmp_ge_u32 s2, 256
 s_cbranch_scc1 L_END
 s_getpc_b64 s[4:5]
L_PCREF:
 s_load_dwordx2 s[40:41], s[0:1], 0
 s_load_dwordx2 s[44:45], s[0:1], 8
 s_load_dwordx2 s[48:49], s[0:1], 32
 s_load_dwordx2 s[64:65], s[0:1], 64
 v_lshrrev_b32 v1, 6, v0
 v_and_b32 v0, 63, v0
 v_readfirstlane_b32 s26, v1
 s_and_b32 s29, s2, 7
 s_lshr_b32 s30, s2, 3
 s_and_b32 s3, s29, 1
 s_lshl_b32 s3, s3, 3
 s_and_b32 s27, s30, 7
 s_or_b32 s27, s27, s3
 s_lshr_b32 s3, s29, 1
 s_lshl_b32 s3, s3, 2
 s_lshr_b32 s28, s30, 3
 s_or_b32 s28, s28, s3
 s_mov_b32 s42, 2097152
 s_mov_b32 s43, 0x20000
 s_mov_b32 s46, 1572864
 s_mov_b32 s47, 0x20000
 s_mov_b32 s50, 1409024
 s_mov_b32 s51, 0x20000
 s_mov_b32 s66, 16777216
 s_mov_b32 s67, 0x20000
 s_mul_i32 s33, s28, 3
 s_lshl_b32 s3, s28, 1
 s_add_u32 s3, s3, 11
 s_min_u32 s33, s33, s3
 s_cmp_lt_u32 s28, 11
 s_cselect_b32 s34, 3, 2
 s_cmp_lt_u32 s26, 4
 s_cbranch_scc1 L_GWAVE
 s_sub_u32 s38, s26, 4
 s_cmp_ge_u32 s38, 2
 s_cbranch_scc1 L_HPUB
 v_lshrrev_b32 v3, 3, v0
 v_lshlrev_b32 v3, 10, v3
 v_and_b32 v4, 7, v0
 v_lshrrev_b32 v5, 4, v0
 v_xor_b32 v4, v4, v5
 v_lshl_or_b32 v8, v4, 4, v3
 v_xor_b32 v9, 64, v8
 v_lshrrev_b32 v3, 2, v0
 v_and_b32 v4, 3, v0
 v_lshlrev_b32 v4, 4, v4
 v_mov_b32 v5, 3072
 v_mad_u32_u24 v10, v3, v5, v4
 v_mov_b32 v5, 2752
 v_mad_u32_u24 v11, v3, v5, v4
 s_lshl_b32 s70, s27, 17
 s_lshl_b32 s78, s38, 16
 s_add_u32 s70, s70, s78
 s_lshl_b32 s73, s38, 13
 s_lshl_b32 s74, s38, 11
 s_mul_i32 s77, s38, 98304
 s_lshl_b32 s78, s28, 6
 s_add_u32 s77, s77, s78
 s_add_u32 s75, s77, 1024
 s_add_u32 s76, s77, 2048
 s_mul_i32 s79, s38, 88064
 s_lshl_b32 s78, s33, 6
 s_add_u32 s79, s79, s78
 s_and_b32 s95, s28, 3
 s_lshl_b32 s95, s95, 1
 s_bfe_u32 s96, s28, 0x10002
 s_add_u32 s95, s95, s96
 s_add_u32 s95, s95, s27
 s_waitcnt lgkmcnt(0)
 s_setprio 2
 v_mov_b32 v3, 0
 buffer_load_dword v28, v3, s[64:67], 0 offen sc1
 s_add_u32 s96, s95, 0
 s_and_b32 s96, s96, 7
 s_lshl_b32 s97, s96, 7
 s_add_u32 s97, s97, s70
 s_add_u32 m0, s73, 0
 s_add_u32 s78, s97, 0
 buffer_load_dwordx4 v8, s[40:43], s78 offen lds
 s_add_u32 m0, s73, 1024
 s_add_u32 s78, s97, 8192
 buffer_load_dwordx4 v9, s[40:43], s78 offen lds
 s_add_u32 m0, s73, 2048
 s_add_u32 s78, s97, 16384
 buffer_load_dwordx4 v8, s[40:43], s78 offen lds
 s_add_u32 m0, s73, 3072
 s_add_u32 s78, s97, 24576
 buffer_load_dwordx4 v9, s[40:43], s78 offen lds
 s_add_u32 m0, s73, 4096
 s_add_u32 s78, s97, 32768
 buffer_load_dwordx4 v8, s[40:43], s78 offen lds
 s_add_u32 m0, s73, 5120
 s_add_u32 s78, s97, 40960
 buffer_load_dwordx4 v9, s[40:43], s78 offen lds
 s_add_u32 m0, s73, 6144
 s_add_u32 s78, s97, 49152
 buffer_load_dwordx4 v8, s[40:43], s78 offen lds
 s_add_u32 m0, s73, 7168
 s_add_u32 s78, s97, 57344
 buffer_load_dwordx4 v9, s[40:43], s78 offen lds
 s_mul_i32 s97, s96, 196608
 s_add_u32 s3, s75, s97
 s_add_u32 m0, s74, 16384
 s_add_u32 s78, s3, 0
 buffer_load_dwordx4 v10, s[44:47], s78 offen lds
 s_add_u32 m0, s74, 17408
 s_add_u32 s78, s3, 49152
 buffer_load_dwordx4 v10, s[44:47], s78 offen lds
 s_add_u32 s3, s76, s97
 s_add_u32 m0, s74, 20480
 s_add_u32 s78, s3, 0
 buffer_load_dwordx4 v10, s[44:47], s78 offen lds
 s_add_u32 m0, s74, 21504
 s_add_u32 s78, s3, 49152
 buffer_load_dwordx4 v10, s[44:47], s78 offen lds
 s_add_u32 s96, s95, 1
 s_and_b32 s96, s96, 7
 s_lshl_b32 s97, s96, 7
 s_add_u32 s97, s97, s70
 s_add_u32 m0, s73, 24576
 s_add_u32 s78, s97, 0
 buffer_load_dwordx4 v8, s[40:43], s78 offen lds
 s_add_u32 m0, s73, 25600
 s_add_u32 s78, s97, 8192
 buffer_load_dwordx4 v9, s[40:43], s78 offen lds
 s_add_u32 m0, s73, 26624
 s_add_u32 s78, s97, 16384
 buffer_load_dwordx4 v8, s[40:43], s78 offen lds
 s_add_u32 m0, s73, 27648
 s_add_u32 s78, s97, 24576
 buffer_load_dwordx4 v9, s[40:43], s78 offen lds
 s_add_u32 m0, s73, 28672
 s_add_u32 s78, s97, 32768
 buffer_load_dwordx4 v8, s[40:43], s78 offen lds
 s_add_u32 m0, s73, 29696
 s_add_u32 s78, s97, 40960
 buffer_load_dwordx4 v9, s[40:43], s78 offen lds
 s_add_u32 m0, s73, 30720
 s_add_u32 s78, s97, 49152
 buffer_load_dwordx4 v8, s[40:43], s78 offen lds
 s_add_u32 m0, s73, 31744
 s_add_u32 s78, s97, 57344
 buffer_load_dwordx4 v9, s[40:43], s78 offen lds
 s_mul_i32 s97, s96, 196608
 s_add_u32 s3, s75, s97
 s_add_u32 m0, s74, 40960
 s_add_u32 s78, s3, 0
 buffer_load_dwordx4 v10, s[44:47], s78 offen lds
 s_add_u32 m0, s74, 41984
 s_add_u32 s78, s3, 49152
 buffer_load_dwordx4 v10, s[44:47], s78 offen lds
 s_add_u32 s3, s76, s97
 s_add_u32 m0, s74, 45056
 s_add_u32 s78, s3, 0
 buffer_load_dwordx4 v10, s[44:47], s78 offen lds
 s_add_u32 m0, s74, 46080
 s_add_u32 s78, s3, 49152
 buffer_load_dwordx4 v10, s[44:47], s78 offen lds
 s_load_dwordx2 s[68:69], s[0:1], 56
 s_lshl_b32 s71, s38, 10
 s_lshl_b32 s72, s38, 12
 v_lshlrev_b32 v15, 7, v0
 v_lshlrev_b32 v7, 4, v0
 v_lshrrev_b32 v3, 5, v0
 v_lshlrev_b32 v3, 3, v3
 v_bfe_u32 v4, v0, 2, 2
 v_add_u32 v3, v3, v4
 v_lshlrev_b32 v3, 6, v3
 v_bfe_u32 v4, v0, 4, 1
 v_lshl_add_u32 v3, v4, 5, v3
 v_and_b32 v4, 3, v0
 v_lshl_add_u32 v3, v4, 3, v3
 s_add_u32 s81, s71, 16384
 v_add_u32 v12, s81, v3
 v_add_u32 v13, 73728, v12
 s_add_u32 s81, s71, 73728
 v_add_u32 v14, s81, v3
 v_and_b32 v3, 31, v0
 v_lshrrev_b32 v4, 5, v0
 v_lshlrev_b32 v4, 2, v4
 v_sub_u32 v3, v3, v4
 v_mov_b32 v5, 0xf149f2ca
 s_lshl_b32 s81, s27, 2
 s_add_u32 s81, s81, s38
 s_sub_i32 s84, 8, s81
 s_max_i32 s84, s84, 0
 v_subrev_u32 v6, 0, v3
 v_ashrrev_i32 v6, 31, v6
 v_and_b32 v128, v6, v5
 v_bfi_b32 v144, v6, 0, v5
 v_subrev_u32 v6, 1, v3
 v_ashrrev_i32 v6, 31, v6
 v_and_b32 v129, v6, v5
 v_bfi_b32 v145, v6, 0, v5
 v_subrev_u32 v6, 2, v3
 v_ashrrev_i32 v6, 31, v6
 v_and_b32 v130, v6, v5
 v_bfi_b32 v146, v6, 0, v5
 v_subrev_u32 v6, 3, v3
 v_ashrrev_i32 v6, 31, v6
 v_and_b32 v131, v6, v5
 v_bfi_b32 v147, v6, 0, v5
 v_subrev_u32 v6, 8, v3
 v_ashrrev_i32 v6, 31, v6
 v_and_b32 v132, v6, v5
 v_bfi_b32 v148, v6, 0, v5
 v_subrev_u32 v6, 9, v3
 v_ashrrev_i32 v6, 31, v6
 v_and_b32 v133, v6, v5
 v_bfi_b32 v149, v6, 0, v5
 v_subrev_u32 v6, 10, v3
 v_ashrrev_i32 v6, 31, v6
 v_and_b32 v134, v6, v5
 v_bfi_b32 v150, v6, 0, v5
 v_subrev_u32 v6, 11, v3
 v_ashrrev_i32 v6, 31, v6
 v_and_b32 v135, v6, v5
 v_bfi_b32 v151, v6, 0, v5
 v_subrev_u32 v6, 16, v3
 v_ashrrev_i32 v6, 31, v6
 v_and_b32 v136, v6, v5
 v_bfi_b32 v152, v6, 0, v5
 v_subrev_u32 v6, 17, v3
 v_ashrrev_i32 v6, 31, v6
 v_and_b32 v137, v6, v5
 v_bfi_b32 v153, v6, 0, v5
 v_subrev_u32 v6, 18, v3
 v_ashrrev_i32 v6, 31, v6
 v_and_b32 v138, v6, v5
 v_bfi_b32 v154, v6, 0, v5
 v_subrev_u32 v6, 19, v3
 v_ashrrev_i32 v6, 31, v6
 v_and_b32 v139, v6, v5
 v_bfi_b32 v155, v6, 0, v5
 v_subrev_u32 v6, 24, v3
 v_ashrrev_i32 v6, 31, v6
 v_and_b32 v140, v6, v5
 v_bfi_b32 v156, v6, 0, v5
 v_subrev_u32 v6, 25, v3
 v_ashrrev_i32 v6, 31, v6
 v_and_b32 v141, v6, v5
 v_bfi_b32 v157, v6, 0, v5
 v_subrev_u32 v6, 26, v3
 v_ashrrev_i32 v6, 31, v6
 v_and_b32 v142, v6, v5
 v_bfi_b32 v158, v6, 0, v5
 v_subrev_u32 v6, 27, v3
 v_ashrrev_i32 v6, 31, v6
 v_and_b32 v143, v6, v5
 v_bfi_b32 v159, v6, 0, v5
 s_cmp_eq_u32 s84, 0
 s_cbranch_scc1 BOK_1
 v_mov_b32 v144, v5
 v_mov_b32 v145, v5
 v_mov_b32 v146, v5
 v_mov_b32 v147, v5
 v_mov_b32 v148, v5
 v_mov_b32 v149, v5
 v_mov_b32 v150, v5
 v_mov_b32 v151, v5
 v_mov_b32 v152, v5
 v_mov_b32 v153, v5
 v_mov_b32 v154, v5
 v_mov_b32 v155, v5
 v_mov_b32 v156, v5
 v_mov_b32 v157, v5
 v_mov_b32 v158, v5
 v_mov_b32 v159, v5
BOK_1:
 v_and_b32 v3, 15, v0
 v_bfe_u32 v4, v0, 4, 1
 v_cmp_eq_u32 vcc, v3, v4
 v_mov_b32 v6, 0x3f803f80
 s_nop 0
 v_cndmask_b32 v60, 0, v6, vcc
 v_mov_b32 v61, v60
 v_mov_b32 v62, v60
 v_mov_b32 v63, v60
 v_and_b32 v2, 31, v0
 v_lshrrev_b32 v3, 3, v2
 v_lshlrev_b32 v3, 10, v3
 v_and_b32 v4, 7, v2
 v_lshl_add_u32 v3, v4, 7, v3
 v_bfe_u32 v4, v0, 1, 3
 v_lshrrev_b32 v6, 5, v0
 v_xor_b32 v4, v4, v6
 v_lshl_add_u32 v3, v4, 4, v3
 v_add_u32 v92, s72, v3
 v_xor_b32 v93, 32, v92
 v_xor_b32 v94, 64, v92
 v_xor_b32 v95, 96, v92
 v_lshlrev_b32 v3, 4, v0
 s_lshl_b32 s81, s38, 2
 s_add_u32 s81, s81, 160768
 v_add_u32 v18, s81, v3
 s_waitcnt lgkmcnt(0)
 s_add_u32 s96, s95, 2
 s_and_b32 s96, s96, 7
 s_lshl_b32 s97, s96, 7
 s_add_u32 s97, s97, s70
 s_add_u32 m0, s73, 49152
 s_add_u32 s78, s97, 0
 buffer_load_dwordx4 v8, s[40:43], s78 offen lds
 s_add_u32 m0, s73, 50176
 s_add_u32 s78, s97, 8192
 buffer_load_dwordx4 v9, s[40:43], s78 offen lds
 s_add_u32 m0, s73, 51200
 s_add_u32 s78, s97, 16384
 buffer_load_dwordx4 v8, s[40:43], s78 offen lds
 s_add_u32 m0, s73, 52224
 s_add_u32 s78, s97, 24576
 buffer_load_dwordx4 v9, s[40:43], s78 offen lds
 s_add_u32 m0, s73, 53248
 s_add_u32 s78, s97, 32768
 buffer_load_dwordx4 v8, s[40:43], s78 offen lds
 s_add_u32 m0, s73, 54272
 s_add_u32 s78, s97, 40960
 buffer_load_dwordx4 v9, s[40:43], s78 offen lds
 s_add_u32 m0, s73, 55296
 s_add_u32 s78, s97, 49152
 buffer_load_dwordx4 v8, s[40:43], s78 offen lds
 s_add_u32 m0, s73, 56320
 s_add_u32 s78, s97, 57344
 buffer_load_dwordx4 v9, s[40:43], s78 offen lds
 s_mul_i32 s97, s96, 196608
 s_add_u32 s3, s75, s97
 s_add_u32 m0, s74, 65536
 s_add_u32 s78, s3, 0
 buffer_load_dwordx4 v10, s[44:47], s78 offen lds
 s_add_u32 m0, s74, 66560
 s_add_u32 s78, s3, 49152
 buffer_load_dwordx4 v10, s[44:47], s78 offen lds
 s_add_u32 s3, s76, s97
 s_add_u32 m0, s74, 69632
 s_add_u32 s78, s3, 0
 buffer_load_dwordx4 v10, s[44:47], s78 offen lds
 s_add_u32 m0, s74, 70656
 s_add_u32 s78, s3, 49152
 buffer_load_dwordx4 v10, s[44:47], s78 offen lds
 s_add_u32 s96, s95, 3
 s_and_b32 s96, s96, 7
 s_lshl_b32 s97, s96, 7
 s_add_u32 s97, s97, s70
 s_add_u32 m0, s73, 73728
 s_add_u32 s78, s97, 0
 buffer_load_dwordx4 v8, s[40:43], s78 offen lds
 s_add_u32 m0, s73, 74752
 s_add_u32 s78, s97, 8192
 buffer_load_dwordx4 v9, s[40:43], s78 offen lds
 s_add_u32 m0, s73, 75776
 s_add_u32 s78, s97, 16384
 buffer_load_dwordx4 v8, s[40:43], s78 offen lds
 s_add_u32 m0, s73, 76800
 s_add_u32 s78, s97, 24576
 buffer_load_dwordx4 v9, s[40:43], s78 offen lds
 s_add_u32 m0, s73, 77824
 s_add_u32 s78, s97, 32768
 buffer_load_dwordx4 v8, s[40:43], s78 offen lds
 s_add_u32 m0, s73, 78848
 s_add_u32 s78, s97, 40960
 buffer_load_dwordx4 v9, s[40:43], s78 offen lds
 s_add_u32 m0, s73, 79872
 s_add_u32 s78, s97, 49152
 buffer_load_dwordx4 v8, s[40:43], s78 offen lds
 s_add_u32 m0, s73, 80896
 s_add_u32 s78, s97, 57344
 buffer_load_dwordx4 v9, s[40:43], s78 offen lds
 s_mul_i32 s97, s96, 196608
 s_add_u32 s3, s75, s97
 s_add_u32 m0, s74, 90112
 s_add_u32 s78, s3, 0
 buffer_load_dwordx4 v10, s[44:47], s78 offen lds
 s_add_u32 m0, s74, 91136
 s_add_u32 s78, s3, 49152
 buffer_load_dwordx4 v10, s[44:47], s78 offen lds
 s_add_u32 s3, s76, s97
 s_add_u32 m0, s74, 94208
 s_add_u32 s78, s3, 0
 buffer_load_dwordx4 v10, s[44:47], s78 offen lds
 s_add_u32 m0, s74, 95232
 s_add_u32 s78, s3, 49152
 buffer_load_dwordx4 v10, s[44:47], s78 offen lds
 s_add_u32 s96, s95, 4
 s_and_b32 s96, s96, 7
 s_lshl_b32 s97, s96, 7
 s_add_u32 s97, s97, s70
 s_add_u32 m0, s73, 106496
 s_add_u32 s78, s97, 0
 buffer_load_dwordx4 v8, s[40:43], s78 offen lds
 s_add_u32 m0, s73, 107520
 s_add_u32 s78, s97, 8192
 buffer_load_dwordx4 v9, s[40:43], s78 offen lds
 s_add_u32 m0, s73, 108544
 s_add_u32 s78, s97, 16384
 buffer_load_dwordx4 v8, s[40:43], s78 offen lds
 s_add_u32 m0, s73, 109568
 s_add_u32 s78, s97, 24576
 buffer_load_dwordx4 v9, s[40:43], s78 offen lds
 s_add_u32 m0, s73, 110592
 s_add_u32 s78, s97, 32768
 buffer_load_dwordx4 v8, s[40:43], s78 offen lds
 s_add_u32 m0, s73, 111616
 s_add_u32 s78, s97, 40960
 buffer_load_dwordx4 v9, s[40:43], s78 offen lds
 s_add_u32 m0, s73, 112640
 s_add_u32 s78, s97, 49152
 buffer_load_dwordx4 v8, s[40:43], s78 offen lds
 s_add_u32 m0, s73, 113664
 s_add_u32 s78, s97, 57344
 buffer_load_dwordx4 v9, s[40:43], s78 offen lds
 s_mul_i32 s97, s96, 196608
 s_add_u32 s3, s75, s97
 s_add_u32 m0, s74, 122880
 s_add_u32 s78, s3, 0
 buffer_load_dwordx4 v10, s[44:47], s78 offen lds
 s_add_u32 m0, s74, 123904
 s_add_u32 s78, s3, 49152
 buffer_load_dwordx4 v10, s[44:47], s78 offen lds
 s_add_u32 s3, s76, s97
 s_add_u32 m0, s74, 126976
 s_add_u32 s78, s3, 0
 buffer_load_dwordx4 v10, s[44:47], s78 offen lds
 s_add_u32 m0, s74, 128000
 s_add_u32 s78, s3, 49152
 buffer_load_dwordx4 v10, s[44:47], s78 offen lds
 s_waitcnt vmcnt(60)
 v_readfirstlane_b32 s31, v28
 s_nop 1
 s_add_u32 s31, s31, 2654435769
 s_mov_b32 s24, s31
 s_mov_b32 s25, s31
 s_waitcnt vmcnt(48) lgkmcnt(0)
 s_barrier
 ds_read_b128 v[76:79], v92 offset:0
 ds_read_b128 v[80:83], v93 offset:0
 ds_read_b128 v[84:87], v94 offset:0
 ds_read_b128 v[88:91], v95 offset:0
 ds_read_b64_tr_b16 v[32:33], v12 offset:0
 ds_read_b64_tr_b16 v[34:35], v12 offset:256
 ds_read_b64_tr_b16 v[36:37], v12 offset:4096
 ds_read_b64_tr_b16 v[38:39], v12 offset:4352
 s_waitcnt lgkmcnt(7)
 v_mfma_f32_16x16x32_bf16 v[68:71], v[60:63], v[76:79], 0
 s_waitcnt lgkmcnt(6)
 v_mfma_f32_16x16x32_bf16 v[72:75], v[60:63], v[80:83], 0
 s_waitcnt lgkmcnt(5)
 v_mfma_f32_16x16x32_bf16 v[68:71], v[60:63], v[84:87], v[68:71]
 s_waitcnt lgkmcnt(4)
 v_mfma_f32_16x16x32_bf16 v[72:75], v[60:63], v[88:91], v[72:75]
 s_waitcnt lgkmcnt(0)
 v_mfma_f32_16x16x32_bf16 v[56:59], v[60:63], v[32:35], 0
 v_mfma_f32_16x16x32_bf16 v[64:67], v[60:63], v[36:39], 0
 s_waitcnt vmcnt(36) lgkmcnt(0)
 s_barrier
 ds_read_b128 v[76:79], v92 offset:24576
 ds_read_b128 v[80:83], v93 offset:24576
 ds_read_b128 v[84:87], v94 offset:24576
 ds_read_b128 v[88:91], v95 offset:24576
 ds_read_b64_tr_b16 v[32:33], v12 offset:24576
 ds_read_b64_tr_b16 v[34:35], v12 offset:24832
 ds_read_b64_tr_b16 v[36:37], v12 offset:28672
 ds_read_b64_tr_b16 v[38:39], v12 offset:28928
 s_waitcnt lgkmcnt(7)
 v_mfma_f32_16x16x32_bf16 v[68:71], v[60:63], v[76:79], v[68:71]
 s_waitcnt lgkmcnt(6)
 v_mfma_f32_16x16x32_bf16 v[72:75], v[60:63], v[80:83], v[72:75]
 s_waitcnt lgkmcnt(5)
 v_mfma_f32_16x16x32_bf16 v[68:71], v[60:63], v[84:87], v[68:71]
 s_waitcnt lgkmcnt(4)
 v_mfma_f32_16x16x32_bf16 v[72:75], v[60:63], v[88:91], v[72:75]
 s_waitcnt lgkmcnt(0)
 v_mfma_f32_16x16x32_bf16 v[56:59], v[60:63], v[32:35], v[56:59]
 v_mfma_f32_16x16x32_bf16 v[64:67], v[60:63], v[36:39], v[64:67]
 s_waitcnt vmcnt(24) lgkmcnt(0)
 s_barrier
 ds_read_b128 v[76:79], v92 offset:49152
 ds_read_b128 v[80:83], v93 offset:49152
 ds_read_b128 v[84:87], v94 offset:49152
 ds_read_b128 v[88:91], v95 offset:49152
 ds_read_b64_tr_b16 v[32:33], v12 offset:49152
 ds_read_b64_tr_b16 v[34:35], v12 offset:49408
 ds_read_b64_tr_b16 v[36:37], v12 offset:53248
 ds_read_b64_tr_b16 v[38:39], v12 offset:53504
 s_add_u32 s96, s95, 5
 s_and_b32 s96, s96, 7
 s_lshl_b32 s97, s96, 7
 s_add_u32 s97, s97, s70
 s_add_u32 m0, s73, 0
 s_add_u32 s78, s97, 0
 buffer_load_dwordx4 v8, s[40:43], s78 offen lds
 s_add_u32 m0, s73, 1024
 s_add_u32 s78, s97, 8192
 buffer_load_dwordx4 v9, s[40:43], s78 offen lds
 s_add_u32 m0, s73, 2048
 s_add_u32 s78, s97, 16384
 buffer_load_dwordx4 v8, s[40:43], s78 offen lds
 s_add_u32 m0, s73, 3072
 s_add_u32 s78, s97, 24576
 buffer_load_dwordx4 v9, s[40:43], s78 offen lds
 s_add_u32 m0, s73, 4096
 s_add_u32 s78, s97, 32768
 buffer_load_dwordx4 v8, s[40:43], s78 offen lds
 s_add_u32 m0, s73, 5120
 s_add_u32 s78, s97, 40960
 buffer_load_dwordx4 v9, s[40:43], s78 offen lds
 s_add_u32 m0, s73, 6144
 s_add_u32 s78, s97, 49152
 buffer_load_dwordx4 v8, s[40:43], s78 offen lds
 s_add_u32 m0, s73, 7168
 s_add_u32 s78, s97, 57344
 buffer_load_dwordx4 v9, s[40:43], s78 offen lds
 s_mul_i32 s97, s96, 196608
 s_add_u32 s3, s75, s97
 s_add_u32 m0, s74, 16384
 s_add_u32 s78, s3, 0
 buffer_load_dwordx4 v10, s[44:47], s78 offen lds
 s_add_u32 m0, s74, 17408
 s_add_u32 s78, s3, 49152
 buffer_load_dwordx4 v10, s[44:47], s78 offen lds
 s_add_u32 s3, s76, s97
 s_add_u32 m0, s74, 20480
 s_add_u32 s78, s3, 0
 buffer_load_dwordx4 v10, s[44:47], s78 offen lds
 s_add_u32 m0, s74, 21504
 s_add_u32 s78, s3, 49152
 buffer_load_dwordx4 v10, s[44:47], s78 offen lds
 s_waitcnt lgkmcnt(7)
 v_mfma_f32_16x16x32_bf16 v[68:71], v[60:63], v[76:79], v[68:71]
 s_waitcnt lgkmcnt(6)
 v_mfma_f32_16x16x32_bf16 v[72:75], v[60:63], v[80:83], v[72:75]
 s_waitcnt lgkmcnt(5)
 v_mfma_f32_16x16x32_bf16 v[68:71], v[60:63], v[84:87], v[68:71]
 s_waitcnt lgkmcnt(4)
 v_mfma_f32_16x16x32_bf16 v[72:75], v[60:63], v[88:91], v[72:75]
 s_waitcnt lgkmcnt(0)
 v_mfma_f32_16x16x32_bf16 v[56:59], v[60:63], v[32:35], v[56:59]
 v_mfma_f32_16x16x32_bf16 v[64:67], v[60:63], v[36:39], v[64:67]
 s_waitcnt vmcnt(24) lgkmcnt(0)
 s_barrier
 v_add_u32 v92, 73728, v92
 v_add_u32 v93, 73728, v93
 v_add_u32 v94, 73728, v94
 v_add_u32 v95, 73728, v95
 ds_read_b128 v[76:79], v92 offset:0
 ds_read_b128 v[80:83], v93 offset:0
 ds_read_b128 v[84:87], v94 offset:0
 ds_read_b128 v[88:91], v95 offset:0
 ds_read_b64_tr_b16 v[32:33], v13 offset:0
 ds_read_b64_tr_b16 v[34:35], v13 offset:256
 ds_read_b64_tr_b16 v[36:37], v13 offset:4096
 ds_read_b64_tr_b16 v[38:39], v13 offset:4352
 s_add_u32 s96, s95, 6
 s_and_b32 s96, s96, 7
 s_lshl_b32 s97, s96, 7
 s_add_u32 s97, s97, s70
 s_add_u32 m0, s73, 24576
 s_add_u32 s78, s97, 0
 buffer_load_dwordx4 v8, s[40:43], s78 offen lds
 s_add_u32 m0, s73, 25600
 s_add_u32 s78, s97, 8192
 buffer_load_dwordx4 v9, s[40:43], s78 offen lds
 s_add_u32 m0, s73, 26624
 s_add_u32 s78, s97, 16384
 buffer_load_dwordx4 v8, s[40:43], s78 offen lds
 s_add_u32 m0, s73, 27648
 s_add_u32 s78, s97, 24576
 buffer_load_dwordx4 v9, s[40:43], s78 offen lds
 s_add_u32 m0, s73, 28672
 s_add_u32 s78, s97, 32768
 buffer_load_dwordx4 v8, s[40:43], s78 offen lds
 s_add_u32 m0, s73, 29696
 s_add_u32 s78, s97, 40960
 buffer_load_dwordx4 v9, s[40:43], s78 offen lds
 s_add_u32 m0, s73, 30720
 s_add_u32 s78, s97, 49152
 buffer_load_dwordx4 v8, s[40:43], s78 offen lds
 s_add_u32 m0, s73, 31744
 s_add_u32 s78, s97, 57344
 buffer_load_dwordx4 v9, s[40:43], s78 offen lds
 s_mul_i32 s97, s96, 196608
 s_add_u32 s3, s75, s97
 s_add_u32 m0, s74, 40960
 s_add_u32 s78, s3, 0
 buffer_load_dwordx4 v10, s[44:47], s78 offen lds
 s_add_u32 m0, s74, 41984
 s_add_u32 s78, s3, 49152
 buffer_load_dwordx4 v10, s[44:47], s78 offen lds
 s_add_u32 s3, s76, s97
 s_add_u32 m0, s74, 45056
 s_add_u32 s78, s3, 0
 buffer_load_dwordx4 v10, s[44:47], s78 offen lds
 s_add_u32 m0, s74, 46080
 s_add_u32 s78, s3, 49152
 buffer_load_dwordx4 v10, s[44:47], s78 offen lds
 s_waitcnt lgkmcnt(7)
 v_mfma_f32_16x16x32_bf16 v[68:71], v[60:63], v[76:79], v[68:71]
 s_waitcnt lgkmcnt(6)
 v_mfma_f32_16x16x32_bf16 v[72:75], v[60:63], v[80:83], v[72:75]
 s_waitcnt lgkmcnt(5)
 v_mfma_f32_16x16x32_bf16 v[68:71], v[60:63], v[84:87], v[68:71]
 s_waitcnt lgkmcnt(4)
 v_mfma_f32_16x16x32_bf16 v[72:75], v[60:63], v[88:91], v[72:75]
 s_waitcnt lgkmcnt(0)
 v_mfma_f32_16x16x32_bf16 v[56:59], v[60:63], v[32:35], v[56:59]
 v_mfma_f32_16x16x32_bf16 v[64:67], v[60:63], v[36:39], v[64:67]
 s_waitcnt vmcnt(24) lgkmcnt(0)
 s_barrier
 ds_read_b128 v[76:79], v92 offset:32768
 ds_read_b128 v[80:83], v93 offset:32768
 ds_read_b128 v[84:87], v94 offset:32768
 ds_read_b128 v[88:91], v95 offset:32768
 ds_read_b64_tr_b16 v[32:33], v13 offset:32768
 ds_read_b64_tr_b16 v[34:35], v13 offset:33024
 ds_read_b64_tr_b16 v[36:37], v13 offset:36864
 ds_read_b64_tr_b16 v[38:39], v13 offset:37120
 s_add_u32 s96, s95, 7
 s_and_b32 s96, s96, 7
 s_lshl_b32 s97, s96, 7
 s_add_u32 s97, s97, s70
 s_add_u32 m0, s73, 49152
 s_add_u32 s78, s97, 0
 buffer_load_dwordx4 v8, s[40:43], s78 offen lds
 s_add_u32 m0, s73, 50176
 s_add_u32 s78, s97, 8192
 buffer_load_dwordx4 v9, s[40:43], s78 offen lds
 s_add_u32 m0, s73, 51200
 s_add_u32 s78, s97, 16384
 buffer_load_dwordx4 v8, s[40:43], s78 offen lds
 s_add_u32 m0, s73, 52224
 s_add_u32 s78, s97, 24576
 buffer_load_dwordx4 v9, s[40:43], s78 offen lds
 s_add_u32 m0, s73, 53248
 s_add_u32 s78, s97, 32768
 buffer_load_dwordx4 v8, s[40:43], s78 offen lds
 s_add_u32 m0, s73, 54272
 s_add_u32 s78, s97, 40960
 buffer_load_dwordx4 v9, s[40:43], s78 offen lds
 s_add_u32 m0, s73, 55296
 s_add_u32 s78, s97, 49152
 buffer_load_dwordx4 v8, s[40:43], s78 offen lds
 s_add_u32 m0, s73, 56320
 s_add_u32 s78, s97, 57344
 buffer_load_dwordx4 v9, s[40:43], s78 offen lds
 s_mul_i32 s97, s96, 196608
 s_add_u32 s3, s75, s97
 s_add_u32 m0, s74, 65536
 s_add_u32 s78, s3, 0
 buffer_load_dwordx4 v10, s[44:47], s78 offen lds
 s_add_u32 m0, s74, 66560
 s_add_u32 s78, s3, 49152
 buffer_load_dwordx4 v10, s[44:47], s78 offen lds
 s_add_u32 s3, s76, s97
 s_add_u32 m0, s74, 69632
 s_add_u32 s78, s3, 0
 buffer_load_dwordx4 v10, s[44:47], s78 offen lds
 s_add_u32 m0, s74, 70656
 s_add_u32 s78, s3, 49152
 buffer_load_dwordx4 v10, s[44:47], s78 offen lds
 s_waitcnt lgkmcnt(7)
 v_mfma_f32_16x16x32_bf16 v[68:71], v[60:63], v[76:79], v[68:71]
 s_waitcnt lgkmcnt(6)
 v_mfma_f32_16x16x32_bf16 v[72:75], v[60:63], v[80:83], v[72:75]
 s_waitcnt lgkmcnt(5)
 v_mfma_f32_16x16x32_bf16 v[68:71], v[60:63], v[84:87], v[68:71]
 s_waitcnt lgkmcnt(4)
 v_mfma_f32_16x16x32_bf16 v[72:75], v[60:63], v[88:91], v[72:75]
 s_waitcnt lgkmcnt(0)
 v_mfma_f32_16x16x32_bf16 v[56:59], v[60:63], v[32:35], v[56:59]
 v_mfma_f32_16x16x32_bf16 v[64:67], v[60:63], v[36:39], v[64:67]
 s_waitcnt vmcnt(24) lgkmcnt(0)
 s_barrier
 v_subrev_u32 v92, 73728, v92
 v_subrev_u32 v93, 73728, v93
 v_subrev_u32 v94, 73728, v94
 v_subrev_u32 v95, 73728, v95
 ds_read_b128 v[76:79], v92 offset:0
 ds_read_b128 v[80:83], v93 offset:0
 ds_read_b128 v[84:87], v94 offset:0
 ds_read_b128 v[88:91], v95 offset:0
 ds_read_b64_tr_b16 v[32:33], v12 offset:0
 ds_read_b64_tr_b16 v[34:35], v12 offset:256
 ds_read_b64_tr_b16 v[36:37], v12 offset:4096
 ds_read_b64_tr_b16 v[38:39], v12 offset:4352
 s_add_u32 s96, s95, 0
 s_and_b32 s96, s96, 7
 s_mul_i32 s97, s96, 176128
 s_add_u32 s3, s79, s97
 s_add_u32 m0, s74, 73728
 s_add_u32 s78, s3, 0
 buffer_load_dwordx4 v11, s[48:51], s78 offen lds
 s_add_u32 m0, s74, 74752
 s_add_u32 s78, s3, 44032
 buffer_load_dwordx4 v11, s[48:51], s78 offen lds
 s_mul_i32 s97, s96, 176128
 s_add_u32 s3, s79, s97
 s_add_u32 m0, s74, 77824
 s_add_u32 s78, s3, 64
 buffer_load_dwordx4 v11, s[48:51], s78 offen lds
 s_add_u32 m0, s74, 78848
 s_add_u32 s78, s3, 44096
 buffer_load_dwordx4 v11, s[48:51], s78 offen lds
 s_add_u32 s96, s95, 1
 s_and_b32 s96, s96, 7
 s_mul_i32 s97, s96, 176128
 s_add_u32 s3, s79, s97
 s_add_u32 m0, s74, 81920
 s_add_u32 s78, s3, 0
 buffer_load_dwordx4 v11, s[48:51], s78 offen lds
 s_add_u32 m0, s74, 82944
 s_add_u32 s78, s3, 44032
 buffer_load_dwordx4 v11, s[48:51], s78 offen lds
 s_mul_i32 s97, s96, 176128
 s_add_u32 s3, s79, s97
 s_add_u32 m0, s74, 86016
 s_add_u32 s78, s3, 64
 buffer_load_dwordx4 v11, s[48:51], s78 offen lds
 s_add_u32 m0, s74, 87040
 s_add_u32 s78, s3, 44096
 buffer_load_dwordx4 v11, s[48:51], s78 offen lds
 s_waitcnt lgkmcnt(7)
 v_mfma_f32_16x16x32_bf16 v[68:71], v[60:63], v[76:79], v[68:71]
 s_waitcnt lgkmcnt(6)
 v_mfma_f32_16x16x32_bf16 v[72:75], v[60:63], v[80:83], v[72:75]
 s_waitcnt lgkmcnt(5)
 v_mfma_f32_16x16x32_bf16 v[68:71], v[60:63], v[84:87], v[68:71]
 s_waitcnt lgkmcnt(4)
 v_mfma_f32_16x16x32_bf16 v[72:75], v[60:63], v[88:91], v[72:75]
 s_waitcnt lgkmcnt(0)
 v_mfma_f32_16x16x32_bf16 v[56:59], v[60:63], v[32:35], v[56:59]
 v_mfma_f32_16x16x32_bf16 v[64:67], v[60:63], v[36:39], v[64:67]
 s_waitcnt vmcnt(20) lgkmcnt(0)
 s_barrier
 ds_read_b128 v[76:79], v92 offset:24576
 ds_read_b128 v[80:83], v93 offset:24576
 ds_read_b128 v[84:87], v94 offset:24576
 ds_read_b128 v[88:91], v95 offset:24576
 ds_read_b64_tr_b16 v[32:33], v12 offset:24576
 ds_read_b64_tr_b16 v[34:35], v12 offset:24832
 ds_read_b64_tr_b16 v[36:37], v12 offset:28672
 ds_read_b64_tr_b16 v[38:39], v12 offset:28928
 s_add_u32 s96, s95, 2
 s_and_b32 s96, s96, 7
 s_mul_i32 s97, s96, 176128
 s_add_u32 s3, s79, s97
 s_add_u32 m0, s74, 90112
 s_add_u32 s78, s3, 0
 buffer_load_dwordx4 v11, s[48:51], s78 offen lds
 s_add_u32 m0, s74, 91136
 s_add_u32 s78, s3, 44032
 buffer_load_dwordx4 v11, s[48:51], s78 offen lds
 s_mul_i32 s97, s96, 176128
 s_add_u32 s3, s79, s97
 s_add_u32 m0, s74, 94208
 s_add_u32 s78, s3, 64
 buffer_load_dwordx4 v11, s[48:51], s78 offen lds
 s_add_u32 m0, s74, 95232
 s_add_u32 s78, s3, 44096
 buffer_load_dwordx4 v11, s[48:51], s78 offen lds
 s_add_u32 s96, s95, 3
 s_and_b32 s96, s96, 7
 s_mul_i32 s97, s96, 176128
 s_add_u32 s3, s79, s97
 s_add_u32 m0, s74, 98304
 s_add_u32 s78, s3, 0
 buffer_load_dwordx4 v11, s[48:51], s78 offen lds
 s_add_u32 m0, s74, 99328
 s_add_u32 s78, s3, 44032
 buffer_load_dwordx4 v11, s[48:51], s78 offen lds
 s_mul_i32 s97, s96, 176128
 s_add_u32 s3, s79, s97
 s_add_u32 m0, s74, 102400
 s_add_u32 s78, s3, 64
 buffer_load_dwordx4 v11, s[48:51], s78 offen lds
 s_add_u32 m0, s74, 103424
 s_add_u32 s78, s3, 44096
 buffer_load_dwordx4 v11, s[48:51], s78 offen lds
 s_waitcnt lgkmcnt(7)
 v_mfma_f32_16x16x32_bf16 v[68:71], v[60:63], v[76:79], v[68:71]
 s_waitcnt lgkmcnt(6)
 v_mfma_f32_16x16x32_bf16 v[72:75], v[60:63], v[80:83], v[72:75]
 s_waitcnt lgkmcnt(5)
 v_mfma_f32_16x16x32_bf16 v[68:71], v[60:63], v[84:87], v[68:71]
 s_waitcnt lgkmcnt(4)
 v_mfma_f32_16x16x32_bf16 v[72:75], v[60:63], v[88:91], v[72:75]
 s_waitcnt lgkmcnt(0)
 v_mfma_f32_16x16x32_bf16 v[56:59], v[60:63], v[32:35], v[56:59]
 v_mfma_f32_16x16x32_bf16 v[64:67], v[60:63], v[36:39], v[64:67]
 s_waitcnt vmcnt(16) lgkmcnt(0)
 s_barrier
 ds_read_b128 v[76:79], v92 offset:49152
 ds_read_b128 v[80:83], v93 offset:49152
 ds_read_b128 v[84:87], v94 offset:49152
 ds_read_b128 v[88:91], v95 offset:49152
 ds_read_b64_tr_b16 v[32:33], v12 offset:49152
 ds_read_b64_tr_b16 v[34:35], v12 offset:49408
 ds_read_b64_tr_b16 v[36:37], v12 offset:53248
 ds_read_b64_tr_b16 v[38:39], v12 offset:53504
 s_add_u32 s96, s95, 4
 s_and_b32 s96, s96, 7
 s_mul_i32 s97, s96, 176128
 s_add_u32 s3, s79, s97
 s_add_u32 m0, s74, 106496
 s_add_u32 s78, s3, 0
 buffer_load_dwordx4 v11, s[48:51], s78 offen lds
 s_add_u32 m0, s74, 107520
 s_add_u32 s78, s3, 44032
 buffer_load_dwordx4 v11, s[48:51], s78 offen lds
 s_mul_i32 s97, s96, 176128
 s_add_u32 s3, s79, s97
 s_add_u32 m0, s74, 110592
 s_add_u32 s78, s3, 64
 buffer_load_dwordx4 v11, s[48:51], s78 offen lds
 s_add_u32 m0, s74, 111616
 s_add_u32 s78, s3, 44096
 buffer_load_dwordx4 v11, s[48:51], s78 offen lds
 s_add_u32 s96, s95, 5
 s_and_b32 s96, s96, 7
 s_mul_i32 s97, s96, 176128
 s_add_u32 s3, s79, s97
 s_add_u32 m0, s74, 114688
 s_add_u32 s78, s3, 0
 buffer_load_dwordx4 v11, s[48:51], s78 offen lds
 s_add_u32 m0, s74, 115712
 s_add_u32 s78, s3, 44032
 buffer_load_dwordx4 v11, s[48:51], s78 offen lds
 s_mul_i32 s97, s96, 176128
 s_add_u32 s3, s79, s97
 s_add_u32 m0, s74, 118784
 s_add_u32 s78, s3, 64
 buffer_load_dwordx4 v11, s[48:51], s78 offen lds
 s_add_u32 m0, s74, 119808
 s_add_u32 s78, s3, 44096
 buffer_load_dwordx4 v11, s[48:51], s78 offen lds
 s_waitcnt lgkmcnt(7)
 v_mfma_f32_16x16x32_bf16 v[68:71], v[60:63], v[76:79], v[68:71]
 s_waitcnt lgkmcnt(6)
 v_mfma_f32_16x16x32_bf16 v[72:75], v[60:63], v[80:83], v[72:75]
 s_waitcnt lgkmcnt(5)
 v_mfma_f32_16x16x32_bf16 v[68:71], v[60:63], v[84:87], v[68:71]
 s_waitcnt lgkmcnt(4)
 v_mfma_f32_16x16x32_bf16 v[72:75], v[60:63], v[88:91], v[72:75]
 s_waitcnt lgkmcnt(0)
 v_mfma_f32_16x16x32_bf16 v[56:59], v[60:63], v[32:35], v[56:59]
 v_mfma_f32_16x16x32_bf16 v[64:67], v[60:63], v[36:39], v[64:67]
 v_lshlrev_b32 v3, 2, v0
 s_lshl_b32 s81, s38, 7
 s_add_u32 s81, s81, 159744
 v_add_u32 v3, s81, v3
 s_nop 9
 v_add_f32 v68, v68, v72
 v_add_f32 v69, v69, v73
 s_mov_b64 exec, 0xffff
 ds_write_b32 v3, v68
 ds_write_b32 v3, v69 offset:64
 s_mov_b64 exec, -1
 s_mov_b64 exec, 0xffff
 ds_write_b32 v18, v56 offset:0
 ds_write_b32 v18, v57 offset:256
 s_mov_b64 exec, -1
 s_mov_b64 exec, 0xffff
 ds_write_b32 v18, v64 offset:512
 ds_write_b32 v18, v65 offset:768
 s_mov_b64 exec, -1
 s_waitcnt vmcnt(16) lgkmcnt(0)
 s_barrier
 v_and_b32 v3, 3, v0
 v_lshlrev_b32 v3, 3, v3
 v_add_u32 v24, 147648, v3
 s_lshl_b32 s81, s38, 2
 s_add_u32 s81, s81, 147584
 v_add_u32 v22, s81, v3
 s_xor_b32 s81, s38, 1
 s_lshl_b32 s81, s81, 2
 s_add_u32 s81, s81, 147584
 v_mov_b32 v23, s81
 s_lshl_b32 s81, s38, 11
 s_add_u32 s81, s81, 73728
 v_subrev_u32 v25, s71, v14
 v_subrev_u32 v25, 73728, v25
 v_add_u32 v25, s81, v25
 s_add_u32 s96, s95, 6
 s_and_b32 s96, s96, 7
 s_mul_i32 s97, s96, 176128
 s_add_u32 s3, s79, s97
 s_add_u32 m0, s74, 122880
 s_add_u32 s78, s3, 0
 buffer_load_dwordx4 v11, s[48:51], s78 offen lds
 s_add_u32 m0, s74, 123904
 s_add_u32 s78, s3, 44032
 buffer_load_dwordx4 v11, s[48:51], s78 offen lds
 s_mul_i32 s97, s96, 176128
 s_add_u32 s3, s79, s97
 s_add_u32 m0, s74, 126976
 s_add_u32 s78, s3, 64
 buffer_load_dwordx4 v11, s[48:51], s78 offen lds
 s_add_u32 m0, s74, 128000
 s_add_u32 s78, s3, 44096
 buffer_load_dwordx4 v11, s[48:51], s78 offen lds
 s_add_u32 s96, s95, 7
 s_and_b32 s96, s96, 7
 s_mul_i32 s97, s96, 176128
 s_add_u32 s3, s79, s97
 s_add_u32 m0, s74, 131072
 s_add_u32 s78, s3, 0
 buffer_load_dwordx4 v11, s[48:51], s78 offen lds
 s_add_u32 m0, s74, 132096
 s_add_u32 s78, s3, 44032
 buffer_load_dwordx4 v11, s[48:51], s78 offen lds
 s_mul_i32 s97, s96, 176128
 s_add_u32 s3, s79, s97
 s_add_u32 m0, s74, 135168
 s_add_u32 s78, s3, 64
 buffer_load_dwordx4 v11, s[48:51], s78 offen lds
 s_add_u32 m0, s74, 136192
 s_add_u32 s78, s3, 44096
 buffer_load_dwordx4 v11, s[48:51], s78 offen lds
 s_waitcnt vmcnt(16)
 v_mov_b32 v26, 2
 s_mov_b64 exec, 0xf
 ds_write_b32 v22, v26 offset:0
 s_mov_b64 exec, -1
 ds_read_b64_tr_b16 v[32:33], v25 offset:0
 ds_read_b64_tr_b16 v[34:35], v25 offset:256
 ds_read_b64_tr_b16 v[36:37], v25 offset:1024
 ds_read_b64_tr_b16 v[38:39], v25 offset:1280
 ds_read_b64_tr_b16 v[40:41], v25 offset:4096
 ds_read_b64_tr_b16 v[42:43], v25 offset:4352
 ds_read_b64_tr_b16 v[44:45], v25 offset:5120
 ds_read_b64_tr_b16 v[46:47], v25 offset:5376
 ds_read_b64_tr_b16 v[76:77], v25 offset:8192
 ds_read_b64_tr_b16 v[78:79], v25 offset:8448
 ds_read_b64_tr_b16 v[80:81], v25 offset:9216
 ds_read_b64_tr_b16 v[82:83], v25 offset:9472
 ds_read_b64_tr_b16 v[84:85], v25 offset:12288
 ds_read_b64_tr_b16 v[86:87], v25 offset:12544
 ds_read_b64_tr_b16 v[88:89], v25 offset:13312
 ds_read_b64_tr_b16 v[90:91], v25 offset:13568
 s_waitcnt lgkmcnt(0)
 v_mfma_f32_16x16x32_bf16 v[56:59], v[60:63], v[32:35], 0
 v_mfma_f32_16x16x32_bf16 v[56:59], v[60:63], v[36:39], v[56:59]
 v_mfma_f32_16x16x32_bf16 v[64:67], v[60:63], v[40:43], 0
 v_mfma_f32_16x16x32_bf16 v[64:67], v[60:63], v[44:47], v[64:67]
 v_mfma_f32_16x16x32_bf16 v[56:59], v[60:63], v[76:79], v[56:59]
 v_mfma_f32_16x16x32_bf16 v[56:59], v[60:63], v[80:83], v[56:59]
 v_mfma_f32_16x16x32_bf16 v[64:67], v[60:63], v[84:87], v[64:67]
 v_mfma_f32_16x16x32_bf16 v[64:67], v[60:63], v[88:91], v[64:67]
 s_waitcnt vmcnt(8)
 v_mov_b32 v26, 3
 s_mov_b64 exec, 0xf
 ds_write_b32 v22, v26 offset:0
 s_mov_b64 exec, -1
 ds_read_b64_tr_b16 v[32:33], v25 offset:16384
 ds_read_b64_tr_b16 v[34:35], v25 offset:16640
 ds_read_b64_tr_b16 v[36:37], v25 offset:17408
 ds_read_b64_tr_b16 v[38:39], v25 offset:17664
 ds_read_b64_tr_b16 v[40:41], v25 offset:20480
 ds_read_b64_tr_b16 v[42:43], v25 offset:20736
 ds_read_b64_tr_b16 v[44:45], v25 offset:21504
 ds_read_b64_tr_b16 v[46:47], v25 offset:21760
 ds_read_b64_tr_b16 v[76:77], v25 offset:24576
 ds_read_b64_tr_b16 v[78:79], v25 offset:24832
 ds_read_b64_tr_b16 v[80:81], v25 offset:25600
 ds_read_b64_tr_b16 v[82:83], v25 offset:25856
 ds_read_b64_tr_b16 v[84:85], v25 offset:28672
 ds_read_b64_tr_b16 v[86:87], v25 offset:28928
 ds_read_b64_tr_b16 v[88:89], v25 offset:29696
 ds_read_b64_tr_b16 v[90:91], v25 offset:29952
 s_waitcnt lgkmcnt(0)
 v_mfma_f32_16x16x32_bf16 v[56:59], v[60:63], v[32:35], v[56:59]
 v_mfma_f32_16x16x32_bf16 v[56:59], v[60:63], v[36:39], v[56:59]
 v_mfma_f32_16x16x32_bf16 v[64:67], v[60:63], v[40:43], v[64:67]
 v_mfma_f32_16x16x32_bf16 v[64:67], v[60:63], v[44:47], v[64:67]
 v_mfma_f32_16x16x32_bf16 v[56:59], v[60:63], v[76:79], v[56:59]
 v_mfma_f32_16x16x32_bf16 v[56:59], v[60:63], v[80:83], v[56:59]
 v_mfma_f32_16x16x32_bf16 v[64:67], v[60:63], v[84:87], v[64:67]
 v_mfma_f32_16x16x32_bf16 v[64:67], v[60:63], v[88:91], v[64:67]
 s_mov_b32 s39, 1048576
LS_2:
 ds_read_b32 v27, v24 offset:0
 s_waitcnt lgkmcnt(0)
 v_cmp_gt_u32 vcc, 1, v27
 s_nop 0
 s_cbranch_vccz LD_3
 s_sub_u32 s39, s39, 1
 s_cbranch_scc0 LS_2
LD_3:
 s_add_u32 s96, s95, 0
 s_and_b32 s96, s96, 7
 s_mul_i32 s97, s96, 196608
 s_add_u32 s3, s77, s97
 s_add_u32 m0, s74, 73728
 s_add_u32 s78, s3, 0
 buffer_load_dwordx4 v10, s[44:47], s78 offen lds
 s_add_u32 m0, s74, 74752
 s_add_u32 s78, s3, 49152
 buffer_load_dwordx4 v10, s[44:47], s78 offen lds
 s_add_u32 s96, s95, 1
 s_and_b32 s96, s96, 7
 s_mul_i32 s97, s96, 196608
 s_add_u32 s3, s77, s97
 s_add_u32 m0, s74, 77824
 s_add_u32 s78, s3, 0
 buffer_load_dwordx4 v10, s[44:47], s78 offen lds
 s_add_u32 m0, s74, 78848
 s_add_u32 s78, s3, 49152
 buffer_load_dwordx4 v10, s[44:47], s78 offen lds
 s_add_u32 s96, s95, 2
 s_and_b32 s96, s96, 7
 s_mul_i32 s97, s96, 196608
 s_add_u32 s3, s77, s97
 s_add_u32 m0, s74, 81920
 s_add_u32 s78, s3, 0
 buffer_load_dwordx4 v10, s[44:47], s78 offen lds
 s_add_u32 m0, s74, 82944
 s_add_u32 s78, s3, 49152
 buffer_load_dwordx4 v10, s[44:47], s78 offen lds
 s_add_u32 s96, s95, 3
 s_and_b32 s96, s96, 7
 s_mul_i32 s97, s96, 196608
 s_add_u32 s3, s77, s97
 s_add_u32 m0, s74, 86016
 s_add_u32 s78, s3, 0
 buffer_load_dwordx4 v10, s[44:47], s78 offen lds
 s_add_u32 m0, s74, 87040
 s_add_u32 s78, s3, 49152
 buffer_load_dwordx4 v10, s[44:47], s78 offen lds
 s_waitcnt vmcnt(8)
 v_mov_b32 v26, 4
 s_mov_b64 exec, 0xf
 ds_write_b32 v22, v26 offset:0
 s_mov_b64 exec, -1
 ds_read_b64_tr_b16 v[32:33], v25 offset:32768
 ds_read_b64_tr_b16 v[34:35], v25 offset:33024
 ds_read_b64_tr_b16 v[36:37], v25 offset:33792
 ds_read_b64_tr_b16 v[38:39], v25 offset:34048
 ds_read_b64_tr_b16 v[40:41], v25 offset:36864
 ds_read_b64_tr_b16 v[42:43], v25 offset:37120
 ds_read_b64_tr_b16 v[44:45], v25 offset:37888
 ds_read_b64_tr_b16 v[46:47], v25 offset:38144
 ds_read_b64_tr_b16 v[76:77], v25 offset:40960
 ds_read_b64_tr_b16 v[78:79], v25 offset:41216
 ds_read_b64_tr_b16 v[80:81], v25 offset:41984
 ds_read_b64_tr_b16 v[82:83], v25 offset:42240
 ds_read_b64_tr_b16 v[84:85], v25 offset:45056
 ds_read_b64_tr_b16 v[86:87], v25 offset:45312
 ds_read_b64_tr_b16 v[88:89], v25 offset:46080
 ds_read_b64_tr_b16 v[90:91], v25 offset:46336
 s_waitcnt lgkmcnt(0)
 v_mfma_f32_16x16x32_bf16 v[56:59], v[60:63], v[32:35], v[56:59]
 v_mfma_f32_16x16x32_bf16 v[56:59], v[60:63], v[36:39], v[56:59]
 v_mfma_f32_16x16x32_bf16 v[64:67], v[60:63], v[40:43], v[64:67]
 v_mfma_f32_16x16x32_bf16 v[64:67], v[60:63], v[44:47], v[64:67]
 v_mfma_f32_16x16x32_bf16 v[56:59], v[60:63], v[76:79], v[56:59]
 v_mfma_f32_16x16x32_bf16 v[56:59], v[60:63], v[80:83], v[56:59]
 v_mfma_f32_16x16x32_bf16 v[64:67], v[60:63], v[84:87], v[64:67]
 v_mfma_f32_16x16x32_bf16 v[64:67], v[60:63], v[88:91], v[64:67]
 s_mov_b32 s39, 1048576
LS_4:
 ds_read_b32 v27, v24 offset:0
 s_waitcnt lgkmcnt(0)
 v_cmp_gt_u32 vcc, 2, v27
 s_nop 0
 s_cbranch_vccz LD_5
 s_sub_u32 s39, s39, 1
 s_cbranch_scc0 LS_4
LD_5:
 s_add_u32 s96, s95, 4
 s_and_b32 s96, s96, 7
 s_mul_i32 s97, s96, 196608
 s_add_u32 s3, s77, s97
 s_add_u32 m0, s74, 90112
 s_add_u32 s78, s3, 0
 buffer_load_dwordx4 v10, s[44:47], s78 offen lds
 s_add_u32 m0, s74, 91136
 s_add_u32 s78, s3, 49152
 buffer_load_dwordx4 v10, s[44:47], s78 offen lds
 s_add_u32 s96, s95, 5
 s_and_b32 s96, s96, 7
 s_mul_i32 s97, s96, 196608
 s_add_u32 s3, s77, s97
 s_add_u32 m0, s74, 94208
 s_add_u32 s78, s3, 0
 buffer_load_dwordx4 v10, s[44:47], s78 offen lds
 s_add_u32 m0, s74, 95232
 s_add_u32 s78, s3, 49152
 buffer_load_dwordx4 v10, s[44:47], s78 offen lds
 s_add_u32 s96, s95, 6
 s_and_b32 s96, s96, 7
 s_mul_i32 s97, s96, 196608
 s_add_u32 s3, s77, s97
 s_add_u32 m0, s74, 98304
 s_add_u32 s78, s3, 0
 buffer_load_dwordx4 v10, s[44:47], s78 offen lds
 s_add_u32 m0, s74, 99328
 s_add_u32 s78, s3, 49152
 buffer_load_dwordx4 v10, s[44:47], s78 offen lds
 s_add_u32 s96, s95, 7
 s_and_b32 s96, s96, 7
 s_mul_i32 s97, s96, 196608
 s_add_u32 s3, s77, s97
 s_add_u32 m0, s74, 102400
 s_add_u32 s78, s3, 0
 buffer_load_dwordx4 v10, s[44:47], s78 offen lds
 s_add_u32 m0, s74, 103424
 s_add_u32 s78, s3, 49152
 buffer_load_dwordx4 v10, s[44:47], s78 offen lds
 s_waitcnt vmcnt(8)
 v_mov_b32 v26, 5
 s_mov_b64 exec, 0xf
 ds_write_b32 v22, v26 offset:0
 s_mov_b64 exec, -1
 ds_read_b64_tr_b16 v[32:33], v25 offset:49152
 ds_read_b64_tr_b16 v[34:35], v25 offset:49408
 ds_read_b64_tr_b16 v[36:37], v25 offset:50176
 ds_read_b64_tr_b16 v[38:39], v25 offset:50432
 ds_read_b64_tr_b16 v[40:41], v25 offset:53248
 ds_read_b64_tr_b16 v[42:43], v25 offset:53504
 ds_read_b64_tr_b16 v[44:45], v25 offset:54272
 ds_read_b64_tr_b16 v[46:47], v25 offset:54528
 ds_read_b64_tr_b16 v[76:77], v25 offset:57344
 ds_read_b64_tr_b16 v[78:79], v25 offset:57600
 ds_read_b64_tr_b16 v[80:81], v25 offset:58368
 ds_read_b64_tr_b16 v[82:83], v25 offset:58624
 ds_read_b64_tr_b16 v[84:85], v25 offset:61440
 ds_read_b64_tr_b16 v[86:87], v25 offset:61696
 ds_read_b64_tr_b16 v[88:89], v25 offset:62464
 ds_read_b64_tr_b16 v[90:91], v25 offset:62720
 s_waitcnt lgkmcnt(0)
 v_mfma_f32_16x16x32_bf16 v[56:59], v[60:63], v[32:35], v[56:59]
 v_mfma_f32_16x16x32_bf16 v[56:59], v[60:63], v[36:39], v[56:59]
 v_mfma_f32_16x16x32_bf16 v[64:67], v[60:63], v[40:43], v[64:67]
 v_mfma_f32_16x16x32_bf16 v[64:67], v[60:63], v[44:47], v[64:67]
 v_mfma_f32_16x16x32_bf16 v[56:59], v[60:63], v[76:79], v[56:59]
 v_mfma_f32_16x16x32_bf16 v[56:59], v[60:63], v[80:83], v[56:59]
 v_mfma_f32_16x16x32_bf16 v[64:67], v[60:63], v[84:87], v[64:67]
 v_mfma_f32_16x16x32_bf16 v[64:67], v[60:63], v[88:91], v[64:67]
 s_nop 11
 s_mov_b64 exec, 0xffff
 ds_write_b32 v18, v56 offset:1024
 ds_write_b32 v18, v57 offset:1280
 s_mov_b64 exec, -1
 s_mov_b64 exec, 0xffff
 ds_write_b32 v18, v64 offset:1536
 ds_write_b32 v18, v65 offset:1792
 s_mov_b64 exec, -1
 s_lshl_b32 s81, s38, 2
 s_add_u32 s81, s81, 147488
 v_mov_b32 v28, s81
 v_mov_b32 v26, 1
 ds_write_b32 v28, v26
 s_cmp_eq_u32 s38, 0
 s_cbranch_scc0 L0_6
 v_mov_b32 v28, 147492
 s_mov_b32 s39, 1048576
LS_7:
 ds_read_b32 v27, v28 offset:0
 s_waitcnt lgkmcnt(0)
 v_cmp_gt_u32 vcc, 1, v27
 s_nop 0
 s_cbranch_vccz LD_8
 s_sub_u32 s39, s39, 1
 s_cbranch_scc0 LS_7
LD_8:
 v_lshlrev_b32 v2, 4, v0
 v_add_u32 v2, 160768, v2
 v_lshlrev_b32 v3, 3, v0
 v_add_u32 v3, 155904, v3
 s_mov_b32 exec_hi, 0
 ds_read_b128 v[112:115], v2 offset:1024
 ds_read_b128 v[116:119], v2 offset:1536
 s_waitcnt lgkmcnt(0)
 v_add_f32 v112, v112, v113
 v_add_f32 v114, v114, v115
 v_add_f32 v112, v112, v114
 v_cvt_pk_bf16_f32 v113, v112, v112
 v_and_b32 v113, 0xffff0000, v113
 v_sub_f32 v112, v112, v113
 v_cvt_pk_bf16_f32 v114, v112, v112
 v_and_b32 v114, 0xffff0000, v114
 v_sub_f32 v112, v112, v114
 v_cvt_pk_bf16_f32 v115, v112, 0
 v_cvt_pk_bf16_f32 v114, v113, v114
 ds_write_b64 v3, v[114:115] offset:1024
 v_add_f32 v116, v116, v117
 v_add_f32 v118, v118, v119
 v_add_f32 v116, v116, v118
 v_cvt_pk_bf16_f32 v117, v116, v116
 v_and_b32 v117, 0xffff0000, v117
 v_sub_f32 v116, v116, v117
 v_cvt_pk_bf16_f32 v118, v116, v116
 v_and_b32 v118, 0xffff0000, v118
 v_sub_f32 v116, v116, v118
 v_cvt_pk_bf16_f32 v119, v116, 0
 v_cvt_pk_bf16_f32 v118, v117, v118
 ds_write_b64 v3, v[118:119] offset:1536
 s_mov_b64 exec, -1
 v_mov_b32 v26, 1
 s_mov_b64 exec, 0xf
 ds_write_b32 v22, v26 offset:32
 s_mov_b64 exec, -1
 v_mov_b32 v26, 1
 s_mov_b64 exec, 0xf
 ds_write_b32 v22, v26 offset:36
 s_mov_b64 exec, -1
L0_6:
 s_mov_b32 s39, 1048576
LS_9:
 ds_read_b32 v27, v24 offset:0
 s_waitcnt lgkmcnt(0)
 v_cmp_gt_u32 vcc, 3, v27
 s_nop 0
 s_cbranch_vccz LD_10
 s_sub_u32 s39, s39, 1
 s_cbranch_scc0 LS_9
LD_10:
 s_add_u32 s96, s95, 0
 s_and_b32 s96, s96, 7
 s_mul_i32 s97, s96, 176128
 s_add_u32 s3, s79, s97
 s_add_u32 m0, s74, 106496
 s_add_u32 s78, s3, 128
 buffer_load_dwordx4 v11, s[48:51], s78 offen lds
 s_add_u32 m0, s74, 107520
 s_add_u32 s78, s3, 44160
 buffer_load_dwordx4 v11, s[48:51], s78 offen lds
 s_add_u32 s96, s95, 1
 s_and_b32 s96, s96, 7
 s_mul_i32 s97, s96, 176128
 s_add_u32 s3, s79, s97
 s_add_u32 m0, s74, 110592
 s_add_u32 s78, s3, 128
 buffer_load_dwordx4 v11, s[48:51], s78 offen lds
 s_add_u32 m0, s74, 111616
 s_add_u32 s78, s3, 44160
 buffer_load_dwordx4 v11, s[48:51], s78 offen lds
 s_add_u32 s96, s95, 2
 s_and_b32 s96, s96, 7
 s_mul_i32 s97, s96, 176128
 s_add_u32 s3, s79, s97
 s_add_u32 m0, s74, 114688
 s_add_u32 s78, s3, 128
 buffer_load_dwordx4 v11, s[48:51], s78 offen lds
 s_add_u32 m0, s74, 115712
 s_add_u32 s78, s3, 44160
 buffer_load_dwordx4 v11, s[48:51], s78 offen lds
 s_add_u32 s96, s95, 3
 s_and_b32 s96, s96, 7
 s_mul_i32 s97, s96, 176128
 s_add_u32 s3, s79, s97
 s_add_u32 m0, s74, 118784
 s_add_u32 s78, s3, 128
 buffer_load_dwordx4 v11, s[48:51], s78 offen lds
 s_add_u32 m0, s74, 119808
 s_add_u32 s78, s3, 44160
 buffer_load_dwordx4 v11, s[48:51], s78 offen lds
 s_waitcnt vmcnt(8)
 v_mov_b32 v26, 6
 s_mov_b64 exec, 0xf
 ds_write_b32 v22, v26 offset:0
 s_mov_b64 exec, -1
 ds_read_b64_tr_b16 v[32:33], v25 offset:0
 ds_read_b64_tr_b16 v[34:35], v25 offset:256
 ds_read_b64_tr_b16 v[36:37], v25 offset:1024
 ds_read_b64_tr_b16 v[38:39], v25 offset:1280
 ds_read_b64_tr_b16 v[40:41], v25 offset:4096
 ds_read_b64_tr_b16 v[42:43], v25 offset:4352
 ds_read_b64_tr_b16 v[44:45], v25 offset:5120
 ds_read_b64_tr_b16 v[46:47], v25 offset:5376
 ds_read_b64_tr_b16 v[76:77], v25 offset:8192
 ds_read_b64_tr_b16 v[78:79], v25 offset:8448
 ds_read_b64_tr_b16 v[80:81], v25 offset:9216
 ds_read_b64_tr_b16 v[82:83], v25 offset:9472
 ds_read_b64_tr_b16 v[84:85], v25 offset:12288
 ds_read_b64_tr_b16 v[86:87], v25 offset:12544
 ds_read_b64_tr_b16 v[88:89], v25 offset:13312
 ds_read_b64_tr_b16 v[90:91], v25 offset:13568
 s_waitcnt lgkmcnt(0)
 v_mfma_f32_16x16x32_bf16 v[56:59], v[60:63], v[32:35], 0
 v_mfma_f32_16x16x32_bf16 v[56:59], v[60:63], v[36:39], v[56:59]
 v_mfma_f32_16x16x32_bf16 v[64:67], v[60:63], v[40:43], 0
 v_mfma_f32_16x16x32_bf16 v[64:67], v[60:63], v[44:47], v[64:67]
 v_mfma_f32_16x16x32_bf16 v[56:59], v[60:63], v[76:79], v[56:59]
 v_mfma_f32_16x16x32_bf16 v[56:59], v[60:63], v[80:83], v[56:59]
 v_mfma_f32_16x16x32_bf16 v[64:67], v[60:63], v[84:87], v[64:67]
 v_mfma_f32_16x16x32_bf16 v[64:67], v[60:63], v[88:91], v[64:67]
 s_mov_b32 s39, 1048576
LS_11:
 ds_read_b32 v27, v24 offset:0
 s_waitcnt lgkmcnt(0)
 v_cmp_gt_u32 vcc, 4, v27
 s_nop 0
 s_cbranch_vccz LD_12
 s_sub_u32 s39, s39, 1
 s_cbranch_scc0 LS_11
LD_12:
 s_add_u32 s96, s95, 4
 s_and_b32 s96, s96, 7
 s_mul_i32 s97, s96, 176128
 s_add_u32 s3, s79, s97
 s_add_u32 m0, s74, 122880
 s_add_u32 s78, s3, 128
 buffer_load_dwordx4 v11, s[48:51], s78 offen lds
 s_add_u32 m0, s74, 123904
 s_add_u32 s78, s3, 44160
 buffer_load_dwordx4 v11, s[48:51], s78 offen lds
 s_add_u32 s96, s95, 5
 s_and_b32 s96, s96, 7
 s_mul_i32 s97, s96, 176128
 s_add_u32 s3, s79, s97
 s_add_u32 m0, s74, 126976
 s_add_u32 s78, s3, 128
 buffer_load_dwordx4 v11, s[48:51], s78 offen lds
 s_add_u32 m0, s74, 128000
 s_add_u32 s78, s3, 44160
 buffer_load_dwordx4 v11, s[48:51], s78 offen lds
 s_add_u32 s96, s95, 6
 s_and_b32 s96, s96, 7
 s_mul_i32 s97, s96, 176128
 s_add_u32 s3, s79, s97
 s_add_u32 m0, s74, 131072
 s_add_u32 s78, s3, 128
 buffer_load_dwordx4 v11, s[48:51], s78 offen lds
 s_add_u32 m0, s74, 132096
 s_add_u32 s78, s3, 44160
 buffer_load_dwordx4 v11, s[48:51], s78 offen lds
 s_add_u32 s96, s95, 7
 s_and_b32 s96, s96, 7
 s_mul_i32 s97, s96, 176128
 s_add_u32 s3, s79, s97
 s_add_u32 m0, s74, 135168
 s_add_u32 s78, s3, 128
 buffer_load_dwordx4 v11, s[48:51], s78 offen lds
 s_add_u32 m0, s74, 136192
 s_add_u32 s78, s3, 44160
 buffer_load_dwordx4 v11, s[48:51], s78 offen lds
 s_waitcnt vmcnt(8)
 v_mov_b32 v26, 7
 s_mov_b64 exec, 0xf
 ds_write_b32 v22, v26 offset:0
 s_mov_b64 exec, -1
 ds_read_b64_tr_b16 v[32:33], v25 offset:16384
 ds_read_b64_tr_b16 v[34:35], v25 offset:16640
 ds_read_b64_tr_b16 v[36:37], v25 offset:17408
 ds_read_b64_tr_b16 v[38:39], v25 offset:17664
 ds_read_b64_tr_b16 v[40:41], v25 offset:20480
 ds_read_b64_tr_b16 v[42:43], v25 offset:20736
 ds_read_b64_tr_b16 v[44:45], v25 offset:21504
 ds_read_b64_tr_b16 v[46:47], v25 offset:21760
 ds_read_b64_tr_b16 v[76:77], v25 offset:24576
 ds_read_b64_tr_b16 v[78:79], v25 offset:24832
 ds_read_b64_tr_b16 v[80:81], v25 offset:25600
 ds_read_b64_tr_b16 v[82:83], v25 offset:25856
 ds_read_b64_tr_b16 v[84:85], v25 offset:28672
 ds_read_b64_tr_b16 v[86:87], v25 offset:28928
 ds_read_b64_tr_b16 v[88:89], v25 offset:29696
 ds_read_b64_tr_b16 v[90:91], v25 offset:29952
 s_waitcnt lgkmcnt(0)
 v_mfma_f32_16x16x32_bf16 v[56:59], v[60:63], v[32:35], v[56:59]
 v_mfma_f32_16x16x32_bf16 v[56:59], v[60:63], v[36:39], v[56:59]
 v_mfma_f32_16x16x32_bf16 v[64:67], v[60:63], v[40:43], v[64:67]
 v_mfma_f32_16x16x32_bf16 v[64:67], v[60:63], v[44:47], v[64:67]
 v_mfma_f32_16x16x32_bf16 v[56:59], v[60:63], v[76:79], v[56:59]
 v_mfma_f32_16x16x32_bf16 v[56:59], v[60:63], v[80:83], v[56:59]
 v_mfma_f32_16x16x32_bf16 v[64:67], v[60:63], v[84:87], v[64:67]
 v_mfma_f32_16x16x32_bf16 v[64:67], v[60:63], v[88:91], v[64:67]
 s_nop 11
 v_add_f32 v56, v56, v64
 v_add_f32 v57, v57, v65
 s_mov_b64 exec, 0xffff
 ds_write_b32 v18, v56 offset:2560
 ds_write_b32 v18, v57 offset:2816
 s_mov_b64 exec, -1
 s_lshl_b32 s81, s38, 2
 s_add_u32 s81, s81, 147488
 v_mov_b32 v28, s81
 v_mov_b32 v26, 2
 ds_write_b32 v28, v26
 s_cmp_eq_u32 s38, 0
 s_cbranch_scc0 L0_13
 v_mov_b32 v28, 147492
 s_mov_b32 s39, 1048576
LS_14:
 ds_read_b32 v27, v28 offset:0
 s_waitcnt lgkmcnt(0)
 v_cmp_gt_u32 vcc, 2, v27
 s_nop 0
 s_cbranch_vccz LD_15
 s_sub_u32 s39, s39, 1
 s_cbranch_scc0 LS_14
LD_15:
 v_lshlrev_b32 v2, 4, v0
 v_add_u32 v2, 160768, v2
 v_lshlrev_b32 v3, 3, v0
 v_add_u32 v3, 155904, v3
 s_mov_b32 exec_hi, 0
 ds_read_b128 v[112:115], v2 offset:2560
 s_waitcnt lgkmcnt(0)
 v_add_f32 v112, v112, v113
 v_add_f32 v114, v114, v115
 v_add_f32 v112, v112, v114
 v_cvt_pk_bf16_f32 v113, v112, v112
 v_and_b32 v113, 0xffff0000, v113
 v_sub_f32 v112, v112, v113
 v_cvt_pk_bf16_f32 v114, v112, v112
 v_and_b32 v114, 0xffff0000, v114
 v_sub_f32 v112, v112, v114
 v_cvt_pk_bf16_f32 v115, v112, 0
 v_cvt_pk_bf16_f32 v114, v113, v114
 ds_write_b64 v3, v[114:115] offset:2560
 s_mov_b64 exec, -1
 v_mov_b32 v26, 2
 s_mov_b64 exec, 0xf
 ds_write_b32 v22, v26 offset:32
 s_mov_b64 exec, -1
 v_mov_b32 v26, 2
 s_mov_b64 exec, 0xf
 ds_write_b32 v22, v26 offset:36
 s_mov_b64 exec, -1
L0_13:
 s_waitcnt vmcnt(0)
 v_mov_b32 v26, 8
 s_mov_b64 exec, 0xf
 ds_write_b32 v22, v26 offset:0
 s_mov_b64 exec, -1
 ds_read_b64_tr_b16 v[32:33], v25 offset:32768
 ds_read_b64_tr_b16 v[34:35], v25 offset:33024
 ds_read_b64_tr_b16 v[36:37], v25 offset:33792
 ds_read_b64_tr_b16 v[38:39], v25 offset:34048
 ds_read_b64_tr_b16 v[40:41], v25 offset:36864
 ds_read_b64_tr_b16 v[42:43], v25 offset:37120
 ds_read_b64_tr_b16 v[44:45], v25 offset:37888
 ds_read_b64_tr_b16 v[46:47], v25 offset:38144
 ds_read_b64_tr_b16 v[76:77], v25 offset:40960
 ds_read_b64_tr_b16 v[78:79], v25 offset:41216
 ds_read_b64_tr_b16 v[80:81], v25 offset:41984
 ds_read_b64_tr_b16 v[82:83], v25 offset:42240
 ds_read_b64_tr_b16 v[84:85], v25 offset:45056
 ds_read_b64_tr_b16 v[86:87], v25 offset:45312
 ds_read_b64_tr_b16 v[88:89], v25 offset:46080
 ds_read_b64_tr_b16 v[90:91], v25 offset:46336
 s_waitcnt lgkmcnt(0)
 v_mfma_f32_16x16x32_bf16 v[56:59], v[60:63], v[32:35], 0
 v_mfma_f32_16x16x32_bf16 v[56:59], v[60:63], v[36:39], v[56:59]
 v_mfma_f32_16x16x32_bf16 v[64:67], v[60:63], v[40:43], 0
 v_mfma_f32_16x16x32_bf16 v[64:67], v[60:63], v[44:47], v[64:67]
 v_mfma_f32_16x16x32_bf16 v[56:59], v[60:63], v[76:79], v[56:59]
 v_mfma_f32_16x16x32_bf16 v[56:59], v[60:63], v[80:83], v[56:59]
 v_mfma_f32_16x16x32_bf16 v[64:67], v[60:63], v[84:87], v[64:67]
 v_mfma_f32_16x16x32_bf16 v[64:67], v[60:63], v[88:91], v[64:67]
 v_and_b32 v3, 1, v0
 v_lshlrev_b32 v3, 3, v3
 s_lshl_b32 s81, s38, 4
 s_add_u32 s81, s81, 147680
 v_add_u32 v28, s81, v3
 s_mov_b32 s39, 1048576
LS_16:
 s_sleep 1
 ds_read_b32 v27, v28 offset:0
 s_waitcnt lgkmcnt(0)
 v_cmp_gt_u32 vcc, 4, v27
 s_nop 0
 s_cbranch_vccz LD_17
 s_sub_u32 s39, s39, 1
 s_cbranch_scc0 LS_16
LD_17:
 s_lshl_b32 s81, s38, 12
 s_add_u32 s81, s81, 57344
 v_add_u32 v28, s81, v7
 ds_read_b128 v[96:99], v28 offset:0
 ds_read_b128 v[100:103], v28 offset:1024
 ds_read_b128 v[104:107], v28 offset:2048
 ds_read_b128 v[108:111], v28 offset:3072
 s_lshl_b32 s81, s27, 2
 s_lshl_b32 s82, s38, 1
 s_add_u32 s81, s81, s82
 s_mul_i32 s81, s81, 118
 s_lshl_b32 s82, s33, 1
 s_add_u32 s81, s81, s82
 s_add_u32 s81, s81, 2
 s_lshl_b32 s81, s81, 10
 s_add_u32 s81, s81, 8388608
 s_waitcnt lgkmcnt(0)
 s_add_u32 s82, s81, 0
 buffer_store_dwordx4 v[96:99], v7, s[64:67], s82 offen offset:0 sc1
 buffer_store_dwordx4 v[100:103], v7, s[64:67], s82 offen offset:1024 sc1
 s_add_u32 s82, s81, 120832
 buffer_store_dwordx4 v[104:107], v7, s[64:67], s82 offen offset:0 sc1
 buffer_store_dwordx4 v[108:111], v7, s[64:67], s82 offen offset:1024 sc1
 ds_read_b64_tr_b16 v[32:33], v25 offset:49152
 ds_read_b64_tr_b16 v[34:35], v25 offset:49408
 ds_read_b64_tr_b16 v[36:37], v25 offset:50176
 ds_read_b64_tr_b16 v[38:39], v25 offset:50432
 ds_read_b64_tr_b16 v[40:41], v25 offset:53248
 ds_read_b64_tr_b16 v[42:43], v25 offset:53504
 ds_read_b64_tr_b16 v[44:45], v25 offset:54272
 ds_read_b64_tr_b16 v[46:47], v25 offset:54528
 ds_read_b64_tr_b16 v[76:77], v25 offset:57344
 ds_read_b64_tr_b16 v[78:79], v25 offset:57600
 ds_read_b64_tr_b16 v[80:81], v25 offset:58368
 ds_read_b64_tr_b16 v[82:83], v25 offset:58624
 ds_read_b64_tr_b16 v[84:85], v25 offset:61440
 ds_read_b64_tr_b16 v[86:87], v25 offset:61696
 ds_read_b64_tr_b16 v[88:89], v25 offset:62464
 ds_read_b64_tr_b16 v[90:91], v25 offset:62720
 s_waitcnt lgkmcnt(0)
 v_mfma_f32_16x16x32_bf16 v[56:59], v[60:63], v[32:35], v[56:59]
 v_mfma_f32_16x16x32_bf16 v[56:59], v[60:63], v[36:39], v[56:59]
 v_mfma_f32_16x16x32_bf16 v[64:67], v[60:63], v[40:43], v[64:67]
 v_mfma_f32_16x16x32_bf16 v[64:67], v[60:63], v[44:47], v[64:67]
 v_mfma_f32_16x16x32_bf16 v[56:59], v[60:63], v[76:79], v[56:59]
 v_mfma_f32_16x16x32_bf16 v[56:59], v[60:63], v[80:83], v[56:59]
 v_mfma_f32_16x16x32_bf16 v[64:67], v[60:63], v[84:87], v[64:67]
 v_mfma_f32_16x16x32_bf16 v[64:67], v[60:63], v[88:91], v[64:67]
 s_nop 11
 v_add_f32 v56, v56, v64
 v_add_f32 v57, v57, v65
 s_mov_b64 exec, 0xffff
 ds_write_b32 v18, v56 offset:2048
 ds_write_b32 v18, v57 offset:2304
 s_mov_b64 exec, -1
 s_lshl_b32 s81, s38, 2
 s_add_u32 s81, s81, 147488
 v_mov_b32 v28, s81
 v_mov_b32 v26, 3
 ds_write_b32 v28, v26
 s_cmp_eq_u32 s38, 0
 s_cbranch_scc0 L0_18
 v_mov_b32 v28, 147492
 s_mov_b32 s39, 1048576
LS_19:
 ds_read_b32 v27, v28 offset:0
 s_waitcnt lgkmcnt(0)
 v_cmp_gt_u32 vcc, 3, v27
 s_nop 0
 s_cbranch_vccz LD_20
 s_sub_u32 s39, s39, 1
 s_cbranch_scc0 LS_19
LD_20:
 v_lshlrev_b32 v2, 4, v0
 v_add_u32 v2, 160768, v2
 v_lshlrev_b32 v3, 3, v0
 v_add_u32 v3, 155904, v3
 s_mov_b32 exec_hi, 0
 ds_read_b128 v[112:115], v2 offset:2048
 s_waitcnt lgkmcnt(0)
 v_add_f32 v112, v112, v113
 v_add_f32 v114, v114, v115
 v_add_f32 v112, v112, v114
 v_cvt_pk_bf16_f32 v113, v112, v112
 v_and_b32 v113, 0xffff0000, v113
 v_sub_f32 v112, v112, v113
 v_cvt_pk_bf16_f32 v114, v112, v112
 v_and_b32 v114, 0xffff0000, v114
 v_sub_f32 v112, v112, v114
 v_cvt_pk_bf16_f32 v115, v112, 0
 v_cvt_pk_bf16_f32 v114, v113, v114
 ds_write_b64 v3, v[114:115] offset:2048
 s_mov_b64 exec, -1
 v_mov_b32 v26, 3
 s_mov_b64 exec, 0xf
 ds_write_b32 v22, v26 offset:32
 s_mov_b64 exec, -1
 v_mov_b32 v26, 3
 s_mov_b64 exec, 0xf
 ds_write_b32 v22, v26 offset:36
 s_mov_b64 exec, -1
L0_18:
 s_waitcnt vmcnt(0) lgkmcnt(0)
 s_lshl_b32 s81, s38, 2
 s_add_u32 s81, s81, 147480
 v_mov_b32 v28, s81
 v_mov_b32 v26, 1
 ds_write_b32 v28, v26
 s_cmp_eq_u32 s38, 0
 s_cbranch_scc0 L0_21
 v_mov_b32 v28, 147484
 s_mov_b32 s39, 1048576
LS_22:
 ds_read_b32 v27, v28 offset:0
 s_waitcnt lgkmcnt(0)
 v_cmp_gt_u32 vcc, 1, v27
 s_nop 0
 s_cbranch_vccz LD_23
 s_sub_u32 s39, s39, 1
 s_cbranch_scc0 LS_22
LD_23:
 s_lshl_b32 s81, s27, 11
 s_lshl_b32 s82, s28, 2
 s_add_u32 s81, s81, s82
 s_add_u32 s81, s81, 98304
 v_lshlrev_b32 v16, 7, v0
 v_add_u32 v16, s81, v16
 v_mov_b32 v17, s31
 s_mov_b64 exec, 0xffff
 buffer_store_dword v17, v16, s[64:67], 0 offen sc1
 s_mov_b64 exec, -1
L0_21:
 s_branch L_ATT
L_HPUB:
 s_sub_u32 s73, s38, 2
 s_waitcnt lgkmcnt(0)
 s_setprio 2
 v_mov_b32 v3, 0
 buffer_load_dword v28, v3, s[64:67], 0 offen sc1
 s_load_dwordx2 s[52:53], s[0:1], 40
 s_load_dwordx2 s[56:57], s[0:1], 16
 s_mov_b32 s54, 1409024
 s_mov_b32 s55, 0x20000
 s_mov_b32 s58, 524288
 s_mov_b32 s59, 0x20000
 s_load_dwordx2 s[68:69], s[0:1], 56
 s_lshl_b32 s71, s38, 10
 s_lshl_b32 s72, s38, 12
 v_lshlrev_b32 v15, 7, v0
 v_lshlrev_b32 v7, 4, v0
 v_lshrrev_b32 v3, 5, v0
 v_lshlrev_b32 v3, 3, v3
 v_bfe_u32 v4, v0, 2, 2
 v_add_u32 v3, v3, v4
 v_lshlrev_b32 v3, 6, v3
 v_bfe_u32 v4, v0, 4, 1
 v_lshl_add_u32 v3, v4, 5, v3
 v_and_b32 v4, 3, v0
 v_lshl_add_u32 v3, v4, 3, v3
 s_add_u32 s81, s71, 16384
 v_add_u32 v12, s81, v3
 v_add_u32 v13, 73728, v12
 s_add_u32 s81, s71, 73728
 v_add_u32 v14, s81, v3
 v_and_b32 v3, 31, v0
 v_lshrrev_b32 v4, 5, v0
 v_lshlrev_b32 v4, 2, v4
 v_sub_u32 v3, v3, v4
 v_mov_b32 v5, 0xf149f2ca
 s_lshl_b32 s81, s27, 2
 s_add_u32 s81, s81, s38
 s_sub_i32 s84, 8, s81
 s_max_i32 s84, s84, 0
 v_subrev_u32 v6, 0, v3
 v_ashrrev_i32 v6, 31, v6
 v_and_b32 v128, v6, v5
 v_bfi_b32 v144, v6, 0, v5
 v_subrev_u32 v6, 1, v3
 v_ashrrev_i32 v6, 31, v6
 v_and_b32 v129, v6, v5
 v_bfi_b32 v145, v6, 0, v5
 v_subrev_u32 v6, 2, v3
 v_ashrrev_i32 v6, 31, v6
 v_and_b32 v130, v6, v5
 v_bfi_b32 v146, v6, 0, v5
 v_subrev_u32 v6, 3, v3
 v_ashrrev_i32 v6, 31, v6
 v_and_b32 v131, v6, v5
 v_bfi_b32 v147, v6, 0, v5
 v_subrev_u32 v6, 8, v3
 v_ashrrev_i32 v6, 31, v6
 v_and_b32 v132, v6, v5
 v_bfi_b32 v148, v6, 0, v5
 v_subrev_u32 v6, 9, v3
 v_ashrrev_i32 v6, 31, v6
 v_and_b32 v133, v6, v5
 v_bfi_b32 v149, v6, 0, v5
 v_subrev_u32 v6, 10, v3
 v_ashrrev_i32 v6, 31, v6
 v_and_b32 v134, v6, v5
 v_bfi_b32 v150, v6, 0, v5
 v_subrev_u32 v6, 11, v3
 v_ashrrev_i32 v6, 31, v6
 v_and_b32 v135, v6, v5
 v_bfi_b32 v151, v6, 0, v5
 v_subrev_u32 v6, 16, v3
 v_ashrrev_i32 v6, 31, v6
 v_and_b32 v136, v6, v5
 v_bfi_b32 v152, v6, 0, v5
 v_subrev_u32 v6, 17, v3
 v_ashrrev_i32 v6, 31, v6
 v_and_b32 v137, v6, v5
 v_bfi_b32 v153, v6, 0, v5
 v_subrev_u32 v6, 18, v3
 v_ashrrev_i32 v6, 31, v6
 v_and_b32 v138, v6, v5
 v_bfi_b32 v154, v6, 0, v5
 v_subrev_u32 v6, 19, v3
 v_ashrrev_i32 v6, 31, v6
 v_and_b32 v139, v6, v5
 v_bfi_b32 v155, v6, 0, v5
 v_subrev_u32 v6, 24, v3
 v_ashrrev_i32 v6, 31, v6
 v_and_b32 v140, v6, v5
 v_bfi_b32 v156, v6, 0, v5
 v_subrev_u32 v6, 25, v3
 v_ashrrev_i32 v6, 31, v6
 v_and_b32 v141, v6, v5
 v_bfi_b32 v157, v6, 0, v5
 v_subrev_u32 v6, 26, v3
 v_ashrrev_i32 v6, 31, v6
 v_and_b32 v142, v6, v5
 v_bfi_b32 v158, v6, 0, v5
 v_subrev_u32 v6, 27, v3
 v_ashrrev_i32 v6, 31, v6
 v_and_b32 v143, v6, v5
 v_bfi_b32 v159, v6, 0, v5
 s_cmp_eq_u32 s84, 0
 s_cbranch_scc1 BOK_24
 v_mov_b32 v144, v5
 v_mov_b32 v145, v5
 v_mov_b32 v146, v5
 v_mov_b32 v147, v5
 v_mov_b32 v148, v5
 v_mov_b32 v149, v5
 v_mov_b32 v150, v5
 v_mov_b32 v151, v5
 v_mov_b32 v152, v5
 v_mov_b32 v153, v5
 v_mov_b32 v154, v5
 v_mov_b32 v155, v5
 v_mov_b32 v156, v5
 v_mov_b32 v157, v5
 v_mov_b32 v158, v5
 v_mov_b32 v159, v5
BOK_24:
 v_and_b32 v3, 15, v0
 v_bfe_u32 v4, v0, 4, 1
 v_cmp_eq_u32 vcc, v3, v4
 v_mov_b32 v6, 0x3f803f80
 s_nop 0
 v_cndmask_b32 v60, 0, v6, vcc
 v_mov_b32 v61, v60
 v_mov_b32 v62, v60
 v_mov_b32 v63, v60
 v_and_b32 v2, 31, v0
 v_lshrrev_b32 v3, 3, v2
 v_lshlrev_b32 v3, 10, v3
 v_and_b32 v4, 7, v2
 v_lshl_add_u32 v3, v4, 7, v3
 v_bfe_u32 v4, v0, 1, 3
 v_lshrrev_b32 v6, 5, v0
 v_xor_b32 v4, v4, v6
 v_lshl_add_u32 v3, v4, 4, v3
 v_add_u32 v92, s72, v3
 v_xor_b32 v93, 32, v92
 v_xor_b32 v94, 64, v92
 v_xor_b32 v95, 96, v92
 v_lshlrev_b32 v3, 4, v0
 s_lshl_b32 s81, s38, 2
 s_add_u32 s81, s81, 160768
 v_add_u32 v18, s81, v3
 v_lshlrev_b32 v3, 4, v0
 v_add_u32 v3, 147456, v3
 v_mov_b32 v20, 0
 v_mov_b32 v21, 0
 v_mov_b32 v22, 0
 v_mov_b32 v23, 0
 s_mov_b64 exec, 0xffff
 ds_write_b128 v3, v[20:23]
 s_mov_b64 exec, -1
 s_mov_b64 exec, 0xffff
 ds_write_b32 v18, v20 offset:1024
 ds_write_b32 v18, v21 offset:1280
 s_mov_b64 exec, -1
 s_mov_b64 exec, 0xffff
 ds_write_b32 v18, v20 offset:1536
 ds_write_b32 v18, v21 offset:1792
 s_mov_b64 exec, -1
 s_mov_b64 exec, 0xffff
 ds_write_b32 v18, v20 offset:2048
 ds_write_b32 v18, v21 offset:2304
 s_mov_b64 exec, -1
 s_mov_b64 exec, 0xffff
 ds_write_b32 v18, v20 offset:2560
 ds_write_b32 v18, v21 offset:2816
 s_mov_b64 exec, -1
 v_lshlrev_b32 v3, 3, v0
 v_add_u32 v3, 155904, v3
 s_mov_b32 exec_lo, 0
 ds_write_b64 v3, v[20:21] offset:0
 ds_write_b64 v3, v[20:21] offset:512
 ds_write_b64 v3, v[20:21] offset:1024
 ds_write_b64 v3, v[20:21] offset:1536
 ds_write_b64 v3, v[20:21] offset:2048
 ds_write_b64 v3, v[20:21] offset:2560
 s_mov_b64 exec, -1
 s_sub_u32 s82, 2, s73
 s_sub_i32 s83, s27, s82
 s_cmp_ge_i32 s83, 0
 s_cselect_b32 s85, 1, 0
 s_xor_b32 s87, s85, 1
 s_mov_b32 s94, s87
 s_mul_i32 s86, s73, 16384
 s_max_i32 s83, s83, 0
 s_lshl_b32 s81, s83, 4
 s_add_u32 s81, s81, s28
 s_lshl_b32 s81, s81, 7
 s_add_u32 s89, s81, 32768
 s_add_u32 s99, s81, 196608
 s_lshl_b32 s81, s27, 2
 s_lshl_b32 s82, s73, 2
 s_add_u32 s81, s81, s82
 s_sub_u32 s81, s81, 8
 s_lshl_b32 s81, s81, 4
 s_add_u32 s81, s81, s28
 s_mul_i32 s81, s81, 4096
 s_add_u32 s88, s81, 1048576
 s_lshl_b32 s81, s27, 2
 s_lshl_b32 s82, s73, 1
 s_add_u32 s81, s81, s82
 s_lshl_b32 s100, s81, 4
 s_add_u32 s100, s100, s28
 s_mul_i32 s100, s100, 4096
 s_add_u32 s100, s100, 1048576
 s_mul_i32 s101, s81, 118
 s_lshl_b32 s82, s33, 1
 s_add_u32 s101, s101, s82
 s_lshl_b32 s101, s101, 10
 s_add_u32 s101, s101, 8388608
 s_lshl_b32 s81, s73, 1
 s_add_u32 s81, s81, 8
 s_mul_i32 s81, s81, 4096
 v_add_u32 v19, s81, v7
 s_lshl_b32 s81, s73, 12
 v_add_u32 v20, s81, v7
 s_waitcnt lgkmcnt(0)
 s_waitcnt vmcnt(0)
 v_readfirstlane_b32 s31, v28
 s_nop 1
 s_add_u32 s31, s31, 2654435769
 s_mov_b32 s24, s31
 s_mov_b32 s25, s31
 s_waitcnt lgkmcnt(0)
 s_barrier
 ds_read_b128 v[76:79], v92 offset:0
 ds_read_b128 v[80:83], v93 offset:0
 ds_read_b128 v[84:87], v94 offset:0
 ds_read_b128 v[88:91], v95 offset:0
 ds_read_b64_tr_b16 v[32:33], v12 offset:0
 ds_read_b64_tr_b16 v[34:35], v12 offset:256
 ds_read_b64_tr_b16 v[36:37], v12 offset:4096
 ds_read_b64_tr_b16 v[38:39], v12 offset:4352
 v_mul_u32_u24 v22, 0x2493, v0
 v_lshrrev_b32 v22, 16, v22
 v_mul_u32_u24 v23, 7, v22
 v_sub_u32 v23, v0, v23
 v_mul_u32_u24 v22, 2752, v22
 v_lshl_add_u32 v22, v23, 7, v22
 s_lshr_b32 s81, s29, 1
 s_lshl_b32 s81, s81, 2
 s_mul_i32 s82, s81, 3
 s_lshl_b32 s83, s81, 1
 s_add_u32 s83, s83, 11
 s_min_u32 s82, s82, s83
 s_lshl_b32 s82, s82, 6
 s_and_b32 s82, s82, 0xffffff80
 s_lshl_b32 s83, s30, 4
 s_lshl_b32 s81, s73, 3
 s_add_u32 s83, s83, s81
 s_mul_i32 s83, s83, 2752
 s_add_u32 s82, s82, s83
 s_mov_b32 exec_hi, 0xffffff
 buffer_load_dword v248, v22, s[48:51], s82 offen
 s_mov_b64 exec, -1
 s_cmp_eq_u32 s73, 1
 s_cbranch_scc0 PI_25
 v_lshrrev_b32 v22, 1, v0
 v_mul_u32_u24 v22, 3072, v22
 v_and_b32 v23, 1, v0
 v_lshl_add_u32 v22, v23, 7, v22
 s_lshr_b32 s81, s29, 1
 s_lshl_b32 s81, s81, 8
 s_mul_i32 s82, s30, 49152
 s_add_u32 s82, s82, s81
 s_mov_b32 exec_hi, 0
 buffer_load_dword v249, v22, s[44:47], s82 offen
 s_mov_b64 exec, -1
PI_25:
 s_waitcnt lgkmcnt(7)
 v_mfma_f32_16x16x32_bf16 v[68:71], v[60:63], v[76:79], 0
 s_waitcnt lgkmcnt(6)
 v_mfma_f32_16x16x32_bf16 v[72:75], v[60:63], v[80:83], 0
 s_waitcnt lgkmcnt(5)
 v_mfma_f32_16x16x32_bf16 v[68:71], v[60:63], v[84:87], v[68:71]
 s_waitcnt lgkmcnt(4)
 v_mfma_f32_16x16x32_bf16 v[72:75], v[60:63], v[88:91], v[72:75]
 s_waitcnt lgkmcnt(0)
 v_mfma_f32_16x16x32_bf16 v[56:59], v[60:63], v[32:35], 0
 v_mfma_f32_16x16x32_bf16 v[64:67], v[60:63], v[36:39], 0
 s_waitcnt lgkmcnt(0)
 s_barrier
 ds_read_b128 v[76:79], v92 offset:24576
 ds_read_b128 v[80:83], v93 offset:24576
 ds_read_b128 v[84:87], v94 offset:24576
 ds_read_b128 v[88:91], v95 offset:24576
 ds_read_b64_tr_b16 v[32:33], v12 offset:24576
 ds_read_b64_tr_b16 v[34:35], v12 offset:24832
 ds_read_b64_tr_b16 v[36:37], v12 offset:28672
 ds_read_b64_tr_b16 v[38:39], v12 offset:28928
 s_waitcnt lgkmcnt(7)
 v_mfma_f32_16x16x32_bf16 v[68:71], v[60:63], v[76:79], v[68:71]
 s_waitcnt lgkmcnt(6)
 v_mfma_f32_16x16x32_bf16 v[72:75], v[60:63], v[80:83], v[72:75]
 s_waitcnt lgkmcnt(5)
 v_mfma_f32_16x16x32_bf16 v[68:71], v[60:63], v[84:87], v[68:71]
 s_waitcnt lgkmcnt(4)
 v_mfma_f32_16x16x32_bf16 v[72:75], v[60:63], v[88:91], v[72:75]
 s_waitcnt lgkmcnt(0)
 v_mfma_f32_16x16x32_bf16 v[56:59], v[60:63], v[32:35], v[56:59]
 v_mfma_f32_16x16x32_bf16 v[64:67], v[60:63], v[36:39], v[64:67]
 s_waitcnt lgkmcnt(0)
 s_barrier
 ds_read_b128 v[76:79], v92 offset:49152
 ds_read_b128 v[80:83], v93 offset:49152
 ds_read_b128 v[84:87], v94 offset:49152
 ds_read_b128 v[88:91], v95 offset:49152
 ds_read_b64_tr_b16 v[32:33], v12 offset:49152
 ds_read_b64_tr_b16 v[34:35], v12 offset:49408
 ds_read_b64_tr_b16 v[36:37], v12 offset:53248
 ds_read_b64_tr_b16 v[38:39], v12 offset:53504
 s_waitcnt lgkmcnt(7)
 v_mfma_f32_16x16x32_bf16 v[68:71], v[60:63], v[76:79], v[68:71]
 s_waitcnt lgkmcnt(6)
 v_mfma_f32_16x16x32_bf16 v[72:75], v[60:63], v[80:83], v[72:75]
 s_waitcnt lgkmcnt(5)
 v_mfma_f32_16x16x32_bf16 v[68:71], v[60:63], v[84:87], v[68:71]
 s_waitcnt lgkmcnt(4)
 v_mfma_f32_16x16x32_bf16 v[72:75], v[60:63], v[88:91], v[72:75]
 s_waitcnt lgkmcnt(0)
 v_mfma_f32_16x16x32_bf16 v[56:59], v[60:63], v[32:35], v[56:59]
 v_mfma_f32_16x16x32_bf16 v[64:67], v[60:63], v[36:39], v[64:67]
 s_waitcnt lgkmcnt(0)
 s_barrier
 v_add_u32 v92, 73728, v92
 v_add_u32 v93, 73728, v93
 v_add_u32 v94, 73728, v94
 v_add_u32 v95, 73728, v95
 ds_read_b128 v[76:79], v92 offset:0
 ds_read_b128 v[80:83], v93 offset:0
 ds_read_b128 v[84:87], v94 offset:0
 ds_read_b128 v[88:91], v95 offset:0
 ds_read_b64_tr_b16 v[32:33], v13 offset:0
 ds_read_b64_tr_b16 v[34:35], v13 offset:256
 ds_read_b64_tr_b16 v[36:37], v13 offset:4096
 ds_read_b64_tr_b16 v[38:39], v13 offset:4352
 s_waitcnt lgkmcnt(7)
 v_mfma_f32_16x16x32_bf16 v[68:71], v[60:63], v[76:79], v[68:71]
 s_waitcnt lgkmcnt(6)
 v_mfma_f32_16x16x32_bf16 v[72:75], v[60:63], v[80:83], v[72:75]
 s_waitcnt lgkmcnt(5)
 v_mfma_f32_16x16x32_bf16 v[68:71], v[60:63], v[84:87], v[68:71]
 s_waitcnt lgkmcnt(4)
 v_mfma_f32_16x16x32_bf16 v[72:75], v[60:63], v[88:91], v[72:75]
 s_waitcnt lgkmcnt(0)
 v_mfma_f32_16x16x32_bf16 v[56:59], v[60:63], v[32:35], v[56:59]
 v_mfma_f32_16x16x32_bf16 v[64:67], v[60:63], v[36:39], v[64:67]
 s_waitcnt lgkmcnt(0)
 s_barrier
 ds_read_b128 v[76:79], v92 offset:32768
 ds_read_b128 v[80:83], v93 offset:32768
 ds_read_b128 v[84:87], v94 offset:32768
 ds_read_b128 v[88:91], v95 offset:32768
 ds_read_b64_tr_b16 v[32:33], v13 offset:32768
 ds_read_b64_tr_b16 v[34:35], v13 offset:33024
 ds_read_b64_tr_b16 v[36:37], v13 offset:36864
 ds_read_b64_tr_b16 v[38:39], v13 offset:37120
 s_waitcnt lgkmcnt(7)
 v_mfma_f32_16x16x32_bf16 v[68:71], v[60:63], v[76:79], v[68:71]
 s_waitcnt lgkmcnt(6)
 v_mfma_f32_16x16x32_bf16 v[72:75], v[60:63], v[80:83], v[72:75]
 s_waitcnt lgkmcnt(5)
 v_mfma_f32_16x16x32_bf16 v[68:71], v[60:63], v[84:87], v[68:71]
 s_waitcnt lgkmcnt(4)
 v_mfma_f32_16x16x32_bf16 v[72:75], v[60:63], v[88:91], v[72:75]
 s_waitcnt lgkmcnt(0)
 v_mfma_f32_16x16x32_bf16 v[56:59], v[60:63], v[32:35], v[56:59]
 v_mfma_f32_16x16x32_bf16 v[64:67], v[60:63], v[36:39], v[64:67]
 s_waitcnt lgkmcnt(0)
 s_barrier
 v_subrev_u32 v92, 73728, v92
 v_subrev_u32 v93, 73728, v93
 v_subrev_u32 v94, 73728, v94
 v_subrev_u32 v95, 73728, v95
 ds_read_b128 v[76:79], v92 offset:0
 ds_read_b128 v[80:83], v93 offset:0
 ds_read_b128 v[84:87], v94 offset:0
 ds_read_b128 v[88:91], v95 offset:0
 ds_read_b64_tr_b16 v[32:33], v12 offset:0
 ds_read_b64_tr_b16 v[34:35], v12 offset:256
 ds_read_b64_tr_b16 v[36:37], v12 offset:4096
 ds_read_b64_tr_b16 v[38:39], v12 offset:4352
 s_waitcnt lgkmcnt(7)
 v_mfma_f32_16x16x32_bf16 v[68:71], v[60:63], v[76:79], v[68:71]
 s_waitcnt lgkmcnt(6)
 v_mfma_f32_16x16x32_bf16 v[72:75], v[60:63], v[80:83], v[72:75]
 s_waitcnt lgkmcnt(5)
 v_mfma_f32_16x16x32_bf16 v[68:71], v[60:63], v[84:87], v[68:71]
 s_waitcnt lgkmcnt(4)
 v_mfma_f32_16x16x32_bf16 v[72:75], v[60:63], v[88:91], v[72:75]
 s_waitcnt lgkmcnt(0)
 v_mfma_f32_16x16x32_bf16 v[56:59], v[60:63], v[32:35], v[56:59]
 v_mfma_f32_16x16x32_bf16 v[64:67], v[60:63], v[36:39], v[64:67]
 s_waitcnt lgkmcnt(0)
 s_barrier
 ds_read_b128 v[76:79], v92 offset:24576
 ds_read_b128 v[80:83], v93 offset:24576
 ds_read_b128 v[84:87], v94 offset:24576
 ds_read_b128 v[88:91], v95 offset:24576
 ds_read_b64_tr_b16 v[32:33], v12 offset:24576
 ds_read_b64_tr_b16 v[34:35], v12 offset:24832
 ds_read_b64_tr_b16 v[36:37], v12 offset:28672
 ds_read_b64_tr_b16 v[38:39], v12 offset:28928
 s_cmp_eq_u32 s73, 0
 s_cbranch_scc0 PI_26
 s_mul_i32 s81, s2, 5504
 s_mov_b32 exec_hi, 0x7ff
 buffer_load_dword v246, v15, s[52:55], s81 offen
 s_mov_b64 exec, -1
PI_26:
 s_cmp_eq_u32 s73, 1
 s_cbranch_scc0 PI_27
 s_mul_i32 s81, s2, 2048
 s_mov_b32 exec_hi, 0
 s_mov_b32 exec_lo, 0xffff
 buffer_load_dword v247, v15, s[56:59], s81 offen
 s_mov_b64 exec, -1
PI_27:
 s_waitcnt lgkmcnt(7)
 v_mfma_f32_16x16x32_bf16 v[68:71], v[60:63], v[76:79], v[68:71]
 s_waitcnt lgkmcnt(6)
 v_mfma_f32_16x16x32_bf16 v[72:75], v[60:63], v[80:83], v[72:75]
 s_waitcnt lgkmcnt(5)
 v_mfma_f32_16x16x32_bf16 v[68:71], v[60:63], v[84:87], v[68:71]
 s_waitcnt lgkmcnt(4)
 v_mfma_f32_16x16x32_bf16 v[72:75], v[60:63], v[88:91], v[72:75]
 s_waitcnt lgkmcnt(0)
 v_mfma_f32_16x16x32_bf16 v[56:59], v[60:63], v[32:35], v[56:59]
 v_mfma_f32_16x16x32_bf16 v[64:67], v[60:63], v[36:39], v[64:67]
 s_waitcnt lgkmcnt(0)
 s_barrier
 ds_read_b128 v[76:79], v92 offset:49152
 ds_read_b128 v[80:83], v93 offset:49152
 ds_read_b128 v[84:87], v94 offset:49152
 ds_read_b128 v[88:91], v95 offset:49152
 ds_read_b64_tr_b16 v[32:33], v12 offset:49152
 ds_read_b64_tr_b16 v[34:35], v12 offset:49408
 ds_read_b64_tr_b16 v[36:37], v12 offset:53248
 ds_read_b64_tr_b16 v[38:39], v12 offset:53504
 s_waitcnt lgkmcnt(7)
 v_mfma_f32_16x16x32_bf16 v[68:71], v[60:63], v[76:79], v[68:71]
 s_waitcnt lgkmcnt(6)
 v_mfma_f32_16x16x32_bf16 v[72:75], v[60:63], v[80:83], v[72:75]
 s_waitcnt lgkmcnt(5)
 v_mfma_f32_16x16x32_bf16 v[68:71], v[60:63], v[84:87], v[68:71]
 s_waitcnt lgkmcnt(4)
 v_mfma_f32_16x16x32_bf16 v[72:75], v[60:63], v[88:91], v[72:75]
 s_waitcnt lgkmcnt(0)
 v_mfma_f32_16x16x32_bf16 v[56:59], v[60:63], v[32:35], v[56:59]
 v_mfma_f32_16x16x32_bf16 v[64:67], v[60:63], v[36:39], v[64:67]
 v_lshlrev_b32 v3, 2, v0
 s_lshl_b32 s81, s38, 7
 s_add_u32 s81, s81, 159744
 v_add_u32 v3, s81, v3
 s_nop 9
 v_add_f32 v68, v68, v72
 v_add_f32 v69, v69, v73
 s_mov_b64 exec, 0xffff
 ds_write_b32 v3, v68
 ds_write_b32 v3, v69 offset:64
 s_mov_b64 exec, -1
 s_mov_b64 exec, 0xffff
 ds_write_b32 v18, v56 offset:0
 ds_write_b32 v18, v57 offset:256
 s_mov_b64 exec, -1
 s_mov_b64 exec, 0xffff
 ds_write_b32 v18, v64 offset:512
 ds_write_b32 v18, v65 offset:768
 s_mov_b64 exec, -1
 s_waitcnt lgkmcnt(0)
 s_barrier
 v_and_b32 v3, 1, v0
 v_lshlrev_b32 v3, 3, v3
 s_lshl_b32 s81, s73, 4
 s_add_u32 s81, s81, 147680
 v_add_u32 v22, s81, v3
 s_lshl_b32 s81, s73, 2
 s_add_u32 s81, s81, 147472
 v_mov_b32 v23, s81
 v_mov_b32 v3, 147476
 v_mov_b32 v30, v3
 s_cmp_eq_u32 s73, 0
 s_cbranch_scc0 PI_28
 v_lshlrev_b32 v2, 4, v0
 v_add_u32 v2, 160768, v2
 v_lshlrev_b32 v3, 3, v0
 v_add_u32 v3, 155904, v3
 s_mov_b32 exec_hi, 0
 ds_read_b128 v[112:115], v2 offset:0
 ds_read_b128 v[116:119], v2 offset:512
 s_waitcnt lgkmcnt(0)
 v_add_f32 v112, v112, v113
 v_add_f32 v114, v114, v115
 v_add_f32 v112, v112, v114
 v_cvt_pk_bf16_f32 v113, v112, v112
 v_and_b32 v113, 0xffff0000, v113
 v_sub_f32 v112, v112, v113
 v_cvt_pk_bf16_f32 v114, v112, v112
 v_and_b32 v114, 0xffff0000, v114
 v_sub_f32 v112, v112, v114
 v_cvt_pk_bf16_f32 v115, v112, 0
 v_cvt_pk_bf16_f32 v114, v113, v114
 ds_write_b64 v3, v[114:115] offset:0
 v_add_f32 v116, v116, v117
 v_add_f32 v118, v118, v119
 v_add_f32 v116, v116, v118
 v_cvt_pk_bf16_f32 v117, v116, v116
 v_and_b32 v117, 0xffff0000, v117
 v_sub_f32 v116, v116, v117
 v_cvt_pk_bf16_f32 v118, v116, v116
 v_and_b32 v118, 0xffff0000, v118
 v_sub_f32 v116, v116, v118
 v_cvt_pk_bf16_f32 v119, v116, 0
 v_cvt_pk_bf16_f32 v118, v117, v118
 ds_write_b64 v3, v[118:119] offset:512
 s_mov_b64 exec, -1
 v_mov_b32 v28, 147496
 v_mov_b32 v26, 1
 ds_write_b32 v28, v26
PI_28:
 s_cmp_eq_u32 s85, 1
 s_cbranch_scc1 NOZF_29
 v_add_u32 v8, s86, v7
 v_mov_b32 v24, 0
 v_mov_b32 v25, 0
 v_mov_b32 v26, 0
 v_mov_b32 v27, 0
 ds_write_b128 v8, v[24:27] offset:0
 ds_write_b128 v8, v[24:27] offset:1024
 ds_write_b128 v8, v[24:27] offset:2048
 ds_write_b128 v8, v[24:27] offset:3072
 ds_write_b128 v8, v[24:27] offset:4096
 ds_write_b128 v8, v[24:27] offset:5120
 ds_write_b128 v8, v[24:27] offset:6144
 ds_write_b128 v8, v[24:27] offset:7168
 ds_write_b128 v8, v[24:27] offset:8192
 ds_write_b128 v8, v[24:27] offset:9216
 ds_write_b128 v8, v[24:27] offset:10240
 ds_write_b128 v8, v[24:27] offset:11264
 ds_write_b128 v8, v[24:27] offset:12288
 ds_write_b128 v8, v[24:27] offset:13312
 ds_write_b128 v8, v[24:27] offset:14336
 ds_write_b128 v8, v[24:27] offset:15360
NOZF_29:
 s_waitcnt lgkmcnt(0)
 s_mov_b32 s39, 1048576
LS_30:
 s_sleep 1
 ds_read_b32 v31, v22 offset:0
 s_waitcnt lgkmcnt(0)
 v_cmp_gt_u32 vcc, 1, v31
 s_nop 0
 s_cbranch_vccz LD_31
 s_sub_u32 s39, s39, 1
 s_cbranch_scc0 LS_30
LD_31:
 ds_read_b128 v[96:99], v19 offset:0
 ds_read_b128 v[100:103], v19 offset:1024
 ds_read_b128 v[104:107], v19 offset:4096
 ds_read_b128 v[108:111], v19 offset:5120
 s_waitcnt lgkmcnt(2)
 s_add_u32 s82, s100, 0
 buffer_store_dwordx4 v[96:99], v7, s[64:67], s82 offen offset:0 sc1
 buffer_store_dwordx4 v[100:103], v7, s[64:67], s82 offen offset:1024 sc1
 s_waitcnt lgkmcnt(0)
 s_add_u32 s82, s100, 65536
 buffer_store_dwordx4 v[104:107], v7, s[64:67], s82 offen offset:0 sc1
 buffer_store_dwordx4 v[108:111], v7, s[64:67], s82 offen offset:1024 sc1
 s_cmp_eq_u32 s73, 0
 s_cbranch_scc0 PI_32
 v_add_u32 v29, 16, v22
 s_mov_b32 s39, 1048576
LS_33:
 s_sleep 1
 ds_read_b32 v31, v29 offset:0
 s_waitcnt lgkmcnt(0)
 v_cmp_gt_u32 vcc, 1, v31
 s_nop 0
 s_cbranch_vccz LD_34
 s_sub_u32 s39, s39, 1
 s_cbranch_scc0 LS_33
LD_34:
 s_cmp_eq_u32 s28, 0
 s_cbranch_scc0 NOR_35
 v_lshlrev_b32 v28, 3, v0
 v_add_u32 v29, 160256, v28
 ds_read_b64 v[40:41], v29
 s_waitcnt lgkmcnt(0)
 s_lshl_b32 s82, s27, 9
 s_add_u32 s82, s82, 262144
 buffer_store_dwordx2 v[40:41], v28, s[64:67], s82 offen sc1
NOR_35:
PI_32:
 s_mov_b32 s39, 1048576
LS_36:
 s_sleep 1
 ds_read_b32 v31, v22 offset:0
 s_waitcnt lgkmcnt(0)
 v_cmp_gt_u32 vcc, 2, v31
 s_nop 0
 s_cbranch_vccz LD_37
 s_sub_u32 s39, s39, 1
 s_cbranch_scc0 LS_36
LD_37:
 ds_read_b128 v[96:99], v19 offset:2048
 ds_read_b128 v[100:103], v19 offset:3072
 ds_read_b128 v[104:107], v19 offset:6144
 ds_read_b128 v[108:111], v19 offset:7168
 s_waitcnt lgkmcnt(2)
 s_add_u32 s82, s100, 2048
 buffer_store_dwordx4 v[96:99], v7, s[64:67], s82 offen offset:0 sc1
 buffer_store_dwordx4 v[100:103], v7, s[64:67], s82 offen offset:1024 sc1
 s_waitcnt lgkmcnt(0)
 s_add_u32 s82, s100, 67584
 buffer_store_dwordx4 v[104:107], v7, s[64:67], s82 offen offset:0 sc1
 buffer_store_dwordx4 v[108:111], v7, s[64:67], s82 offen offset:1024 sc1
 s_waitcnt vmcnt(4)
 v_mov_b32 v26, 1
 ds_write_b32 v23, v26
 s_cmp_eq_u32 s73, 0
 s_cbranch_scc0 PI_38
 s_mov_b32 s39, 1048576
LS_39:
 ds_read_b32 v31, v30 offset:0
 s_waitcnt lgkmcnt(0)
 v_cmp_gt_u32 vcc, 1, v31
 s_nop 0
 s_cbranch_vccz LD_40
 s_sub_u32 s39, s39, 1
 s_cbranch_scc0 LS_39
LD_40:
 s_lshl_b32 s81, s27, 4
 s_add_u32 s81, s81, s28
 s_lshl_b32 s81, s81, 7
 s_add_u32 s81, s81, 32768
 v_mov_b32 v16, s81
 v_mov_b32 v17, s31
 s_mov_b64 exec, 1
 buffer_store_dword v17, v16, s[64:67], 0 offen sc1
 s_mov_b64 exec, -1
PI_38:
 s_waitcnt vmcnt(0)
 v_mov_b32 v26, 2
 ds_write_b32 v23, v26
 s_cmp_eq_u32 s73, 0
 s_cbranch_scc0 PI_41
 s_mov_b32 s39, 1048576
LS_42:
 ds_read_b32 v31, v30 offset:0
 s_waitcnt lgkmcnt(0)
 v_cmp_gt_u32 vcc, 2, v31
 s_nop 0
 s_cbranch_vccz LD_43
 s_sub_u32 s39, s39, 1
 s_cbranch_scc0 LS_42
LD_43:
 s_lshl_b32 s81, s27, 4
 s_add_u32 s81, s81, s28
 s_lshl_b32 s81, s81, 7
 s_add_u32 s81, s81, 196608
 v_mov_b32 v16, s81
 v_mov_b32 v17, s31
 s_mov_b64 exec, 1
 buffer_store_dword v17, v16, s[64:67], 0 offen sc1
 s_mov_b64 exec, -1
PI_41:
 s_load_dword s8, s[64:65], s89 glc
 s_load_dword s9, s[64:65], s99 glc
 s_waitcnt lgkmcnt(0)
 s_cmp_eq_u32 s87, 1
 s_cbranch_scc1 RSK_44
 s_cmp_lg_u32 s8, s31
 s_cbranch_scc1 RSK_44
 s_add_u32 m0, s86, 0
 s_add_u32 s82, s88, 0
 buffer_load_dwordx4 v7, s[64:67], s82 offen sc1 lds
 s_add_u32 m0, s86, 1024
 s_add_u32 s82, s88, 1024
 buffer_load_dwordx4 v7, s[64:67], s82 offen sc1 lds
 s_add_u32 m0, s86, 4096
 s_add_u32 s82, s88, 65536
 buffer_load_dwordx4 v7, s[64:67], s82 offen sc1 lds
 s_add_u32 m0, s86, 5120
 s_add_u32 s82, s88, 66560
 buffer_load_dwordx4 v7, s[64:67], s82 offen sc1 lds
 s_add_u32 m0, s86, 8192
 s_add_u32 s82, s88, 131072
 buffer_load_dwordx4 v7, s[64:67], s82 offen sc1 lds
 s_add_u32 m0, s86, 9216
 s_add_u32 s82, s88, 132096
 buffer_load_dwordx4 v7, s[64:67], s82 offen sc1 lds
 s_add_u32 m0, s86, 12288
 s_add_u32 s82, s88, 196608
 buffer_load_dwordx4 v7, s[64:67], s82 offen sc1 lds
 s_add_u32 m0, s86, 13312
 s_add_u32 s82, s88, 197632
 buffer_load_dwordx4 v7, s[64:67], s82 offen sc1 lds
 s_mov_b32 s87, 1
RSK_44:
 s_cmp_eq_u32 s94, 1
 s_cbranch_scc1 RSK_45
 s_cmp_lg_u32 s9, s31
 s_cbranch_scc1 RSK_45
 s_add_u32 m0, s86, 2048
 s_add_u32 s82, s88, 2048
 buffer_load_dwordx4 v7, s[64:67], s82 offen sc1 lds
 s_add_u32 m0, s86, 3072
 s_add_u32 s82, s88, 3072
 buffer_load_dwordx4 v7, s[64:67], s82 offen sc1 lds
 s_add_u32 m0, s86, 6144
 s_add_u32 s82, s88, 67584
 buffer_load_dwordx4 v7, s[64:67], s82 offen sc1 lds
 s_add_u32 m0, s86, 7168
 s_add_u32 s82, s88, 68608
 buffer_load_dwordx4 v7, s[64:67], s82 offen sc1 lds
 s_add_u32 m0, s86, 10240
 s_add_u32 s82, s88, 133120
 buffer_load_dwordx4 v7, s[64:67], s82 offen sc1 lds
 s_add_u32 m0, s86, 11264
 s_add_u32 s82, s88, 134144
 buffer_load_dwordx4 v7, s[64:67], s82 offen sc1 lds
 s_add_u32 m0, s86, 14336
 s_add_u32 s82, s88, 198656
 buffer_load_dwordx4 v7, s[64:67], s82 offen sc1 lds
 s_add_u32 m0, s86, 15360
 s_add_u32 s82, s88, 199680
 buffer_load_dwordx4 v7, s[64:67], s82 offen sc1 lds
 s_mov_b32 s94, 1
RSK_45:
 s_load_dword s8, s[64:65], s89 glc
 s_load_dword s9, s[64:65], s99 glc
 s_mov_b32 s39, 1048576
LS_46:
 s_sleep 1
 ds_read_b32 v31, v22 offset:0
 s_waitcnt lgkmcnt(0)
 v_cmp_gt_u32 vcc, 3, v31
 s_nop 0
 s_cbranch_vccz LD_47
 s_sub_u32 s39, s39, 1
 s_cbranch_scc0 LS_46
LD_47:
 s_cmp_eq_u32 s87, 1
 s_cbranch_scc1 RSK_48
 s_cmp_lg_u32 s8, s31
 s_cbranch_scc1 RSK_48
 s_add_u32 m0, s86, 0
 s_add_u32 s82, s88, 0
 buffer_load_dwordx4 v7, s[64:67], s82 offen sc1 lds
 s_add_u32 m0, s86, 1024
 s_add_u32 s82, s88, 1024
 buffer_load_dwordx4 v7, s[64:67], s82 offen sc1 lds
 s_add_u32 m0, s86, 4096
 s_add_u32 s82, s88, 65536
 buffer_load_dwordx4 v7, s[64:67], s82 offen sc1 lds
 s_add_u32 m0, s86, 5120
 s_add_u32 s82, s88, 66560
 buffer_load_dwordx4 v7, s[64:67], s82 offen sc1 lds
 s_add_u32 m0, s86, 8192
 s_add_u32 s82, s88, 131072
 buffer_load_dwordx4 v7, s[64:67], s82 offen sc1 lds
 s_add_u32 m0, s86, 9216
 s_add_u32 s82, s88, 132096
 buffer_load_dwordx4 v7, s[64:67], s82 offen sc1 lds
 s_add_u32 m0, s86, 12288
 s_add_u32 s82, s88, 196608
 buffer_load_dwordx4 v7, s[64:67], s82 offen sc1 lds
 s_add_u32 m0, s86, 13312
 s_add_u32 s82, s88, 197632
 buffer_load_dwordx4 v7, s[64:67], s82 offen sc1 lds
 s_mov_b32 s87, 1
RSK_48:
 s_cmp_eq_u32 s94, 1
 s_cbranch_scc1 RSK_49
 s_cmp_lg_u32 s9, s31
 s_cbranch_scc1 RSK_49
 s_add_u32 m0, s86, 2048
 s_add_u32 s82, s88, 2048
 buffer_load_dwordx4 v7, s[64:67], s82 offen sc1 lds
 s_add_u32 m0, s86, 3072
 s_add_u32 s82, s88, 3072
 buffer_load_dwordx4 v7, s[64:67], s82 offen sc1 lds
 s_add_u32 m0, s86, 6144
 s_add_u32 s82, s88, 67584
 buffer_load_dwordx4 v7, s[64:67], s82 offen sc1 lds
 s_add_u32 m0, s86, 7168
 s_add_u32 s82, s88, 68608
 buffer_load_dwordx4 v7, s[64:67], s82 offen sc1 lds
 s_add_u32 m0, s86, 10240
 s_add_u32 s82, s88, 133120
 buffer_load_dwordx4 v7, s[64:67], s82 offen sc1 lds
 s_add_u32 m0, s86, 11264
 s_add_u32 s82, s88, 134144
 buffer_load_dwordx4 v7, s[64:67], s82 offen sc1 lds
 s_add_u32 m0, s86, 14336
 s_add_u32 s82, s88, 198656
 buffer_load_dwordx4 v7, s[64:67], s82 offen sc1 lds
 s_add_u32 m0, s86, 15360
 s_add_u32 s82, s88, 199680
 buffer_load_dwordx4 v7, s[64:67], s82 offen sc1 lds
 s_mov_b32 s94, 1
RSK_49:
 v_add_u32 v21, 49152, v20
 ds_read_b128 v[96:99], v21 offset:0
 ds_read_b128 v[100:103], v21 offset:1024
 ds_read_b128 v[104:107], v21 offset:2048
 ds_read_b128 v[108:111], v21 offset:3072
 s_waitcnt lgkmcnt(2)
 s_add_u32 s82, s101, 0
 buffer_store_dwordx4 v[96:99], v7, s[64:67], s82 offen offset:0 sc1
 buffer_store_dwordx4 v[100:103], v7, s[64:67], s82 offen offset:1024 sc1
 s_waitcnt lgkmcnt(0)
 s_add_u32 s82, s101, 120832
 buffer_store_dwordx4 v[104:107], v7, s[64:67], s82 offen offset:0 sc1
 buffer_store_dwordx4 v[108:111], v7, s[64:67], s82 offen offset:1024 sc1
 s_cmp_eq_u32 s87, 1
 s_cbranch_scc1 RSK_50
 s_mov_b32 s39, 1048576
SPL_51:
 s_load_dword s8, s[64:65], s89 glc
SPF_53:
 s_waitcnt lgkmcnt(0)
 s_cmp_lg_u32 s8, s31
 s_cbranch_scc0 SPD_52
 s_sub_u32 s39, s39, 1
 s_cbranch_scc0 SPL_51
 v_mov_b32 v29, 258
 v_mov_b32 v30, 0
 global_store_dword v30, v29, s[68:69]
 s_waitcnt vmcnt(0)
SPD_52:
 s_add_u32 m0, s86, 0
 s_add_u32 s82, s88, 0
 buffer_load_dwordx4 v7, s[64:67], s82 offen sc1 lds
 s_add_u32 m0, s86, 1024
 s_add_u32 s82, s88, 1024
 buffer_load_dwordx4 v7, s[64:67], s82 offen sc1 lds
 s_add_u32 m0, s86, 4096
 s_add_u32 s82, s88, 65536
 buffer_load_dwordx4 v7, s[64:67], s82 offen sc1 lds
 s_add_u32 m0, s86, 5120
 s_add_u32 s82, s88, 66560
 buffer_load_dwordx4 v7, s[64:67], s82 offen sc1 lds
 s_add_u32 m0, s86, 8192
 s_add_u32 s82, s88, 131072
 buffer_load_dwordx4 v7, s[64:67], s82 offen sc1 lds
 s_add_u32 m0, s86, 9216
 s_add_u32 s82, s88, 132096
 buffer_load_dwordx4 v7, s[64:67], s82 offen sc1 lds
 s_add_u32 m0, s86, 12288
 s_add_u32 s82, s88, 196608
 buffer_load_dwordx4 v7, s[64:67], s82 offen sc1 lds
 s_add_u32 m0, s86, 13312
 s_add_u32 s82, s88, 197632
 buffer_load_dwordx4 v7, s[64:67], s82 offen sc1 lds
 s_mov_b32 s87, 1
RSK_50:
 s_waitcnt vmcnt(0) lgkmcnt(0)
 v_mov_b32 v8, 147468
 v_mov_b32 v9, 1
 s_mov_b64 exec, 1
 ds_add_u32 v8, v9
 s_mov_b64 exec, -1
 s_mov_b32 s98, s94
 v_mov_b32 v26, 3
 ds_write_b32 v23, v26
 s_cmp_eq_u32 s73, 0
 s_cbranch_scc0 PI_54
 s_mov_b32 s39, 1048576
LS_55:
 ds_read_b32 v31, v30 offset:0
 s_waitcnt lgkmcnt(0)
 v_cmp_gt_u32 vcc, 3, v31
 s_nop 0
 s_cbranch_vccz LD_56
 s_sub_u32 s39, s39, 1
 s_cbranch_scc0 LS_55
LD_56:
 s_lshl_b32 s81, s27, 11
 s_lshl_b32 s82, s28, 2
 s_add_u32 s81, s81, s82
 s_add_u32 s81, s81, 65536
 v_lshlrev_b32 v16, 7, v0
 v_add_u32 v16, s81, v16
 v_mov_b32 v17, s31
 s_mov_b64 exec, 0xffff
 buffer_store_dword v17, v16, s[64:67], 0 offen sc1
 s_mov_b64 exec, -1
PI_54:
 s_load_dword s9, s[64:65], s99 glc
 s_waitcnt lgkmcnt(0)
 s_cmp_eq_u32 s94, 1
 s_cbranch_scc1 RSK_57
 s_cmp_lg_u32 s9, s31
 s_cbranch_scc1 RSK_57
 s_add_u32 m0, s86, 2048
 s_add_u32 s82, s88, 2048
 buffer_load_dwordx4 v7, s[64:67], s82 offen sc1 lds
 s_add_u32 m0, s86, 3072
 s_add_u32 s82, s88, 3072
 buffer_load_dwordx4 v7, s[64:67], s82 offen sc1 lds
 s_add_u32 m0, s86, 6144
 s_add_u32 s82, s88, 67584
 buffer_load_dwordx4 v7, s[64:67], s82 offen sc1 lds
 s_add_u32 m0, s86, 7168
 s_add_u32 s82, s88, 68608
 buffer_load_dwordx4 v7, s[64:67], s82 offen sc1 lds
 s_add_u32 m0, s86, 10240
 s_add_u32 s82, s88, 133120
 buffer_load_dwordx4 v7, s[64:67], s82 offen sc1 lds
 s_add_u32 m0, s86, 11264
 s_add_u32 s82, s88, 134144
 buffer_load_dwordx4 v7, s[64:67], s82 offen sc1 lds
 s_add_u32 m0, s86, 14336
 s_add_u32 s82, s88, 198656
 buffer_load_dwordx4 v7, s[64:67], s82 offen sc1 lds
 s_add_u32 m0, s86, 15360
 s_add_u32 s82, s88, 199680
 buffer_load_dwordx4 v7, s[64:67], s82 offen sc1 lds
 s_mov_b32 s94, 1
RSK_57:
L_ATT:
 v_mov_b32 v8, 147468
 s_mov_b32 s39, 1048576
KSP_58:
 ds_read_b32 v9, v8
 s_waitcnt lgkmcnt(0)
 v_cmp_ne_u32 vcc, 2, v9
 s_nop 0
 s_cbranch_vccz KSD_59
 s_sub_u32 s39, s39, 1
 s_cbranch_scc0 KSP_58
KSD_59:
 s_lshl_b32 s81, s38, 3
 s_add_u32 s81, s81, 147680
 v_mov_b32 v8, s81
 s_mov_b32 s39, 1048576
LS_60:
 s_sleep 1
 ds_read_b32 v9, v8 offset:0
 s_waitcnt lgkmcnt(0)
 v_cmp_gt_u32 vcc, 5, v9
 s_nop 0
 s_cbranch_vccz LD_61
 s_sub_u32 s39, s39, 1
 s_cbranch_scc0 LS_60
LD_61:
 s_setprio 3
 s_lshl_b32 s81, s38, 11
 s_add_u32 s81, s81, 139264
 v_add_u32 v10, s81, v7
 ds_read_b128 v[16:19], v10
 ds_read_b128 v[20:23], v10 offset:1024
 s_mul_i32 s81, s38, 4096
 v_add_u32 v11, s81, v7
 s_cmp_eq_u32 s84, 0
 s_cbranch_scc0 ATG_62
 v_mov_b32 v68, v5
 v_mov_b32 v69, v5
 v_mov_b32 v70, v5
 v_mov_b32 v71, v5
 v_mov_b32 v72, v5
 v_mov_b32 v73, v5
 v_mov_b32 v74, v5
 v_mov_b32 v75, v5
 ds_read_b128 v[24:27], v11 offset:0
 ds_read_b128 v[28:31], v11 offset:4096
 s_waitcnt lgkmcnt(2)
 s_waitcnt lgkmcnt(1)
 v_mfma_f32_32x32x16_bf16 v[160:175], v[24:27], v[16:19], v[144:159]
 ds_read_b128 v[32:35], v11 offset:8192
 s_waitcnt lgkmcnt(1)
 v_mfma_f32_32x32x16_bf16 v[176:191], v[28:31], v[16:19], 0
 ds_read_b128 v[24:27], v11 offset:12288
 s_waitcnt lgkmcnt(1)
 v_mfma_f32_32x32x16_bf16 v[224:239], v[32:35], v[16:19], 0
 ds_read_b128 v[28:31], v11 offset:16384
 s_nop 5
 v_max3_f32 v68, v160, v161, v68
 v_max3_f32 v69, v162, v163, v69
 v_max3_f32 v70, v164, v165, v70
 v_max3_f32 v71, v166, v167, v71
 v_max3_f32 v68, v168, v169, v68
 v_max3_f32 v69, v170, v171, v69
 v_max3_f32 v70, v172, v173, v70
 v_max3_f32 v71, v174, v175, v71
 s_waitcnt lgkmcnt(1)
 v_mfma_f32_32x32x16_bf16 v[160:175], v[24:27], v[16:19], 0
 ds_read_b128 v[32:35], v11 offset:20480
 v_max3_f32 v68, v176, v177, v68
 v_max3_f32 v69, v178, v179, v69
 v_max3_f32 v70, v180, v181, v70
 v_max3_f32 v71, v182, v183, v71
 v_max3_f32 v68, v184, v185, v68
 v_max3_f32 v69, v186, v187, v69
 v_max3_f32 v70, v188, v189, v70
 v_max3_f32 v71, v190, v191, v71
 s_waitcnt lgkmcnt(1)
 v_mfma_f32_32x32x16_bf16 v[176:191], v[28:31], v[16:19], 0
 ds_read_b128 v[24:27], v11 offset:24576
 v_max3_f32 v68, v224, v225, v68
 v_max3_f32 v69, v226, v227, v69
 v_max3_f32 v70, v228, v229, v70
 v_max3_f32 v71, v230, v231, v71
 v_max3_f32 v68, v232, v233, v68
 v_max3_f32 v69, v234, v235, v69
 v_max3_f32 v70, v236, v237, v70
 v_max3_f32 v71, v238, v239, v71
 s_waitcnt lgkmcnt(1)
 v_mfma_f32_32x32x16_bf16 v[224:239], v[32:35], v[16:19], 0
 ds_read_b128 v[28:31], v11 offset:28672
 v_max3_f32 v68, v160, v161, v68
 v_max3_f32 v69, v162, v163, v69
 v_max3_f32 v70, v164, v165, v70
 v_max3_f32 v71, v166, v167, v71
 v_max3_f32 v68, v168, v169, v68
 v_max3_f32 v69, v170, v171, v69
 v_max3_f32 v70, v172, v173, v70
 v_max3_f32 v71, v174, v175, v71
 s_waitcnt lgkmcnt(1)
 v_mfma_f32_32x32x16_bf16 v[160:175], v[24:27], v[16:19], 0
 ds_read_b128 v[32:35], v11 offset:32768
 v_max3_f32 v68, v176, v177, v68
 v_max3_f32 v69, v178, v179, v69
 v_max3_f32 v70, v180, v181, v70
 v_max3_f32 v71, v182, v183, v71
 v_max3_f32 v68, v184, v185, v68
 v_max3_f32 v69, v186, v187, v69
 v_max3_f32 v70, v188, v189, v70
 v_max3_f32 v71, v190, v191, v71
 s_waitcnt lgkmcnt(1)
 v_mfma_f32_32x32x16_bf16 v[176:191], v[28:31], v[16:19], 0
 ds_read_b128 v[24:27], v11 offset:1024
 v_max3_f32 v68, v224, v225, v68
 v_max3_f32 v69, v226, v227, v69
 v_max3_f32 v70, v228, v229, v70
 v_max3_f32 v71, v230, v231, v71
 v_max3_f32 v68, v232, v233, v68
 v_max3_f32 v69, v234, v235, v69
 v_max3_f32 v70, v236, v237, v70
 v_max3_f32 v71, v238, v239, v71
 s_waitcnt lgkmcnt(1)
 v_mfma_f32_32x32x16_bf16 v[224:239], v[32:35], v[16:19], v[128:143]
 ds_read_b128 v[28:31], v11 offset:5120
 v_max3_f32 v68, v160, v161, v68
 v_max3_f32 v69, v162, v163, v69
 v_max3_f32 v70, v164, v165, v70
 v_max3_f32 v71, v166, v167, v71
 v_max3_f32 v68, v168, v169, v68
 v_max3_f32 v69, v170, v171, v69
 v_max3_f32 v70, v172, v173, v70
 v_max3_f32 v71, v174, v175, v71
 s_waitcnt lgkmcnt(1)
 v_mfma_f32_32x32x16_bf16 v[160:175], v[24:27], v[20:23], v[144:159]
 ds_read_b128 v[32:35], v11 offset:9216
 v_max3_f32 v68, v176, v177, v68
 v_max3_f32 v69, v178, v179, v69
 v_max3_f32 v70, v180, v181, v70
 v_max3_f32 v71, v182, v183, v71
 v_max3_f32 v68, v184, v185, v68
 v_max3_f32 v69, v186, v187, v69
 v_max3_f32 v70, v188, v189, v70
 v_max3_f32 v71, v190, v191, v71
 s_waitcnt lgkmcnt(1)
 v_mfma_f32_32x32x16_bf16 v[176:191], v[28:31], v[20:23], 0
 ds_read_b128 v[24:27], v11 offset:13312
 v_max3_f32 v68, v224, v225, v68
 v_max3_f32 v69, v226, v227, v69
 v_max3_f32 v70, v228, v229, v70
 v_max3_f32 v71, v230, v231, v71
 v_max3_f32 v68, v232, v233, v68
 v_max3_f32 v69, v234, v235, v69
 v_max3_f32 v70, v236, v237, v70
 v_max3_f32 v71, v238, v239, v71
 s_waitcnt lgkmcnt(1)
 v_mfma_f32_32x32x16_bf16 v[224:239], v[32:35], v[20:23], 0
 ds_read_b128 v[28:31], v11 offset:17408
 v_max3_f32 v72, v160, v161, v72
 v_max3_f32 v73, v162, v163, v73
 v_max3_f32 v74, v164, v165, v74
 v_max3_f32 v75, v166, v167, v75
 v_max3_f32 v72, v168, v169, v72
 v_max3_f32 v73, v170, v171, v73
 v_max3_f32 v74, v172, v173, v74
 v_max3_f32 v75, v174, v175, v75
 s_waitcnt lgkmcnt(1)
 v_mfma_f32_32x32x16_bf16 v[160:175], v[24:27], v[20:23], 0
 ds_read_b128 v[32:35], v11 offset:21504
 v_max3_f32 v72, v176, v177, v72
 v_max3_f32 v73, v178, v179, v73
 v_max3_f32 v74, v180, v181, v74
 v_max3_f32 v75, v182, v183, v75
 v_max3_f32 v72, v184, v185, v72
 v_max3_f32 v73, v186, v187, v73
 v_max3_f32 v74, v188, v189, v74
 v_max3_f32 v75, v190, v191, v75
 s_waitcnt lgkmcnt(1)
 v_mfma_f32_32x32x16_bf16 v[176:191], v[28:31], v[20:23], 0
 ds_read_b128 v[24:27], v11 offset:25600
 v_max3_f32 v72, v224, v225, v72
 v_max3_f32 v73, v226, v227, v73
 v_max3_f32 v74, v228, v229, v74
 v_max3_f32 v75, v230, v231, v75
 v_max3_f32 v72, v232, v233, v72
 v_max3_f32 v73, v234, v235, v73
 v_max3_f32 v74, v236, v237, v74
 v_max3_f32 v75, v238, v239, v75
 s_waitcnt lgkmcnt(1)
 v_mfma_f32_32x32x16_bf16 v[224:239], v[32:35], v[20:23], 0
 ds_read_b128 v[28:31], v11 offset:29696
 v_max3_f32 v72, v160, v161, v72
 v_max3_f32 v73, v162, v163, v73
 v_max3_f32 v74, v164, v165, v74
 v_max3_f32 v75, v166, v167, v75
 v_max3_f32 v72, v168, v169, v72
 v_max3_f32 v73, v170, v171, v73
 v_max3_f32 v74, v172, v173, v74
 v_max3_f32 v75, v174, v175, v75
 s_waitcnt lgkmcnt(1)
 v_mfma_f32_32x32x16_bf16 v[160:175], v[24:27], v[20:23], 0
 ds_read_b128 v[32:35], v11 offset:33792
 v_max3_f32 v72, v176, v177, v72
 v_max3_f32 v73, v178, v179, v73
 v_max3_f32 v74, v180, v181, v74
 v_max3_f32 v75, v182, v183, v75
 v_max3_f32 v72, v184, v185, v72
 v_max3_f32 v73, v186, v187, v73
 v_max3_f32 v74, v188, v189, v74
 v_max3_f32 v75, v190, v191, v75
 s_waitcnt lgkmcnt(1)
 v_mfma_f32_32x32x16_bf16 v[176:191], v[28:31], v[20:23], 0
 v_max3_f32 v72, v224, v225, v72
 v_max3_f32 v73, v226, v227, v73
 v_max3_f32 v74, v228, v229, v74
 v_max3_f32 v75, v230, v231, v75
 v_max3_f32 v72, v232, v233, v72
 v_max3_f32 v73, v234, v235, v73
 v_max3_f32 v74, v236, v237, v74
 v_max3_f32 v75, v238, v239, v75
 s_waitcnt lgkmcnt(0)
 v_mfma_f32_32x32x16_bf16 v[224:239], v[32:35], v[20:23], v[128:143]
 v_max3_f32 v72, v160, v161, v72
 v_max3_f32 v73, v162, v163, v73
 v_max3_f32 v74, v164, v165, v74
 v_max3_f32 v75, v166, v167, v75
 v_max3_f32 v72, v168, v169, v72
 v_max3_f32 v73, v170, v171, v73
 v_max3_f32 v74, v172, v173, v74
 v_max3_f32 v75, v174, v175, v75
 v_max3_f32 v72, v176, v177, v72
 v_max3_f32 v73, v178, v179, v73
 v_max3_f32 v74, v180, v181, v74
 v_max3_f32 v75, v182, v183, v75
 v_max3_f32 v72, v184, v185, v72
 v_max3_f32 v73, v186, v187, v73
 v_max3_f32 v74, v188, v189, v74
 v_max3_f32 v75, v190, v191, v75
 s_nop 3
 v_max3_f32 v72, v224, v225, v72
 v_max3_f32 v73, v226, v227, v73
 v_max3_f32 v74, v228, v229, v74
 v_max3_f32 v75, v230, v231, v75
 v_max3_f32 v72, v232, v233, v72
 v_max3_f32 v73, v234, v235, v73
 v_max3_f32 v74, v236, v237, v74
 v_max3_f32 v75, v238, v239, v75
 v_max3_f32 v68, v68, v69, v70
 v_max3_f32 v72, v72, v73, v74
 v_max_f32 v68, v68, v71
 v_max_f32 v72, v72, v75
 v_mov_b32 v76, v68
 v_mov_b32 v77, v72
 s_nop 1
 v_permlane32_swap_b32 v68, v76
 v_permlane32_swap_b32 v72, v77
 s_nop 0
 v_max_f32 v68, v68, v76
 v_max_f32 v72, v72, v77
 v_sub_f32 v76, 0, v68
 v_sub_f32 v77, 0, v72
 v_mov_b32 v52, 0x3f803f80
 v_mov_b32 v53, 0x3f803f80
 v_mov_b32 v54, 0x3f803f80
 v_mov_b32 v55, 0x3f803f80
 v_mov_b32 v56, 0x3f803f80
 v_mov_b32 v57, 0x3f803f80
 v_mov_b32 v58, 0x3f803f80
 v_mov_b32 v59, 0x3f803f80
 v_mov_b32 v60, 0x3f803f80
 v_mov_b32 v61, 0x3f803f80
 v_mov_b32 v62, 0x3f803f80
 v_mov_b32 v63, 0x3f803f80
 v_mov_b32 v64, 0x3f803f80
 v_mov_b32 v65, 0x3f803f80
 v_mov_b32 v66, 0x3f803f80
 v_mov_b32 v67, 0x3f803f80
 v_mov_b32 v80, 0x3f803f80
 v_mov_b32 v81, 0x3f803f80
 v_mov_b32 v82, 0x3f803f80
 v_mov_b32 v83, 0x3f803f80
 v_mov_b32 v84, 0x3f803f80
 v_mov_b32 v85, 0x3f803f80
 v_mov_b32 v86, 0x3f803f80
 v_mov_b32 v87, 0x3f803f80
 v_mov_b32 v88, 0x3f803f80
 v_mov_b32 v89, 0x3f803f80
 v_mov_b32 v90, 0x3f803f80
 v_mov_b32 v91, 0x3f803f80
 v_mov_b32 v92, 0x3f803f80
 v_mov_b32 v93, 0x3f803f80
 v_mov_b32 v94, 0x3f803f80
 v_mov_b32 v95, 0x3f803f80
 v_mov_b32 v8, 147464
 s_cmp_ge_u32 s38, 2
 s_cbranch_scc0 NPUB_64
 s_cmp_eq_u32 s98, 1
 s_cbranch_scc1 VE_65
 s_cmp_eq_u32 s94, 1
 s_cbranch_scc1 RSK_66
 s_mov_b32 s39, 1048576
SPL_67:
 s_load_dword s8, s[64:65], s99 glc
SPF_69:
 s_waitcnt lgkmcnt(0)
 s_cmp_lg_u32 s8, s31
 s_cbranch_scc0 SPD_68
 s_sub_u32 s39, s39, 1
 s_cbranch_scc0 SPL_67
 v_mov_b32 v29, 261
 v_mov_b32 v30, 0
 global_store_dword v30, v29, s[68:69]
 s_waitcnt vmcnt(0)
SPD_68:
 s_add_u32 m0, s86, 2048
 s_add_u32 s82, s88, 2048
 buffer_load_dwordx4 v7, s[64:67], s82 offen sc1 lds
 s_add_u32 m0, s86, 3072
 s_add_u32 s82, s88, 3072
 buffer_load_dwordx4 v7, s[64:67], s82 offen sc1 lds
 s_add_u32 m0, s86, 6144
 s_add_u32 s82, s88, 67584
 buffer_load_dwordx4 v7, s[64:67], s82 offen sc1 lds
 s_add_u32 m0, s86, 7168
 s_add_u32 s82, s88, 68608
 buffer_load_dwordx4 v7, s[64:67], s82 offen sc1 lds
 s_add_u32 m0, s86, 10240
 s_add_u32 s82, s88, 133120
 buffer_load_dwordx4 v7, s[64:67], s82 offen sc1 lds
 s_add_u32 m0, s86, 11264
 s_add_u32 s82, s88, 134144
 buffer_load_dwordx4 v7, s[64:67], s82 offen sc1 lds
 s_add_u32 m0, s86, 14336
 s_add_u32 s82, s88, 198656
 buffer_load_dwordx4 v7, s[64:67], s82 offen sc1 lds
 s_add_u32 m0, s86, 15360
 s_add_u32 s82, s88, 199680
 buffer_load_dwordx4 v7, s[64:67], s82 offen sc1 lds
 s_mov_b32 s94, 1
RSK_66:
 s_waitcnt vmcnt(0)
VE_65:
 v_mov_b32 v9, 1
 s_mov_b64 exec, 1
 ds_add_u32 v8, v9
 s_mov_b64 exec, -1
NPUB_64:
 s_mov_b32 s39, 1048576
LSP_70:
 ds_read_b32 v9, v8
 s_waitcnt lgkmcnt(0)
 v_cmp_ne_u32 vcc, 2, v9
 s_nop 0
 s_cbranch_vccz LSD_71
 s_sub_u32 s39, s39, 1
 s_cbranch_scc0 LSP_70
LSD_71:
 ds_read_b128 v[24:27], v11 offset:0
 ds_read_b128 v[28:31], v11 offset:4096
 v_add_f32 v208, v144, v76
 v_add_f32 v209, v145, v76
 v_add_f32 v210, v146, v76
 v_add_f32 v211, v147, v76
 v_add_f32 v212, v148, v76
 v_add_f32 v213, v149, v76
 v_add_f32 v214, v150, v76
 v_add_f32 v215, v151, v76
 v_add_f32 v216, v152, v76
 v_add_f32 v217, v153, v76
 v_add_f32 v218, v154, v76
 v_add_f32 v219, v155, v76
 v_add_f32 v220, v156, v76
 v_add_f32 v221, v157, v76
 v_add_f32 v222, v158, v76
 v_add_f32 v223, v159, v76
 v_mov_b32 v192, v76
 v_mov_b32 v193, v76
 v_mov_b32 v194, v76
 v_mov_b32 v195, v76
 v_mov_b32 v196, v76
 v_mov_b32 v197, v76
 v_mov_b32 v198, v76
 v_mov_b32 v199, v76
 v_mov_b32 v200, v76
 v_mov_b32 v201, v76
 v_mov_b32 v202, v76
 v_mov_b32 v203, v76
 v_mov_b32 v204, v76
 v_mov_b32 v205, v76
 v_mov_b32 v206, v76
 v_mov_b32 v207, v76
 s_nop 0
 s_waitcnt lgkmcnt(1)
 s_nop 0
 v_mfma_f32_32x32x16_bf16 v[160:175], v[24:27], v[16:19], v[208:223]
 s_mov_b32 exec_lo, 0x0000ffff
 s_mov_b32 exec_hi, 0x0000ffff
 ds_read_b128 v[52:55], v11 offset:2048
 ds_read_b128 v[56:59], v11 offset:3072
 s_mov_b64 exec, -1
 ds_read_b128 v[32:35], v11 offset:8192
 s_waitcnt lgkmcnt(3)
 v_mfma_f32_32x32x16_bf16 v[176:191], v[28:31], v[16:19], v[192:207]
 s_nop 9
 v_exp_f32 v160, v160
 v_exp_f32 v161, v161
 v_exp_f32 v162, v162
 v_exp_f32 v163, v163
 v_exp_f32 v164, v164
 v_exp_f32 v165, v165
 v_cvt_pk_bf16_f32 v36, v160, v161
 v_exp_f32 v166, v166
 v_exp_f32 v167, v167
 v_cvt_pk_bf16_f32 v37, v162, v163
 v_exp_f32 v168, v168
 v_exp_f32 v169, v169
 v_cvt_pk_bf16_f32 v38, v164, v165
 v_exp_f32 v170, v170
 v_exp_f32 v171, v171
 v_cvt_pk_bf16_f32 v39, v166, v167
 v_exp_f32 v172, v172
 v_exp_f32 v173, v173
 v_cvt_pk_bf16_f32 v40, v168, v169
 v_exp_f32 v174, v174
 v_exp_f32 v175, v175
 v_cvt_pk_bf16_f32 v41, v170, v171
 v_cvt_pk_bf16_f32 v42, v172, v173
 v_cvt_pk_bf16_f32 v43, v174, v175
 ds_read_b128 v[24:27], v11 offset:12288
 s_waitcnt lgkmcnt(1)
 v_mfma_f32_32x32x16_bf16 v[160:175], v[32:35], v[16:19], v[192:207]
 v_exp_f32 v176, v176
 v_exp_f32 v177, v177
 v_exp_f32 v178, v178
 v_exp_f32 v179, v179
 v_exp_f32 v180, v180
 s_waitcnt lgkmcnt(2)
 v_mfma_f32_32x32x16_bf16 v[96:111], v[52:55], v[36:39], 0
 v_exp_f32 v181, v181
 v_cvt_pk_bf16_f32 v44, v176, v177
 v_exp_f32 v182, v182
 v_exp_f32 v183, v183
 v_cvt_pk_bf16_f32 v45, v178, v179
 v_exp_f32 v184, v184
 v_mfma_f32_32x32x16_bf16 v[96:111], v[56:59], v[40:43], v[96:111]
 v_exp_f32 v185, v185
 v_cvt_pk_bf16_f32 v46, v180, v181
 v_exp_f32 v186, v186
 s_mov_b32 exec_lo, 0x0000ffff
 s_mov_b32 exec_hi, 0x0000ffff
 ds_read_b128 v[60:63], v11 offset:6144
 ds_read_b128 v[64:67], v11 offset:7168
 s_mov_b64 exec, -1
 v_exp_f32 v187, v187
 v_cvt_pk_bf16_f32 v47, v182, v183
 v_exp_f32 v188, v188
 v_exp_f32 v189, v189
 v_cvt_pk_bf16_f32 v48, v184, v185
 v_exp_f32 v190, v190
 v_exp_f32 v191, v191
 v_cvt_pk_bf16_f32 v49, v186, v187
 v_cvt_pk_bf16_f32 v50, v188, v189
 v_cvt_pk_bf16_f32 v51, v190, v191
 ds_read_b128 v[28:31], v11 offset:16384
 s_waitcnt lgkmcnt(3)
 v_mfma_f32_32x32x16_bf16 v[176:191], v[24:27], v[16:19], v[192:207]
 v_exp_f32 v160, v160
 v_exp_f32 v161, v161
 v_exp_f32 v162, v162
 v_exp_f32 v163, v163
 v_exp_f32 v164, v164
 s_waitcnt lgkmcnt(1)
 v_mfma_f32_32x32x16_bf16 v[96:111], v[60:63], v[44:47], v[96:111]
 v_exp_f32 v165, v165
 v_cvt_pk_bf16_f32 v36, v160, v161
 v_exp_f32 v166, v166
 v_exp_f32 v167, v167
 v_cvt_pk_bf16_f32 v37, v162, v163
 v_exp_f32 v168, v168
 v_mfma_f32_32x32x16_bf16 v[96:111], v[64:67], v[48:51], v[96:111]
 v_exp_f32 v169, v169
 v_cvt_pk_bf16_f32 v38, v164, v165
 v_exp_f32 v170, v170
 s_mov_b32 exec_lo, 0x0000ffff
 s_mov_b32 exec_hi, 0x0000ffff
 ds_read_b128 v[52:55], v11 offset:10240
 ds_read_b128 v[56:59], v11 offset:11264
 s_mov_b64 exec, -1
 v_exp_f32 v171, v171
 v_cvt_pk_bf16_f32 v39, v166, v167
 v_exp_f32 v172, v172
 v_exp_f32 v173, v173
 v_cvt_pk_bf16_f32 v40, v168, v169
 v_exp_f32 v174, v174
 v_exp_f32 v175, v175
 v_cvt_pk_bf16_f32 v41, v170, v171
 v_cvt_pk_bf16_f32 v42, v172, v173
 v_cvt_pk_bf16_f32 v43, v174, v175
 ds_read_b128 v[32:35], v11 offset:20480
 s_waitcnt lgkmcnt(3)
 v_mfma_f32_32x32x16_bf16 v[160:175], v[28:31], v[16:19], v[192:207]
 v_exp_f32 v176, v176
 v_exp_f32 v177, v177
 v_exp_f32 v178, v178
 v_exp_f32 v179, v179
 v_exp_f32 v180, v180
 s_waitcnt lgkmcnt(1)
 v_mfma_f32_32x32x16_bf16 v[96:111], v[52:55], v[36:39], v[96:111]
 v_exp_f32 v181, v181
 v_cvt_pk_bf16_f32 v44, v176, v177
 v_exp_f32 v182, v182
 v_exp_f32 v183, v183
 v_cvt_pk_bf16_f32 v45, v178, v179
 v_exp_f32 v184, v184
 v_mfma_f32_32x32x16_bf16 v[96:111], v[56:59], v[40:43], v[96:111]
 v_exp_f32 v185, v185
 v_cvt_pk_bf16_f32 v46, v180, v181
 v_exp_f32 v186, v186
 s_mov_b32 exec_lo, 0x0000ffff
 s_mov_b32 exec_hi, 0x0000ffff
 ds_read_b128 v[60:63], v11 offset:14336
 ds_read_b128 v[64:67], v11 offset:15360
 s_mov_b64 exec, -1
 v_exp_f32 v187, v187
 v_cvt_pk_bf16_f32 v47, v182, v183
 v_exp_f32 v188, v188
 v_exp_f32 v189, v189
 v_cvt_pk_bf16_f32 v48, v184, v185
 v_exp_f32 v190, v190
 v_exp_f32 v191, v191
 v_cvt_pk_bf16_f32 v49, v186, v187
 v_cvt_pk_bf16_f32 v50, v188, v189
 v_cvt_pk_bf16_f32 v51, v190, v191
 ds_read_b128 v[24:27], v11 offset:24576
 s_waitcnt lgkmcnt(3)
 v_mfma_f32_32x32x16_bf16 v[176:191], v[32:35], v[16:19], v[192:207]
 v_exp_f32 v160, v160
 v_exp_f32 v161, v161
 v_exp_f32 v162, v162
 v_exp_f32 v163, v163
 v_exp_f32 v164, v164
 s_waitcnt lgkmcnt(1)
 v_mfma_f32_32x32x16_bf16 v[96:111], v[60:63], v[44:47], v[96:111]
 v_exp_f32 v165, v165
 v_cvt_pk_bf16_f32 v36, v160, v161
 v_exp_f32 v166, v166
 v_exp_f32 v167, v167
 v_cvt_pk_bf16_f32 v37, v162, v163
 v_exp_f32 v168, v168
 v_mfma_f32_32x32x16_bf16 v[96:111], v[64:67], v[48:51], v[96:111]
 v_exp_f32 v169, v169
 v_cvt_pk_bf16_f32 v38, v164, v165
 v_exp_f32 v170, v170
 s_mov_b32 exec_lo, 0x0000ffff
 s_mov_b32 exec_hi, 0x0000ffff
 ds_read_b128 v[52:55], v11 offset:18432
 ds_read_b128 v[56:59], v11 offset:19456
 s_mov_b64 exec, -1
 v_exp_f32 v171, v171
 v_cvt_pk_bf16_f32 v39, v166, v167
 v_exp_f32 v172, v172
 v_exp_f32 v173, v173
 v_cvt_pk_bf16_f32 v40, v168, v169
 v_exp_f32 v174, v174
 v_exp_f32 v175, v175
 v_cvt_pk_bf16_f32 v41, v170, v171
 v_cvt_pk_bf16_f32 v42, v172, v173
 v_cvt_pk_bf16_f32 v43, v174, v175
 ds_read_b128 v[28:31], v11 offset:28672
 s_waitcnt lgkmcnt(3)
 v_mfma_f32_32x32x16_bf16 v[160:175], v[24:27], v[16:19], v[192:207]
 v_exp_f32 v176, v176
 v_exp_f32 v177, v177
 v_exp_f32 v178, v178
 v_exp_f32 v179, v179
 v_exp_f32 v180, v180
 s_waitcnt lgkmcnt(1)
 v_mfma_f32_32x32x16_bf16 v[96:111], v[52:55], v[36:39], v[96:111]
 v_exp_f32 v181, v181
 v_cvt_pk_bf16_f32 v44, v176, v177
 v_exp_f32 v182, v182
 v_exp_f32 v183, v183
 v_cvt_pk_bf16_f32 v45, v178, v179
 v_exp_f32 v184, v184
 v_mfma_f32_32x32x16_bf16 v[96:111], v[56:59], v[40:43], v[96:111]
 v_exp_f32 v185, v185
 v_cvt_pk_bf16_f32 v46, v180, v181
 v_exp_f32 v186, v186
 s_mov_b32 exec_lo, 0x0000ffff
 s_mov_b32 exec_hi, 0x0000ffff
 ds_read_b128 v[60:63], v11 offset:22528
 ds_read_b128 v[64:67], v11 offset:23552
 s_mov_b64 exec, -1
 v_exp_f32 v187, v187
 v_cvt_pk_bf16_f32 v47, v182, v183
 v_exp_f32 v188, v188
 v_exp_f32 v189, v189
 v_cvt_pk_bf16_f32 v48, v184, v185
 v_exp_f32 v190, v190
 v_exp_f32 v191, v191
 v_cvt_pk_bf16_f32 v49, v186, v187
 v_cvt_pk_bf16_f32 v50, v188, v189
 v_cvt_pk_bf16_f32 v51, v190, v191
 ds_read_b128 v[32:35], v11 offset:32768
 s_waitcnt lgkmcnt(3)
 v_mfma_f32_32x32x16_bf16 v[176:191], v[28:31], v[16:19], v[192:207]
 v_exp_f32 v160, v160
 v_exp_f32 v161, v161
 v_exp_f32 v162, v162
 v_exp_f32 v163, v163
 v_exp_f32 v164, v164
 s_waitcnt lgkmcnt(1)
 v_mfma_f32_32x32x16_bf16 v[96:111], v[60:63], v[44:47], v[96:111]
 v_exp_f32 v165, v165
 v_cvt_pk_bf16_f32 v36, v160, v161
 v_exp_f32 v166, v166
 v_exp_f32 v167, v167
 v_cvt_pk_bf16_f32 v37, v162, v163
 v_exp_f32 v168, v168
 v_mfma_f32_32x32x16_bf16 v[96:111], v[64:67], v[48:51], v[96:111]
 v_exp_f32 v169, v169
 v_cvt_pk_bf16_f32 v38, v164, v165
 v_exp_f32 v170, v170
 s_mov_b32 exec_lo, 0x0000ffff
 s_mov_b32 exec_hi, 0x0000ffff
 ds_read_b128 v[52:55], v11 offset:26624
 ds_read_b128 v[56:59], v11 offset:27648
 s_mov_b64 exec, -1
 v_exp_f32 v171, v171
 v_cvt_pk_bf16_f32 v39, v166, v167
 v_exp_f32 v172, v172
 v_exp_f32 v173, v173
 v_cvt_pk_bf16_f32 v40, v168, v169
 v_exp_f32 v174, v174
 v_exp_f32 v175, v175
 v_cvt_pk_bf16_f32 v41, v170, v171
 v_cvt_pk_bf16_f32 v42, v172, v173
 v_cvt_pk_bf16_f32 v43, v174, v175
 ds_read_b128 v[24:27], v11 offset:1024
 v_add_f32 v208, v128, v76
 v_add_f32 v209, v129, v76
 v_add_f32 v210, v130, v76
 v_add_f32 v211, v131, v76
 v_add_f32 v212, v132, v76
 v_add_f32 v213, v133, v76
 v_add_f32 v214, v134, v76
 v_add_f32 v215, v135, v76
 v_add_f32 v216, v136, v76
 v_add_f32 v217, v137, v76
 v_add_f32 v218, v138, v76
 v_add_f32 v219, v139, v76
 v_add_f32 v220, v140, v76
 v_add_f32 v221, v141, v76
 v_add_f32 v222, v142, v76
 v_add_f32 v223, v143, v76
 s_nop 0
 s_waitcnt lgkmcnt(3)
 v_mfma_f32_32x32x16_bf16 v[160:175], v[32:35], v[16:19], v[208:223]
 v_exp_f32 v176, v176
 v_exp_f32 v177, v177
 v_exp_f32 v178, v178
 v_exp_f32 v179, v179
 v_exp_f32 v180, v180
 s_waitcnt lgkmcnt(1)
 v_mfma_f32_32x32x16_bf16 v[96:111], v[52:55], v[36:39], v[96:111]
 v_exp_f32 v181, v181
 v_cvt_pk_bf16_f32 v44, v176, v177
 v_exp_f32 v182, v182
 v_exp_f32 v183, v183
 v_cvt_pk_bf16_f32 v45, v178, v179
 v_exp_f32 v184, v184
 v_mfma_f32_32x32x16_bf16 v[96:111], v[56:59], v[40:43], v[96:111]
 v_exp_f32 v185, v185
 v_cvt_pk_bf16_f32 v46, v180, v181
 v_exp_f32 v186, v186
 s_mov_b32 exec_lo, 0x0000ffff
 s_mov_b32 exec_hi, 0x0000ffff
 ds_read_b128 v[60:63], v11 offset:30720
 ds_read_b128 v[64:67], v11 offset:31744
 s_mov_b64 exec, -1
 v_exp_f32 v187, v187
 v_cvt_pk_bf16_f32 v47, v182, v183
 v_exp_f32 v188, v188
 v_exp_f32 v189, v189
 v_cvt_pk_bf16_f32 v48, v184, v185
 v_exp_f32 v190, v190
 v_exp_f32 v191, v191
 v_cvt_pk_bf16_f32 v49, v186, v187
 v_cvt_pk_bf16_f32 v50, v188, v189
 v_cvt_pk_bf16_f32 v51, v190, v191
 ds_read_b128 v[28:31], v11 offset:5120
 v_add_f32 v208, v144, v77
 v_add_f32 v209, v145, v77
 v_add_f32 v210, v146, v77
 v_add_f32 v211, v147, v77
 v_add_f32 v212, v148, v77
 v_add_f32 v213, v149, v77
 v_add_f32 v214, v150, v77
 v_add_f32 v215, v151, v77
 v_add_f32 v216, v152, v77
 v_add_f32 v217, v153, v77
 v_add_f32 v218, v154, v77
 v_add_f32 v219, v155, v77
 v_add_f32 v220, v156, v77
 v_add_f32 v221, v157, v77
 v_add_f32 v222, v158, v77
 v_add_f32 v223, v159, v77
 v_mov_b32 v192, v77
 v_mov_b32 v193, v77
 v_mov_b32 v194, v77
 v_mov_b32 v195, v77
 v_mov_b32 v196, v77
 v_mov_b32 v197, v77
 v_mov_b32 v198, v77
 v_mov_b32 v199, v77
 v_mov_b32 v200, v77
 v_mov_b32 v201, v77
 v_mov_b32 v202, v77
 v_mov_b32 v203, v77
 v_mov_b32 v204, v77
 v_mov_b32 v205, v77
 v_mov_b32 v206, v77
 v_mov_b32 v207, v77
 s_nop 0
 s_waitcnt lgkmcnt(3)
 v_mfma_f32_32x32x16_bf16 v[176:191], v[24:27], v[20:23], v[208:223]
 v_exp_f32 v160, v160
 v_exp_f32 v161, v161
 v_exp_f32 v162, v162
 v_exp_f32 v163, v163
 v_exp_f32 v164, v164
 s_waitcnt lgkmcnt(1)
 v_mfma_f32_32x32x16_bf16 v[96:111], v[60:63], v[44:47], v[96:111]
 v_exp_f32 v165, v165
 v_cvt_pk_bf16_f32 v36, v160, v161
 v_exp_f32 v166, v166
 v_exp_f32 v167, v167
 v_cvt_pk_bf16_f32 v37, v162, v163
 v_exp_f32 v168, v168
 v_mfma_f32_32x32x16_bf16 v[96:111], v[64:67], v[48:51], v[96:111]
 v_exp_f32 v169, v169
 v_cvt_pk_bf16_f32 v38, v164, v165
 v_exp_f32 v170, v170
 s_mov_b32 exec_lo, 0x0000ffff
 s_mov_b32 exec_hi, 0x0000ffff
 ds_read_b128 v[52:55], v11 offset:34816
 ds_read_b128 v[56:59], v11 offset:35840
 s_mov_b64 exec, -1
 v_exp_f32 v171, v171
 v_cvt_pk_bf16_f32 v39, v166, v167
 v_exp_f32 v172, v172
 v_exp_f32 v173, v173
 v_cvt_pk_bf16_f32 v40, v168, v169
 v_exp_f32 v174, v174
 v_exp_f32 v175, v175
 v_cvt_pk_bf16_f32 v41, v170, v171
 v_cvt_pk_bf16_f32 v42, v172, v173
 v_cvt_pk_bf16_f32 v43, v174, v175
 ds_read_b128 v[32:35], v11 offset:9216
 s_waitcnt lgkmcnt(3)
 v_mfma_f32_32x32x16_bf16 v[160:175], v[28:31], v[20:23], v[192:207]
 v_exp_f32 v176, v176
 v_exp_f32 v177, v177
 v_exp_f32 v178, v178
 v_exp_f32 v179, v179
 v_exp_f32 v180, v180
 s_waitcnt lgkmcnt(1)
 v_mfma_f32_32x32x16_bf16 v[96:111], v[52:55], v[36:39], v[96:111]
 v_exp_f32 v181, v181
 v_cvt_pk_bf16_f32 v44, v176, v177
 v_exp_f32 v182, v182
 v_exp_f32 v183, v183
 v_cvt_pk_bf16_f32 v45, v178, v179
 v_exp_f32 v184, v184
 v_mfma_f32_32x32x16_bf16 v[96:111], v[56:59], v[40:43], v[96:111]
 v_exp_f32 v185, v185
 v_cvt_pk_bf16_f32 v46, v180, v181
 v_exp_f32 v186, v186
 s_mov_b32 exec_lo, 0xffff0000
 s_mov_b32 exec_hi, 0xffff0000
 ds_read_b128 v[88:91], v11 offset:2048
 ds_read_b128 v[92:95], v11 offset:3072
 s_mov_b64 exec, -1
 v_exp_f32 v187, v187
 v_cvt_pk_bf16_f32 v47, v182, v183
 v_exp_f32 v188, v188
 v_exp_f32 v189, v189
 v_cvt_pk_bf16_f32 v48, v184, v185
 v_exp_f32 v190, v190
 v_exp_f32 v191, v191
 v_cvt_pk_bf16_f32 v49, v186, v187
 v_cvt_pk_bf16_f32 v50, v188, v189
 v_cvt_pk_bf16_f32 v51, v190, v191
 ds_read_b128 v[24:27], v11 offset:13312
 s_waitcnt lgkmcnt(3)
 v_mfma_f32_32x32x16_bf16 v[176:191], v[32:35], v[20:23], v[192:207]
 v_exp_f32 v160, v160
 v_exp_f32 v161, v161
 v_exp_f32 v162, v162
 v_exp_f32 v163, v163
 v_exp_f32 v164, v164
 s_waitcnt lgkmcnt(1)
 v_mfma_f32_32x32x16_bf16 v[112:127], v[88:91], v[44:47], 0
 v_exp_f32 v165, v165
 v_cvt_pk_bf16_f32 v36, v160, v161
 v_exp_f32 v166, v166
 v_exp_f32 v167, v167
 v_cvt_pk_bf16_f32 v37, v162, v163
 v_exp_f32 v168, v168
 v_mfma_f32_32x32x16_bf16 v[112:127], v[92:95], v[48:51], v[112:127]
 v_exp_f32 v169, v169
 v_cvt_pk_bf16_f32 v38, v164, v165
 v_exp_f32 v170, v170
 s_mov_b32 exec_lo, 0xffff0000
 s_mov_b32 exec_hi, 0xffff0000
 ds_read_b128 v[80:83], v11 offset:6144
 ds_read_b128 v[84:87], v11 offset:7168
 s_mov_b64 exec, -1
 v_exp_f32 v171, v171
 v_cvt_pk_bf16_f32 v39, v166, v167
 v_exp_f32 v172, v172
 v_exp_f32 v173, v173
 v_cvt_pk_bf16_f32 v40, v168, v169
 v_exp_f32 v174, v174
 v_exp_f32 v175, v175
 v_cvt_pk_bf16_f32 v41, v170, v171
 v_cvt_pk_bf16_f32 v42, v172, v173
 v_cvt_pk_bf16_f32 v43, v174, v175
 ds_read_b128 v[28:31], v11 offset:17408
 s_waitcnt lgkmcnt(3)
 v_mfma_f32_32x32x16_bf16 v[160:175], v[24:27], v[20:23], v[192:207]
 v_exp_f32 v176, v176
 v_exp_f32 v177, v177
 v_exp_f32 v178, v178
 v_exp_f32 v179, v179
 v_exp_f32 v180, v180
 s_waitcnt lgkmcnt(1)
 v_mfma_f32_32x32x16_bf16 v[112:127], v[80:83], v[36:39], v[112:127]
 v_exp_f32 v181, v181
 v_cvt_pk_bf16_f32 v44, v176, v177
 v_exp_f32 v182, v182
 v_exp_f32 v183, v183
 v_cvt_pk_bf16_f32 v45, v178, v179
 v_exp_f32 v184, v184
 v_mfma_f32_32x32x16_bf16 v[112:127], v[84:87], v[40:43], v[112:127]
 v_exp_f32 v185, v185
 v_cvt_pk_bf16_f32 v46, v180, v181
 v_exp_f32 v186, v186
 s_mov_b32 exec_lo, 0xffff0000
 s_mov_b32 exec_hi, 0xffff0000
 ds_read_b128 v[88:91], v11 offset:10240
 ds_read_b128 v[92:95], v11 offset:11264
 s_mov_b64 exec, -1
 v_exp_f32 v187, v187
 v_cvt_pk_bf16_f32 v47, v182, v183
 v_exp_f32 v188, v188
 v_exp_f32 v189, v189
 v_cvt_pk_bf16_f32 v48, v184, v185
 v_exp_f32 v190, v190
 v_exp_f32 v191, v191
 v_cvt_pk_bf16_f32 v49, v186, v187
 v_cvt_pk_bf16_f32 v50, v188, v189
 v_cvt_pk_bf16_f32 v51, v190, v191
 ds_read_b128 v[32:35], v11 offset:21504
 s_waitcnt lgkmcnt(3)
 v_mfma_f32_32x32x16_bf16 v[176:191], v[28:31], v[20:23], v[192:207]
 v_exp_f32 v160, v160
 v_exp_f32 v161, v161
 v_exp_f32 v162, v162
 v_exp_f32 v163, v163
 v_exp_f32 v164, v164
 s_waitcnt lgkmcnt(1)
 v_mfma_f32_32x32x16_bf16 v[112:127], v[88:91], v[44:47], v[112:127]
 v_exp_f32 v165, v165
 v_cvt_pk_bf16_f32 v36, v160, v161
 v_exp_f32 v166, v166
 v_exp_f32 v167, v167
 v_cvt_pk_bf16_f32 v37, v162, v163
 v_exp_f32 v168, v168
 v_mfma_f32_32x32x16_bf16 v[112:127], v[92:95], v[48:51], v[112:127]
 v_exp_f32 v169, v169
 v_cvt_pk_bf16_f32 v38, v164, v165
 v_exp_f32 v170, v170
 s_mov_b32 exec_lo, 0xffff0000
 s_mov_b32 exec_hi, 0xffff0000
 ds_read_b128 v[80:83], v11 offset:14336
 ds_read_b128 v[84:87], v11 offset:15360
 s_mov_b64 exec, -1
 v_exp_f32 v171, v171
 v_cvt_pk_bf16_f32 v39, v166, v167
 v_exp_f32 v172, v172
 v_exp_f32 v173, v173
 v_cvt_pk_bf16_f32 v40, v168, v169
 v_exp_f32 v174, v174
 v_exp_f32 v175, v175
 v_cvt_pk_bf16_f32 v41, v170, v171
 v_cvt_pk_bf16_f32 v42, v172, v173
 v_cvt_pk_bf16_f32 v43, v174, v175
 ds_read_b128 v[24:27], v11 offset:25600
 s_waitcnt lgkmcnt(3)
 v_mfma_f32_32x32x16_bf16 v[160:175], v[32:35], v[20:23], v[192:207]
 v_exp_f32 v176, v176
 v_exp_f32 v177, v177
 v_exp_f32 v178, v178
 v_exp_f32 v179, v179
 v_exp_f32 v180, v180
 s_waitcnt lgkmcnt(1)
 v_mfma_f32_32x32x16_bf16 v[112:127], v[80:83], v[36:39], v[112:127]
 v_exp_f32 v181, v181
 v_cvt_pk_bf16_f32 v44, v176, v177
 v_exp_f32 v182, v182
 v_exp_f32 v183, v183
 v_cvt_pk_bf16_f32 v45, v178, v179
 v_exp_f32 v184, v184
 v_mfma_f32_32x32x16_bf16 v[112:127], v[84:87], v[40:43], v[112:127]
 v_exp_f32 v185, v185
 v_cvt_pk_bf16_f32 v46, v180, v181
 v_exp_f32 v186, v186
 s_mov_b32 exec_lo, 0xffff0000
 s_mov_b32 exec_hi, 0xffff0000
 ds_read_b128 v[88:91], v11 offset:18432
 ds_read_b128 v[92:95], v11 offset:19456
 s_mov_b64 exec, -1
 v_exp_f32 v187, v187
 v_cvt_pk_bf16_f32 v47, v182, v183
 v_exp_f32 v188, v188
 v_exp_f32 v189, v189
 v_cvt_pk_bf16_f32 v48, v184, v185
 v_exp_f32 v190, v190
 v_exp_f32 v191, v191
 v_cvt_pk_bf16_f32 v49, v186, v187
 v_cvt_pk_bf16_f32 v50, v188, v189
 v_cvt_pk_bf16_f32 v51, v190, v191
 ds_read_b128 v[28:31], v11 offset:29696
 s_waitcnt lgkmcnt(3)
 v_mfma_f32_32x32x16_bf16 v[176:191], v[24:27], v[20:23], v[192:207]
 v_exp_f32 v160, v160
 v_exp_f32 v161, v161
 v_exp_f32 v162, v162
 v_exp_f32 v163, v163
 v_exp_f32 v164, v164
 s_waitcnt lgkmcnt(1)
 v_mfma_f32_32x32x16_bf16 v[112:127], v[88:91], v[44:47], v[112:127]
 v_exp_f32 v165, v165
 v_cvt_pk_bf16_f32 v36, v160, v161
 v_exp_f32 v166, v166
 v_exp_f32 v167, v167
 v_cvt_pk_bf16_f32 v37, v162, v163
 v_exp_f32 v168, v168
 v_mfma_f32_32x32x16_bf16 v[112:127], v[92:95], v[48:51], v[112:127]
 v_exp_f32 v169, v169
 v_cvt_pk_bf16_f32 v38, v164, v165
 v_exp_f32 v170, v170
 s_mov_b32 exec_lo, 0xffff0000
 s_mov_b32 exec_hi, 0xffff0000
 ds_read_b128 v[80:83], v11 offset:22528
 ds_read_b128 v[84:87], v11 offset:23552
 s_mov_b64 exec, -1
 v_exp_f32 v171, v171
 v_cvt_pk_bf16_f32 v39, v166, v167
 v_exp_f32 v172, v172
 v_exp_f32 v173, v173
 v_cvt_pk_bf16_f32 v40, v168, v169
 v_exp_f32 v174, v174
 v_exp_f32 v175, v175
 v_cvt_pk_bf16_f32 v41, v170, v171
 v_cvt_pk_bf16_f32 v42, v172, v173
 v_cvt_pk_bf16_f32 v43, v174, v175
 ds_read_b128 v[32:35], v11 offset:33792
 s_waitcnt lgkmcnt(3)
 v_mfma_f32_32x32x16_bf16 v[160:175], v[28:31], v[20:23], v[192:207]
 v_exp_f32 v176, v176
 v_exp_f32 v177, v177
 v_exp_f32 v178, v178
 v_exp_f32 v179, v179
 v_exp_f32 v180, v180
 s_waitcnt lgkmcnt(1)
 v_mfma_f32_32x32x16_bf16 v[112:127], v[80:83], v[36:39], v[112:127]
 v_exp_f32 v181, v181
 v_cvt_pk_bf16_f32 v44, v176, v177
 v_exp_f32 v182, v182
 v_exp_f32 v183, v183
 v_cvt_pk_bf16_f32 v45, v178, v179
 v_exp_f32 v184, v184
 v_mfma_f32_32x32x16_bf16 v[112:127], v[84:87], v[40:43], v[112:127]
 v_exp_f32 v185, v185
 v_cvt_pk_bf16_f32 v46, v180, v181
 v_exp_f32 v186, v186
 s_mov_b32 exec_lo, 0xffff0000
 s_mov_b32 exec_hi, 0xffff0000
 ds_read_b128 v[88:91], v11 offset:26624
 ds_read_b128 v[92:95], v11 offset:27648
 s_mov_b64 exec, -1
 v_exp_f32 v187, v187
 v_cvt_pk_bf16_f32 v47, v182, v183
 v_exp_f32 v188, v188
 v_exp_f32 v189, v189
 v_cvt_pk_bf16_f32 v48, v184, v185
 v_exp_f32 v190, v190
 v_exp_f32 v191, v191
 v_cvt_pk_bf16_f32 v49, v186, v187
 v_cvt_pk_bf16_f32 v50, v188, v189
 v_cvt_pk_bf16_f32 v51, v190, v191
 v_add_f32 v208, v128, v77
 v_add_f32 v209, v129, v77
 v_add_f32 v210, v130, v77
 v_add_f32 v211, v131, v77
 v_add_f32 v212, v132, v77
 v_add_f32 v213, v133, v77
 v_add_f32 v214, v134, v77
 v_add_f32 v215, v135, v77
 v_add_f32 v216, v136, v77
 v_add_f32 v217, v137, v77
 v_add_f32 v218, v138, v77
 v_add_f32 v219, v139, v77
 v_add_f32 v220, v140, v77
 v_add_f32 v221, v141, v77
 v_add_f32 v222, v142, v77
 v_add_f32 v223, v143, v77
 s_nop 0
 s_waitcnt lgkmcnt(2)
 v_mfma_f32_32x32x16_bf16 v[176:191], v[32:35], v[20:23], v[208:223]
 v_exp_f32 v160, v160
 v_exp_f32 v161, v161
 v_exp_f32 v162, v162
 v_exp_f32 v163, v163
 v_exp_f32 v164, v164
 s_waitcnt lgkmcnt(0)
 v_mfma_f32_32x32x16_bf16 v[112:127], v[88:91], v[44:47], v[112:127]
 v_exp_f32 v165, v165
 v_cvt_pk_bf16_f32 v36, v160, v161
 v_exp_f32 v166, v166
 v_exp_f32 v167, v167
 v_cvt_pk_bf16_f32 v37, v162, v163
 v_exp_f32 v168, v168
 v_mfma_f32_32x32x16_bf16 v[112:127], v[92:95], v[48:51], v[112:127]
 v_exp_f32 v169, v169
 v_cvt_pk_bf16_f32 v38, v164, v165
 v_exp_f32 v170, v170
 s_mov_b32 exec_lo, 0xffff0000
 s_mov_b32 exec_hi, 0xffff0000
 ds_read_b128 v[80:83], v11 offset:30720
 ds_read_b128 v[84:87], v11 offset:31744
 s_mov_b64 exec, -1
 v_exp_f32 v171, v171
 v_cvt_pk_bf16_f32 v39, v166, v167
 v_exp_f32 v172, v172
 v_exp_f32 v173, v173
 v_cvt_pk_bf16_f32 v40, v168, v169
 v_exp_f32 v174, v174
 v_exp_f32 v175, v175
 v_cvt_pk_bf16_f32 v41, v170, v171
 v_cvt_pk_bf16_f32 v42, v172, v173
 v_cvt_pk_bf16_f32 v43, v174, v175
 v_exp_f32 v176, v176
 v_exp_f32 v177, v177
 v_exp_f32 v178, v178
 v_exp_f32 v179, v179
 v_exp_f32 v180, v180
 s_waitcnt lgkmcnt(0)
 v_mfma_f32_32x32x16_bf16 v[112:127], v[80:83], v[36:39], v[112:127]
 v_exp_f32 v181, v181
 v_cvt_pk_bf16_f32 v44, v176, v177
 v_exp_f32 v182, v182
 v_exp_f32 v183, v183
 v_cvt_pk_bf16_f32 v45, v178, v179
 v_exp_f32 v184, v184
 v_mfma_f32_32x32x16_bf16 v[112:127], v[84:87], v[40:43], v[112:127]
 v_exp_f32 v185, v185
 v_cvt_pk_bf16_f32 v46, v180, v181
 v_exp_f32 v186, v186
 s_mov_b32 exec_lo, 0xffff0000
 s_mov_b32 exec_hi, 0xffff0000
 ds_read_b128 v[88:91], v11 offset:34816
 ds_read_b128 v[92:95], v11 offset:35840
 s_mov_b64 exec, -1
 v_exp_f32 v187, v187
 v_cvt_pk_bf16_f32 v47, v182, v183
 v_exp_f32 v188, v188
 v_exp_f32 v189, v189
 v_cvt_pk_bf16_f32 v48, v184, v185
 v_exp_f32 v190, v190
 v_exp_f32 v191, v191
 v_cvt_pk_bf16_f32 v49, v186, v187
 v_cvt_pk_bf16_f32 v50, v188, v189
 v_cvt_pk_bf16_f32 v51, v190, v191
 s_waitcnt lgkmcnt(0)
 s_nop 1
 v_mfma_f32_32x32x16_bf16 v[112:127], v[88:91], v[44:47], v[112:127]
 v_mfma_f32_32x32x16_bf16 v[112:127], v[92:95], v[48:51], v[112:127]
 s_branch ATF_63
ATG_62:
 v_mov_b32 v68, v5
 v_mov_b32 v69, v5
 v_mov_b32 v70, v5
 v_mov_b32 v71, v5
 v_mov_b32 v72, v5
 v_mov_b32 v73, v5
 v_mov_b32 v74, v5
 v_mov_b32 v75, v5
 ds_read_b128 v[24:27], v11 offset:0
 ds_read_b128 v[28:31], v11 offset:4096
 s_cmp_gt_u32 s84, 1
 s_cbranch_scc1 CZA_72
 v_mov_b32 v192, 0
 v_mov_b32 v193, 0
 v_mov_b32 v194, 0
 v_mov_b32 v195, 0
 v_mov_b32 v196, 0
 v_mov_b32 v197, 0
 v_mov_b32 v198, 0
 v_mov_b32 v199, 0
 v_mov_b32 v200, 0
 v_mov_b32 v201, 0
 v_mov_b32 v202, 0
 v_mov_b32 v203, 0
 v_mov_b32 v204, 0
 v_mov_b32 v205, 0
 v_mov_b32 v206, 0
 v_mov_b32 v207, 0
 s_branch CZB_73
CZA_72:
 v_mov_b32 v192, v5
 v_mov_b32 v193, v5
 v_mov_b32 v194, v5
 v_mov_b32 v195, v5
 v_mov_b32 v196, v5
 v_mov_b32 v197, v5
 v_mov_b32 v198, v5
 v_mov_b32 v199, v5
 v_mov_b32 v200, v5
 v_mov_b32 v201, v5
 v_mov_b32 v202, v5
 v_mov_b32 v203, v5
 v_mov_b32 v204, v5
 v_mov_b32 v205, v5
 v_mov_b32 v206, v5
 v_mov_b32 v207, v5
CZB_73:
 s_waitcnt lgkmcnt(2)
 s_waitcnt lgkmcnt(1)
 v_mfma_f32_32x32x16_bf16 v[160:175], v[24:27], v[16:19], v[144:159]
 ds_read_b128 v[32:35], v11 offset:8192
 s_waitcnt lgkmcnt(1)
 v_mfma_f32_32x32x16_bf16 v[176:191], v[28:31], v[16:19], v[192:207]
 ds_read_b128 v[24:27], v11 offset:12288
 s_cmp_eq_u32 s84, 2
 s_cbranch_scc0 CZS_74
 s_nop 7
 v_mov_b32 v192, 0
 v_mov_b32 v193, 0
 v_mov_b32 v194, 0
 v_mov_b32 v195, 0
 v_mov_b32 v196, 0
 v_mov_b32 v197, 0
 v_mov_b32 v198, 0
 v_mov_b32 v199, 0
 v_mov_b32 v200, 0
 v_mov_b32 v201, 0
 v_mov_b32 v202, 0
 v_mov_b32 v203, 0
 v_mov_b32 v204, 0
 v_mov_b32 v205, 0
 v_mov_b32 v206, 0
 v_mov_b32 v207, 0
 s_nop 1
CZS_74:
 s_waitcnt lgkmcnt(1)
 v_mfma_f32_32x32x16_bf16 v[224:239], v[32:35], v[16:19], v[192:207]
 ds_read_b128 v[28:31], v11 offset:16384
 s_nop 5
 v_max3_f32 v68, v160, v161, v68
 v_max3_f32 v69, v162, v163, v69
 v_max3_f32 v70, v164, v165, v70
 v_max3_f32 v71, v166, v167, v71
 v_max3_f32 v68, v168, v169, v68
 v_max3_f32 v69, v170, v171, v69
 v_max3_f32 v70, v172, v173, v70
 v_max3_f32 v71, v174, v175, v71
 s_cmp_eq_u32 s84, 3
 s_cbranch_scc0 CZS_75
 s_nop 7
 v_mov_b32 v192, 0
 v_mov_b32 v193, 0
 v_mov_b32 v194, 0
 v_mov_b32 v195, 0
 v_mov_b32 v196, 0
 v_mov_b32 v197, 0
 v_mov_b32 v198, 0
 v_mov_b32 v199, 0
 v_mov_b32 v200, 0
 v_mov_b32 v201, 0
 v_mov_b32 v202, 0
 v_mov_b32 v203, 0
 v_mov_b32 v204, 0
 v_mov_b32 v205, 0
 v_mov_b32 v206, 0
 v_mov_b32 v207, 0
 s_nop 1
CZS_75:
 s_waitcnt lgkmcnt(1)
 v_mfma_f32_32x32x16_bf16 v[160:175], v[24:27], v[16:19], v[192:207]
 ds_read_b128 v[32:35], v11 offset:20480
 v_max3_f32 v68, v176, v177, v68
 v_max3_f32 v69, v178, v179, v69
 v_max3_f32 v70, v180, v181, v70
 v_max3_f32 v71, v182, v183, v71
 v_max3_f32 v68, v184, v185, v68
 v_max3_f32 v69, v186, v187, v69
 v_max3_f32 v70, v188, v189, v70
 v_max3_f32 v71, v190, v191, v71
 s_cmp_eq_u32 s84, 4
 s_cbranch_scc0 CZS_76
 s_nop 7
 v_mov_b32 v192, 0
 v_mov_b32 v193, 0
 v_mov_b32 v194, 0
 v_mov_b32 v195, 0
 v_mov_b32 v196, 0
 v_mov_b32 v197, 0
 v_mov_b32 v198, 0
 v_mov_b32 v199, 0
 v_mov_b32 v200, 0
 v_mov_b32 v201, 0
 v_mov_b32 v202, 0
 v_mov_b32 v203, 0
 v_mov_b32 v204, 0
 v_mov_b32 v205, 0
 v_mov_b32 v206, 0
 v_mov_b32 v207, 0
 s_nop 1
CZS_76:
 s_waitcnt lgkmcnt(1)
 v_mfma_f32_32x32x16_bf16 v[176:191], v[28:31], v[16:19], v[192:207]
 ds_read_b128 v[24:27], v11 offset:24576
 v_max3_f32 v68, v224, v225, v68
 v_max3_f32 v69, v226, v227, v69
 v_max3_f32 v70, v228, v229, v70
 v_max3_f32 v71, v230, v231, v71
 v_max3_f32 v68, v232, v233, v68
 v_max3_f32 v69, v234, v235, v69
 v_max3_f32 v70, v236, v237, v70
 v_max3_f32 v71, v238, v239, v71
 s_cmp_eq_u32 s84, 5
 s_cbranch_scc0 CZS_77
 s_nop 7
 v_mov_b32 v192, 0
 v_mov_b32 v193, 0
 v_mov_b32 v194, 0
 v_mov_b32 v195, 0
 v_mov_b32 v196, 0
 v_mov_b32 v197, 0
 v_mov_b32 v198, 0
 v_mov_b32 v199, 0
 v_mov_b32 v200, 0
 v_mov_b32 v201, 0
 v_mov_b32 v202, 0
 v_mov_b32 v203, 0
 v_mov_b32 v204, 0
 v_mov_b32 v205, 0
 v_mov_b32 v206, 0
 v_mov_b32 v207, 0
 s_nop 1
CZS_77:
 s_waitcnt lgkmcnt(1)
 v_mfma_f32_32x32x16_bf16 v[224:239], v[32:35], v[16:19], v[192:207]
 ds_read_b128 v[28:31], v11 offset:28672
 v_max3_f32 v68, v160, v161, v68
 v_max3_f32 v69, v162, v163, v69
 v_max3_f32 v70, v164, v165, v70
 v_max3_f32 v71, v166, v167, v71
 v_max3_f32 v68, v168, v169, v68
 v_max3_f32 v69, v170, v171, v69
 v_max3_f32 v70, v172, v173, v70
 v_max3_f32 v71, v174, v175, v71
 s_cmp_eq_u32 s84, 6
 s_cbranch_scc0 CZS_78
 s_nop 7
 v_mov_b32 v192, 0
 v_mov_b32 v193, 0
 v_mov_b32 v194, 0
 v_mov_b32 v195, 0
 v_mov_b32 v196, 0
 v_mov_b32 v197, 0
 v_mov_b32 v198, 0
 v_mov_b32 v199, 0
 v_mov_b32 v200, 0
 v_mov_b32 v201, 0
 v_mov_b32 v202, 0
 v_mov_b32 v203, 0
 v_mov_b32 v204, 0
 v_mov_b32 v205, 0
 v_mov_b32 v206, 0
 v_mov_b32 v207, 0
 s_nop 1
CZS_78:
 s_waitcnt lgkmcnt(1)
 v_mfma_f32_32x32x16_bf16 v[160:175], v[24:27], v[16:19], v[192:207]
 ds_read_b128 v[32:35], v11 offset:32768
 v_max3_f32 v68, v176, v177, v68
 v_max3_f32 v69, v178, v179, v69
 v_max3_f32 v70, v180, v181, v70
 v_max3_f32 v71, v182, v183, v71
 v_max3_f32 v68, v184, v185, v68
 v_max3_f32 v69, v186, v187, v69
 v_max3_f32 v70, v188, v189, v70
 v_max3_f32 v71, v190, v191, v71
 s_cmp_eq_u32 s84, 7
 s_cbranch_scc0 CZS_79
 s_nop 7
 v_mov_b32 v192, 0
 v_mov_b32 v193, 0
 v_mov_b32 v194, 0
 v_mov_b32 v195, 0
 v_mov_b32 v196, 0
 v_mov_b32 v197, 0
 v_mov_b32 v198, 0
 v_mov_b32 v199, 0
 v_mov_b32 v200, 0
 v_mov_b32 v201, 0
 v_mov_b32 v202, 0
 v_mov_b32 v203, 0
 v_mov_b32 v204, 0
 v_mov_b32 v205, 0
 v_mov_b32 v206, 0
 v_mov_b32 v207, 0
 s_nop 1
CZS_79:
 s_waitcnt lgkmcnt(1)
 v_mfma_f32_32x32x16_bf16 v[176:191], v[28:31], v[16:19], v[192:207]
 ds_read_b128 v[24:27], v11 offset:1024
 v_max3_f32 v68, v224, v225, v68
 v_max3_f32 v69, v226, v227, v69
 v_max3_f32 v70, v228, v229, v70
 v_max3_f32 v71, v230, v231, v71
 v_max3_f32 v68, v232, v233, v68
 v_max3_f32 v69, v234, v235, v69
 v_max3_f32 v70, v236, v237, v70
 v_max3_f32 v71, v238, v239, v71
 s_waitcnt lgkmcnt(1)
 v_mfma_f32_32x32x16_bf16 v[224:239], v[32:35], v[16:19], v[128:143]
 ds_read_b128 v[28:31], v11 offset:5120
 v_max3_f32 v68, v160, v161, v68
 v_max3_f32 v69, v162, v163, v69
 v_max3_f32 v70, v164, v165, v70
 v_max3_f32 v71, v166, v167, v71
 v_max3_f32 v68, v168, v169, v68
 v_max3_f32 v69, v170, v171, v69
 v_max3_f32 v70, v172, v173, v70
 v_max3_f32 v71, v174, v175, v71
 s_cmp_gt_u32 s84, 1
 s_cbranch_scc1 CZA_80
 v_mov_b32 v192, 0
 v_mov_b32 v193, 0
 v_mov_b32 v194, 0
 v_mov_b32 v195, 0
 v_mov_b32 v196, 0
 v_mov_b32 v197, 0
 v_mov_b32 v198, 0
 v_mov_b32 v199, 0
 v_mov_b32 v200, 0
 v_mov_b32 v201, 0
 v_mov_b32 v202, 0
 v_mov_b32 v203, 0
 v_mov_b32 v204, 0
 v_mov_b32 v205, 0
 v_mov_b32 v206, 0
 v_mov_b32 v207, 0
 s_branch CZB_81
CZA_80:
 v_mov_b32 v192, v5
 v_mov_b32 v193, v5
 v_mov_b32 v194, v5
 v_mov_b32 v195, v5
 v_mov_b32 v196, v5
 v_mov_b32 v197, v5
 v_mov_b32 v198, v5
 v_mov_b32 v199, v5
 v_mov_b32 v200, v5
 v_mov_b32 v201, v5
 v_mov_b32 v202, v5
 v_mov_b32 v203, v5
 v_mov_b32 v204, v5
 v_mov_b32 v205, v5
 v_mov_b32 v206, v5
 v_mov_b32 v207, v5
CZB_81:
 s_waitcnt lgkmcnt(1)
 s_nop 0
 v_mfma_f32_32x32x16_bf16 v[160:175], v[24:27], v[20:23], v[144:159]
 ds_read_b128 v[32:35], v11 offset:9216
 v_max3_f32 v68, v176, v177, v68
 v_max3_f32 v69, v178, v179, v69
 v_max3_f32 v70, v180, v181, v70
 v_max3_f32 v71, v182, v183, v71
 v_max3_f32 v68, v184, v185, v68
 v_max3_f32 v69, v186, v187, v69
 v_max3_f32 v70, v188, v189, v70
 v_max3_f32 v71, v190, v191, v71
 s_waitcnt lgkmcnt(1)
 v_mfma_f32_32x32x16_bf16 v[176:191], v[28:31], v[20:23], v[192:207]
 ds_read_b128 v[24:27], v11 offset:13312
 v_max3_f32 v68, v224, v225, v68
 v_max3_f32 v69, v226, v227, v69
 v_max3_f32 v70, v228, v229, v70
 v_max3_f32 v71, v230, v231, v71
 v_max3_f32 v68, v232, v233, v68
 v_max3_f32 v69, v234, v235, v69
 v_max3_f32 v70, v236, v237, v70
 v_max3_f32 v71, v238, v239, v71
 s_cmp_eq_u32 s84, 2
 s_cbranch_scc0 CZS_82
 s_nop 7
 v_mov_b32 v192, 0
 v_mov_b32 v193, 0
 v_mov_b32 v194, 0
 v_mov_b32 v195, 0
 v_mov_b32 v196, 0
 v_mov_b32 v197, 0
 v_mov_b32 v198, 0
 v_mov_b32 v199, 0
 v_mov_b32 v200, 0
 v_mov_b32 v201, 0
 v_mov_b32 v202, 0
 v_mov_b32 v203, 0
 v_mov_b32 v204, 0
 v_mov_b32 v205, 0
 v_mov_b32 v206, 0
 v_mov_b32 v207, 0
 s_nop 1
CZS_82:
 s_waitcnt lgkmcnt(1)
 v_mfma_f32_32x32x16_bf16 v[224:239], v[32:35], v[20:23], v[192:207]
 ds_read_b128 v[28:31], v11 offset:17408
 v_max3_f32 v72, v160, v161, v72
 v_max3_f32 v73, v162, v163, v73
 v_max3_f32 v74, v164, v165, v74
 v_max3_f32 v75, v166, v167, v75
 v_max3_f32 v72, v168, v169, v72
 v_max3_f32 v73, v170, v171, v73
 v_max3_f32 v74, v172, v173, v74
 v_max3_f32 v75, v174, v175, v75
 s_cmp_eq_u32 s84, 3
 s_cbranch_scc0 CZS_83
 s_nop 7
 v_mov_b32 v192, 0
 v_mov_b32 v193, 0
 v_mov_b32 v194, 0
 v_mov_b32 v195, 0
 v_mov_b32 v196, 0
 v_mov_b32 v197, 0
 v_mov_b32 v198, 0
 v_mov_b32 v199, 0
 v_mov_b32 v200, 0
 v_mov_b32 v201, 0
 v_mov_b32 v202, 0
 v_mov_b32 v203, 0
 v_mov_b32 v204, 0
 v_mov_b32 v205, 0
 v_mov_b32 v206, 0
 v_mov_b32 v207, 0
 s_nop 1
CZS_83:
 s_waitcnt lgkmcnt(1)
 v_mfma_f32_32x32x16_bf16 v[160:175], v[24:27], v[20:23], v[192:207]
 ds_read_b128 v[32:35], v11 offset:21504
 v_max3_f32 v72, v176, v177, v72
 v_max3_f32 v73, v178, v179, v73
 v_max3_f32 v74, v180, v181, v74
 v_max3_f32 v75, v182, v183, v75
 v_max3_f32 v72, v184, v185, v72
 v_max3_f32 v73, v186, v187, v73
 v_max3_f32 v74, v188, v189, v74
 v_max3_f32 v75, v190, v191, v75
 s_cmp_eq_u32 s84, 4
 s_cbranch_scc0 CZS_84
 s_nop 7
 v_mov_b32 v192, 0
 v_mov_b32 v193, 0
 v_mov_b32 v194, 0
 v_mov_b32 v195, 0
 v_mov_b32 v196, 0
 v_mov_b32 v197, 0
 v_mov_b32 v198, 0
 v_mov_b32 v199, 0
 v_mov_b32 v200, 0
 v_mov_b32 v201, 0
 v_mov_b32 v202, 0
 v_mov_b32 v203, 0
 v_mov_b32 v204, 0
 v_mov_b32 v205, 0
 v_mov_b32 v206, 0
 v_mov_b32 v207, 0
 s_nop 1
CZS_84:
 s_waitcnt lgkmcnt(1)
 v_mfma_f32_32x32x16_bf16 v[176:191], v[28:31], v[20:23], v[192:207]
 ds_read_b128 v[24:27], v11 offset:25600
 v_max3_f32 v72, v224, v225, v72
 v_max3_f32 v73, v226, v227, v73
 v_max3_f32 v74, v228, v229, v74
 v_max3_f32 v75, v230, v231, v75
 v_max3_f32 v72, v232, v233, v72
 v_max3_f32 v73, v234, v235, v73
 v_max3_f32 v74, v236, v237, v74
 v_max3_f32 v75, v238, v239, v75
 s_cmp_eq_u32 s84, 5
 s_cbranch_scc0 CZS_85
 s_nop 7
 v_mov_b32 v192, 0
 v_mov_b32 v193, 0
 v_mov_b32 v194, 0
 v_mov_b32 v195, 0
 v_mov_b32 v196, 0
 v_mov_b32 v197, 0
 v_mov_b32 v198, 0
 v_mov_b32 v199, 0
 v_mov_b32 v200, 0
 v_mov_b32 v201, 0
 v_mov_b32 v202, 0
 v_mov_b32 v203, 0
 v_mov_b32 v204, 0
 v_mov_b32 v205, 0
 v_mov_b32 v206, 0
 v_mov_b32 v207, 0
 s_nop 1
CZS_85:
 s_waitcnt lgkmcnt(1)
 v_mfma_f32_32x32x16_bf16 v[224:239], v[32:35], v[20:23], v[192:207]
 ds_read_b128 v[28:31], v11 offset:29696
 v_max3_f32 v72, v160, v161, v72
 v_max3_f32 v73, v162, v163, v73
 v_max3_f32 v74, v164, v165, v74
 v_max3_f32 v75, v166, v167, v75
 v_max3_f32 v72, v168, v169, v72
 v_max3_f32 v73, v170, v171, v73
 v_max3_f32 v74, v172, v173, v74
 v_max3_f32 v75, v174, v175, v75
 s_cmp_eq_u32 s84, 6
 s_cbranch_scc0 CZS_86
 s_nop 7
 v_mov_b32 v192, 0
 v_mov_b32 v193, 0
 v_mov_b32 v194, 0
 v_mov_b32 v195, 0
 v_mov_b32 v196, 0
 v_mov_b32 v197, 0
 v_mov_b32 v198, 0
 v_mov_b32 v199, 0
 v_mov_b32 v200, 0
 v_mov_b32 v201, 0
 v_mov_b32 v202, 0
 v_mov_b32 v203, 0
 v_mov_b32 v204, 0
 v_mov_b32 v205, 0
 v_mov_b32 v206, 0
 v_mov_b32 v207, 0
 s_nop 1
CZS_86:
 s_waitcnt lgkmcnt(1)
 v_mfma_f32_32x32x16_bf16 v[160:175], v[24:27], v[20:23], v[192:207]
 ds_read_b128 v[32:35], v11 offset:33792
 v_max3_f32 v72, v176, v177, v72
 v_max3_f32 v73, v178, v179, v73
 v_max3_f32 v74, v180, v181, v74
 v_max3_f32 v75, v182, v183, v75
 v_max3_f32 v72, v184, v185, v72
 v_max3_f32 v73, v186, v187, v73
 v_max3_f32 v74, v188, v189, v74
 v_max3_f32 v75, v190, v191, v75
 s_cmp_eq_u32 s84, 7
 s_cbranch_scc0 CZS_87
 s_nop 7
 v_mov_b32 v192, 0
 v_mov_b32 v193, 0
 v_mov_b32 v194, 0
 v_mov_b32 v195, 0
 v_mov_b32 v196, 0
 v_mov_b32 v197, 0
 v_mov_b32 v198, 0
 v_mov_b32 v199, 0
 v_mov_b32 v200, 0
 v_mov_b32 v201, 0
 v_mov_b32 v202, 0
 v_mov_b32 v203, 0
 v_mov_b32 v204, 0
 v_mov_b32 v205, 0
 v_mov_b32 v206, 0
 v_mov_b32 v207, 0
 s_nop 1
CZS_87:
 s_waitcnt lgkmcnt(1)
 v_mfma_f32_32x32x16_bf16 v[176:191], v[28:31], v[20:23], v[192:207]
 v_max3_f32 v72, v224, v225, v72
 v_max3_f32 v73, v226, v227, v73
 v_max3_f32 v74, v228, v229, v74
 v_max3_f32 v75, v230, v231, v75
 v_max3_f32 v72, v232, v233, v72
 v_max3_f32 v73, v234, v235, v73
 v_max3_f32 v74, v236, v237, v74
 v_max3_f32 v75, v238, v239, v75
 s_waitcnt lgkmcnt(0)
 v_mfma_f32_32x32x16_bf16 v[224:239], v[32:35], v[20:23], v[128:143]
 v_max3_f32 v72, v160, v161, v72
 v_max3_f32 v73, v162, v163, v73
 v_max3_f32 v74, v164, v165, v74
 v_max3_f32 v75, v166, v167, v75
 v_max3_f32 v72, v168, v169, v72
 v_max3_f32 v73, v170, v171, v73
 v_max3_f32 v74, v172, v173, v74
 v_max3_f32 v75, v174, v175, v75
 v_max3_f32 v72, v176, v177, v72
 v_max3_f32 v73, v178, v179, v73
 v_max3_f32 v74, v180, v181, v74
 v_max3_f32 v75, v182, v183, v75
 v_max3_f32 v72, v184, v185, v72
 v_max3_f32 v73, v186, v187, v73
 v_max3_f32 v74, v188, v189, v74
 v_max3_f32 v75, v190, v191, v75
 s_nop 3
 v_max3_f32 v72, v224, v225, v72
 v_max3_f32 v73, v226, v227, v73
 v_max3_f32 v74, v228, v229, v74
 v_max3_f32 v75, v230, v231, v75
 v_max3_f32 v72, v232, v233, v72
 v_max3_f32 v73, v234, v235, v73
 v_max3_f32 v74, v236, v237, v74
 v_max3_f32 v75, v238, v239, v75
 v_max3_f32 v68, v68, v69, v70
 v_max3_f32 v72, v72, v73, v74
 v_max_f32 v68, v68, v71
 v_max_f32 v72, v72, v75
 v_mov_b32 v76, v68
 v_mov_b32 v77, v72
 s_nop 1
 v_permlane32_swap_b32 v68, v76
 v_permlane32_swap_b32 v72, v77
 s_nop 0
 v_max_f32 v68, v68, v76
 v_max_f32 v72, v72, v77
 v_sub_f32 v76, 0, v68
 v_sub_f32 v77, 0, v72
 v_mov_b32 v52, 0x3f803f80
 v_mov_b32 v53, 0x3f803f80
 v_mov_b32 v54, 0x3f803f80
 v_mov_b32 v55, 0x3f803f80
 v_mov_b32 v56, 0x3f803f80
 v_mov_b32 v57, 0x3f803f80
 v_mov_b32 v58, 0x3f803f80
 v_mov_b32 v59, 0x3f803f80
 v_mov_b32 v60, 0x3f803f80
 v_mov_b32 v61, 0x3f803f80
 v_mov_b32 v62, 0x3f803f80
 v_mov_b32 v63, 0x3f803f80
 v_mov_b32 v64, 0x3f803f80
 v_mov_b32 v65, 0x3f803f80
 v_mov_b32 v66, 0x3f803f80
 v_mov_b32 v67, 0x3f803f80
 v_mov_b32 v80, 0x3f803f80
 v_mov_b32 v81, 0x3f803f80
 v_mov_b32 v82, 0x3f803f80
 v_mov_b32 v83, 0x3f803f80
 v_mov_b32 v84, 0x3f803f80
 v_mov_b32 v85, 0x3f803f80
 v_mov_b32 v86, 0x3f803f80
 v_mov_b32 v87, 0x3f803f80
 v_mov_b32 v88, 0x3f803f80
 v_mov_b32 v89, 0x3f803f80
 v_mov_b32 v90, 0x3f803f80
 v_mov_b32 v91, 0x3f803f80
 v_mov_b32 v92, 0x3f803f80
 v_mov_b32 v93, 0x3f803f80
 v_mov_b32 v94, 0x3f803f80
 v_mov_b32 v95, 0x3f803f80
 v_mov_b32 v8, 147464
 s_cmp_ge_u32 s38, 2
 s_cbranch_scc0 NPUB_88
 s_cmp_eq_u32 s98, 1
 s_cbranch_scc1 VE_89
 s_cmp_eq_u32 s94, 1
 s_cbranch_scc1 RSK_90
 s_mov_b32 s39, 1048576
SPL_91:
 s_load_dword s8, s[64:65], s99 glc
SPF_93:
 s_waitcnt lgkmcnt(0)
 s_cmp_lg_u32 s8, s31
 s_cbranch_scc0 SPD_92
 s_sub_u32 s39, s39, 1
 s_cbranch_scc0 SPL_91
 v_mov_b32 v29, 261
 v_mov_b32 v30, 0
 global_store_dword v30, v29, s[68:69]
 s_waitcnt vmcnt(0)
SPD_92:
 s_add_u32 m0, s86, 2048
 s_add_u32 s82, s88, 2048
 buffer_load_dwordx4 v7, s[64:67], s82 offen sc1 lds
 s_add_u32 m0, s86, 3072
 s_add_u32 s82, s88, 3072
 buffer_load_dwordx4 v7, s[64:67], s82 offen sc1 lds
 s_add_u32 m0, s86, 6144
 s_add_u32 s82, s88, 67584
 buffer_load_dwordx4 v7, s[64:67], s82 offen sc1 lds
 s_add_u32 m0, s86, 7168
 s_add_u32 s82, s88, 68608
 buffer_load_dwordx4 v7, s[64:67], s82 offen sc1 lds
 s_add_u32 m0, s86, 10240
 s_add_u32 s82, s88, 133120
 buffer_load_dwordx4 v7, s[64:67], s82 offen sc1 lds
 s_add_u32 m0, s86, 11264
 s_add_u32 s82, s88, 134144
 buffer_load_dwordx4 v7, s[64:67], s82 offen sc1 lds
 s_add_u32 m0, s86, 14336
 s_add_u32 s82, s88, 198656
 buffer_load_dwordx4 v7, s[64:67], s82 offen sc1 lds
 s_add_u32 m0, s86, 15360
 s_add_u32 s82, s88, 199680
 buffer_load_dwordx4 v7, s[64:67], s82 offen sc1 lds
 s_mov_b32 s94, 1
RSK_90:
 s_waitcnt vmcnt(0)
VE_89:
 v_mov_b32 v9, 1
 s_mov_b64 exec, 1
 ds_add_u32 v8, v9
 s_mov_b64 exec, -1
NPUB_88:
 s_mov_b32 s39, 1048576
LSP_94:
 ds_read_b32 v9, v8
 s_waitcnt lgkmcnt(0)
 v_cmp_ne_u32 vcc, 2, v9
 s_nop 0
 s_cbranch_vccz LSD_95
 s_sub_u32 s39, s39, 1
 s_cbranch_scc0 LSP_94
LSD_95:
 ds_read_b128 v[24:27], v11 offset:0
 ds_read_b128 v[28:31], v11 offset:4096
 v_add_f32 v208, v144, v76
 v_add_f32 v209, v145, v76
 v_add_f32 v210, v146, v76
 v_add_f32 v211, v147, v76
 v_add_f32 v212, v148, v76
 v_add_f32 v213, v149, v76
 v_add_f32 v214, v150, v76
 v_add_f32 v215, v151, v76
 v_add_f32 v216, v152, v76
 v_add_f32 v217, v153, v76
 v_add_f32 v218, v154, v76
 v_add_f32 v219, v155, v76
 v_add_f32 v220, v156, v76
 v_add_f32 v221, v157, v76
 v_add_f32 v222, v158, v76
 v_add_f32 v223, v159, v76
 s_cmp_gt_u32 s84, 1
 s_cbranch_scc1 CZA_96
 v_mov_b32 v192, v76
 v_mov_b32 v193, v76
 v_mov_b32 v194, v76
 v_mov_b32 v195, v76
 v_mov_b32 v196, v76
 v_mov_b32 v197, v76
 v_mov_b32 v198, v76
 v_mov_b32 v199, v76
 v_mov_b32 v200, v76
 v_mov_b32 v201, v76
 v_mov_b32 v202, v76
 v_mov_b32 v203, v76
 v_mov_b32 v204, v76
 v_mov_b32 v205, v76
 v_mov_b32 v206, v76
 v_mov_b32 v207, v76
 s_branch CZB_97
CZA_96:
 v_mov_b32 v192, v5
 v_mov_b32 v193, v5
 v_mov_b32 v194, v5
 v_mov_b32 v195, v5
 v_mov_b32 v196, v5
 v_mov_b32 v197, v5
 v_mov_b32 v198, v5
 v_mov_b32 v199, v5
 v_mov_b32 v200, v5
 v_mov_b32 v201, v5
 v_mov_b32 v202, v5
 v_mov_b32 v203, v5
 v_mov_b32 v204, v5
 v_mov_b32 v205, v5
 v_mov_b32 v206, v5
 v_mov_b32 v207, v5
CZB_97:
 s_waitcnt lgkmcnt(1)
 s_nop 0
 v_mfma_f32_32x32x16_bf16 v[160:175], v[24:27], v[16:19], v[208:223]
 s_mov_b32 exec_lo, 0x0000ffff
 s_mov_b32 exec_hi, 0x0000ffff
 ds_read_b128 v[52:55], v11 offset:2048
 ds_read_b128 v[56:59], v11 offset:3072
 s_mov_b64 exec, -1
 ds_read_b128 v[32:35], v11 offset:8192
 s_waitcnt lgkmcnt(3)
 v_mfma_f32_32x32x16_bf16 v[176:191], v[28:31], v[16:19], v[192:207]
 s_nop 9
 v_exp_f32 v160, v160
 v_exp_f32 v161, v161
 v_exp_f32 v162, v162
 v_exp_f32 v163, v163
 v_exp_f32 v164, v164
 v_exp_f32 v165, v165
 v_cvt_pk_bf16_f32 v36, v160, v161
 v_exp_f32 v166, v166
 v_exp_f32 v167, v167
 v_cvt_pk_bf16_f32 v37, v162, v163
 v_exp_f32 v168, v168
 v_exp_f32 v169, v169
 v_cvt_pk_bf16_f32 v38, v164, v165
 v_exp_f32 v170, v170
 v_exp_f32 v171, v171
 v_cvt_pk_bf16_f32 v39, v166, v167
 v_exp_f32 v172, v172
 v_exp_f32 v173, v173
 v_cvt_pk_bf16_f32 v40, v168, v169
 v_exp_f32 v174, v174
 v_exp_f32 v175, v175
 v_cvt_pk_bf16_f32 v41, v170, v171
 v_cvt_pk_bf16_f32 v42, v172, v173
 v_cvt_pk_bf16_f32 v43, v174, v175
 ds_read_b128 v[24:27], v11 offset:12288
 s_cmp_eq_u32 s84, 2
 s_cbranch_scc0 CZS_98
 s_nop 7
 v_mov_b32 v192, v76
 v_mov_b32 v193, v76
 v_mov_b32 v194, v76
 v_mov_b32 v195, v76
 v_mov_b32 v196, v76
 v_mov_b32 v197, v76
 v_mov_b32 v198, v76
 v_mov_b32 v199, v76
 v_mov_b32 v200, v76
 v_mov_b32 v201, v76
 v_mov_b32 v202, v76
 v_mov_b32 v203, v76
 v_mov_b32 v204, v76
 v_mov_b32 v205, v76
 v_mov_b32 v206, v76
 v_mov_b32 v207, v76
 s_nop 1
CZS_98:
 s_waitcnt lgkmcnt(1)
 v_mfma_f32_32x32x16_bf16 v[160:175], v[32:35], v[16:19], v[192:207]
 v_exp_f32 v176, v176
 v_exp_f32 v177, v177
 v_exp_f32 v178, v178
 v_exp_f32 v179, v179
 v_exp_f32 v180, v180
 s_waitcnt lgkmcnt(2)
 v_mfma_f32_32x32x16_bf16 v[96:111], v[52:55], v[36:39], 0
 v_exp_f32 v181, v181
 v_cvt_pk_bf16_f32 v44, v176, v177
 v_exp_f32 v182, v182
 v_exp_f32 v183, v183
 v_cvt_pk_bf16_f32 v45, v178, v179
 v_exp_f32 v184, v184
 v_mfma_f32_32x32x16_bf16 v[96:111], v[56:59], v[40:43], v[96:111]
 v_exp_f32 v185, v185
 v_cvt_pk_bf16_f32 v46, v180, v181
 v_exp_f32 v186, v186
 s_mov_b32 exec_lo, 0x0000ffff
 s_mov_b32 exec_hi, 0x0000ffff
 ds_read_b128 v[60:63], v11 offset:6144
 ds_read_b128 v[64:67], v11 offset:7168
 s_mov_b64 exec, -1
 v_exp_f32 v187, v187
 v_cvt_pk_bf16_f32 v47, v182, v183
 v_exp_f32 v188, v188
 v_exp_f32 v189, v189
 v_cvt_pk_bf16_f32 v48, v184, v185
 v_exp_f32 v190, v190
 v_exp_f32 v191, v191
 v_cvt_pk_bf16_f32 v49, v186, v187
 v_cvt_pk_bf16_f32 v50, v188, v189
 v_cvt_pk_bf16_f32 v51, v190, v191
 ds_read_b128 v[28:31], v11 offset:16384
 s_cmp_eq_u32 s84, 3
 s_cbranch_scc0 CZS_99
 s_nop 7
 v_mov_b32 v192, v76
 v_mov_b32 v193, v76
 v_mov_b32 v194, v76
 v_mov_b32 v195, v76
 v_mov_b32 v196, v76
 v_mov_b32 v197, v76
 v_mov_b32 v198, v76
 v_mov_b32 v199, v76
 v_mov_b32 v200, v76
 v_mov_b32 v201, v76
 v_mov_b32 v202, v76
 v_mov_b32 v203, v76
 v_mov_b32 v204, v76
 v_mov_b32 v205, v76
 v_mov_b32 v206, v76
 v_mov_b32 v207, v76
 s_nop 1
CZS_99:
 s_waitcnt lgkmcnt(3)
 v_mfma_f32_32x32x16_bf16 v[176:191], v[24:27], v[16:19], v[192:207]
 v_exp_f32 v160, v160
 v_exp_f32 v161, v161
 v_exp_f32 v162, v162
 v_exp_f32 v163, v163
 v_exp_f32 v164, v164
 s_waitcnt lgkmcnt(1)
 v_mfma_f32_32x32x16_bf16 v[96:111], v[60:63], v[44:47], v[96:111]
 v_exp_f32 v165, v165
 v_cvt_pk_bf16_f32 v36, v160, v161
 v_exp_f32 v166, v166
 v_exp_f32 v167, v167
 v_cvt_pk_bf16_f32 v37, v162, v163
 v_exp_f32 v168, v168
 v_mfma_f32_32x32x16_bf16 v[96:111], v[64:67], v[48:51], v[96:111]
 v_exp_f32 v169, v169
 v_cvt_pk_bf16_f32 v38, v164, v165
 v_exp_f32 v170, v170
 s_mov_b32 exec_lo, 0x0000ffff
 s_mov_b32 exec_hi, 0x0000ffff
 ds_read_b128 v[52:55], v11 offset:10240
 ds_read_b128 v[56:59], v11 offset:11264
 s_mov_b64 exec, -1
 v_exp_f32 v171, v171
 v_cvt_pk_bf16_f32 v39, v166, v167
 v_exp_f32 v172, v172
 v_exp_f32 v173, v173
 v_cvt_pk_bf16_f32 v40, v168, v169
 v_exp_f32 v174, v174
 v_exp_f32 v175, v175
 v_cvt_pk_bf16_f32 v41, v170, v171
 v_cvt_pk_bf16_f32 v42, v172, v173
 v_cvt_pk_bf16_f32 v43, v174, v175
 ds_read_b128 v[32:35], v11 offset:20480
 s_cmp_eq_u32 s84, 4
 s_cbranch_scc0 CZS_100
 s_nop 7
 v_mov_b32 v192, v76
 v_mov_b32 v193, v76
 v_mov_b32 v194, v76
 v_mov_b32 v195, v76
 v_mov_b32 v196, v76
 v_mov_b32 v197, v76
 v_mov_b32 v198, v76
 v_mov_b32 v199, v76
 v_mov_b32 v200, v76
 v_mov_b32 v201, v76
 v_mov_b32 v202, v76
 v_mov_b32 v203, v76
 v_mov_b32 v204, v76
 v_mov_b32 v205, v76
 v_mov_b32 v206, v76
 v_mov_b32 v207, v76
 s_nop 1
CZS_100:
 s_waitcnt lgkmcnt(3)
 v_mfma_f32_32x32x16_bf16 v[160:175], v[28:31], v[16:19], v[192:207]
 v_exp_f32 v176, v176
 v_exp_f32 v177, v177
 v_exp_f32 v178, v178
 v_exp_f32 v179, v179
 v_exp_f32 v180, v180
 s_waitcnt lgkmcnt(1)
 v_mfma_f32_32x32x16_bf16 v[96:111], v[52:55], v[36:39], v[96:111]
 v_exp_f32 v181, v181
 v_cvt_pk_bf16_f32 v44, v176, v177
 v_exp_f32 v182, v182
 v_exp_f32 v183, v183
 v_cvt_pk_bf16_f32 v45, v178, v179
 v_exp_f32 v184, v184
 v_mfma_f32_32x32x16_bf16 v[96:111], v[56:59], v[40:43], v[96:111]
 v_exp_f32 v185, v185
 v_cvt_pk_bf16_f32 v46, v180, v181
 v_exp_f32 v186, v186
 s_mov_b32 exec_lo, 0x0000ffff
 s_mov_b32 exec_hi, 0x0000ffff
 ds_read_b128 v[60:63], v11 offset:14336
 ds_read_b128 v[64:67], v11 offset:15360
 s_mov_b64 exec, -1
 v_exp_f32 v187, v187
 v_cvt_pk_bf16_f32 v47, v182, v183
 v_exp_f32 v188, v188
 v_exp_f32 v189, v189
 v_cvt_pk_bf16_f32 v48, v184, v185
 v_exp_f32 v190, v190
 v_exp_f32 v191, v191
 v_cvt_pk_bf16_f32 v49, v186, v187
 v_cvt_pk_bf16_f32 v50, v188, v189
 v_cvt_pk_bf16_f32 v51, v190, v191
 ds_read_b128 v[24:27], v11 offset:24576
 s_cmp_eq_u32 s84, 5
 s_cbranch_scc0 CZS_101
 s_nop 7
 v_mov_b32 v192, v76
 v_mov_b32 v193, v76
 v_mov_b32 v194, v76
 v_mov_b32 v195, v76
 v_mov_b32 v196, v76
 v_mov_b32 v197, v76
 v_mov_b32 v198, v76
 v_mov_b32 v199, v76
 v_mov_b32 v200, v76
 v_mov_b32 v201, v76
 v_mov_b32 v202, v76
 v_mov_b32 v203, v76
 v_mov_b32 v204, v76
 v_mov_b32 v205, v76
 v_mov_b32 v206, v76
 v_mov_b32 v207, v76
 s_nop 1
CZS_101:
 s_waitcnt lgkmcnt(3)
 v_mfma_f32_32x32x16_bf16 v[176:191], v[32:35], v[16:19], v[192:207]
 v_exp_f32 v160, v160
 v_exp_f32 v161, v161
 v_exp_f32 v162, v162
 v_exp_f32 v163, v163
 v_exp_f32 v164, v164
 s_waitcnt lgkmcnt(1)
 v_mfma_f32_32x32x16_bf16 v[96:111], v[60:63], v[44:47], v[96:111]
 v_exp_f32 v165, v165
 v_cvt_pk_bf16_f32 v36, v160, v161
 v_exp_f32 v166, v166
 v_exp_f32 v167, v167
 v_cvt_pk_bf16_f32 v37, v162, v163
 v_exp_f32 v168, v168
 v_mfma_f32_32x32x16_bf16 v[96:111], v[64:67], v[48:51], v[96:111]
 v_exp_f32 v169, v169
 v_cvt_pk_bf16_f32 v38, v164, v165
 v_exp_f32 v170, v170
 s_mov_b32 exec_lo, 0x0000ffff
 s_mov_b32 exec_hi, 0x0000ffff
 ds_read_b128 v[52:55], v11 offset:18432
 ds_read_b128 v[56:59], v11 offset:19456
 s_mov_b64 exec, -1
 v_exp_f32 v171, v171
 v_cvt_pk_bf16_f32 v39, v166, v167
 v_exp_f32 v172, v172
 v_exp_f32 v173, v173
 v_cvt_pk_bf16_f32 v40, v168, v169
 v_exp_f32 v174, v174
 v_exp_f32 v175, v175
 v_cvt_pk_bf16_f32 v41, v170, v171
 v_cvt_pk_bf16_f32 v42, v172, v173
 v_cvt_pk_bf16_f32 v43, v174, v175
 ds_read_b128 v[28:31], v11 offset:28672
 s_cmp_eq_u32 s84, 6
 s_cbranch_scc0 CZS_102
 s_nop 7
 v_mov_b32 v192, v76
 v_mov_b32 v193, v76
 v_mov_b32 v194, v76
 v_mov_b32 v195, v76
 v_mov_b32 v196, v76
 v_mov_b32 v197, v76
 v_mov_b32 v198, v76
 v_mov_b32 v199, v76
 v_mov_b32 v200, v76
 v_mov_b32 v201, v76
 v_mov_b32 v202, v76
 v_mov_b32 v203, v76
 v_mov_b32 v204, v76
 v_mov_b32 v205, v76
 v_mov_b32 v206, v76
 v_mov_b32 v207, v76
 s_nop 1
CZS_102:
 s_waitcnt lgkmcnt(3)
 v_mfma_f32_32x32x16_bf16 v[160:175], v[24:27], v[16:19], v[192:207]
 v_exp_f32 v176, v176
 v_exp_f32 v177, v177
 v_exp_f32 v178, v178
 v_exp_f32 v179, v179
 v_exp_f32 v180, v180
 s_waitcnt lgkmcnt(1)
 v_mfma_f32_32x32x16_bf16 v[96:111], v[52:55], v[36:39], v[96:111]
 v_exp_f32 v181, v181
 v_cvt_pk_bf16_f32 v44, v176, v177
 v_exp_f32 v182, v182
 v_exp_f32 v183, v183
 v_cvt_pk_bf16_f32 v45, v178, v179
 v_exp_f32 v184, v184
 v_mfma_f32_32x32x16_bf16 v[96:111], v[56:59], v[40:43], v[96:111]
 v_exp_f32 v185, v185
 v_cvt_pk_bf16_f32 v46, v180, v181
 v_exp_f32 v186, v186
 s_mov_b32 exec_lo, 0x0000ffff
 s_mov_b32 exec_hi, 0x0000ffff
 ds_read_b128 v[60:63], v11 offset:22528
 ds_read_b128 v[64:67], v11 offset:23552
 s_mov_b64 exec, -1
 v_exp_f32 v187, v187
 v_cvt_pk_bf16_f32 v47, v182, v183
 v_exp_f32 v188, v188
 v_exp_f32 v189, v189
 v_cvt_pk_bf16_f32 v48, v184, v185
 v_exp_f32 v190, v190
 v_exp_f32 v191, v191
 v_cvt_pk_bf16_f32 v49, v186, v187
 v_cvt_pk_bf16_f32 v50, v188, v189
 v_cvt_pk_bf16_f32 v51, v190, v191
 ds_read_b128 v[32:35], v11 offset:32768
 s_cmp_eq_u32 s84, 7
 s_cbranch_scc0 CZS_103
 s_nop 7
 v_mov_b32 v192, v76
 v_mov_b32 v193, v76
 v_mov_b32 v194, v76
 v_mov_b32 v195, v76
 v_mov_b32 v196, v76
 v_mov_b32 v197, v76
 v_mov_b32 v198, v76
 v_mov_b32 v199, v76
 v_mov_b32 v200, v76
 v_mov_b32 v201, v76
 v_mov_b32 v202, v76
 v_mov_b32 v203, v76
 v_mov_b32 v204, v76
 v_mov_b32 v205, v76
 v_mov_b32 v206, v76
 v_mov_b32 v207, v76
 s_nop 1
CZS_103:
 s_waitcnt lgkmcnt(3)
 v_mfma_f32_32x32x16_bf16 v[176:191], v[28:31], v[16:19], v[192:207]
 v_exp_f32 v160, v160
 v_exp_f32 v161, v161
 v_exp_f32 v162, v162
 v_exp_f32 v163, v163
 v_exp_f32 v164, v164
 s_waitcnt lgkmcnt(1)
 v_mfma_f32_32x32x16_bf16 v[96:111], v[60:63], v[44:47], v[96:111]
 v_exp_f32 v165, v165
 v_cvt_pk_bf16_f32 v36, v160, v161
 v_exp_f32 v166, v166
 v_exp_f32 v167, v167
 v_cvt_pk_bf16_f32 v37, v162, v163
 v_exp_f32 v168, v168
 v_mfma_f32_32x32x16_bf16 v[96:111], v[64:67], v[48:51], v[96:111]
 v_exp_f32 v169, v169
 v_cvt_pk_bf16_f32 v38, v164, v165
 v_exp_f32 v170, v170
 s_mov_b32 exec_lo, 0x0000ffff
 s_mov_b32 exec_hi, 0x0000ffff
 ds_read_b128 v[52:55], v11 offset:26624
 ds_read_b128 v[56:59], v11 offset:27648
 s_mov_b64 exec, -1
 v_exp_f32 v171, v171
 v_cvt_pk_bf16_f32 v39, v166, v167
 v_exp_f32 v172, v172
 v_exp_f32 v173, v173
 v_cvt_pk_bf16_f32 v40, v168, v169
 v_exp_f32 v174, v174
 v_exp_f32 v175, v175
 v_cvt_pk_bf16_f32 v41, v170, v171
 v_cvt_pk_bf16_f32 v42, v172, v173
 v_cvt_pk_bf16_f32 v43, v174, v175
 ds_read_b128 v[24:27], v11 offset:1024
 v_add_f32 v208, v128, v76
 v_add_f32 v209, v129, v76
 v_add_f32 v210, v130, v76
 v_add_f32 v211, v131, v76
 v_add_f32 v212, v132, v76
 v_add_f32 v213, v133, v76
 v_add_f32 v214, v134, v76
 v_add_f32 v215, v135, v76
 v_add_f32 v216, v136, v76
 v_add_f32 v217, v137, v76
 v_add_f32 v218, v138, v76
 v_add_f32 v219, v139, v76
 v_add_f32 v220, v140, v76
 v_add_f32 v221, v141, v76
 v_add_f32 v222, v142, v76
 v_add_f32 v223, v143, v76
 s_nop 0
 s_waitcnt lgkmcnt(3)
 v_mfma_f32_32x32x16_bf16 v[160:175], v[32:35], v[16:19], v[208:223]
 v_exp_f32 v176, v176
 v_exp_f32 v177, v177
 v_exp_f32 v178, v178
 v_exp_f32 v179, v179
 v_exp_f32 v180, v180
 s_waitcnt lgkmcnt(1)
 v_mfma_f32_32x32x16_bf16 v[96:111], v[52:55], v[36:39], v[96:111]
 v_exp_f32 v181, v181
 v_cvt_pk_bf16_f32 v44, v176, v177
 v_exp_f32 v182, v182
 v_exp_f32 v183, v183
 v_cvt_pk_bf16_f32 v45, v178, v179
 v_exp_f32 v184, v184
 v_mfma_f32_32x32x16_bf16 v[96:111], v[56:59], v[40:43], v[96:111]
 v_exp_f32 v185, v185
 v_cvt_pk_bf16_f32 v46, v180, v181
 v_exp_f32 v186, v186
 s_mov_b32 exec_lo, 0x0000ffff
 s_mov_b32 exec_hi, 0x0000ffff
 ds_read_b128 v[60:63], v11 offset:30720
 ds_read_b128 v[64:67], v11 offset:31744
 s_mov_b64 exec, -1
 v_exp_f32 v187, v187
 v_cvt_pk_bf16_f32 v47, v182, v183
 v_exp_f32 v188, v188
 v_exp_f32 v189, v189
 v_cvt_pk_bf16_f32 v48, v184, v185
 v_exp_f32 v190, v190
 v_exp_f32 v191, v191
 v_cvt_pk_bf16_f32 v49, v186, v187
 v_cvt_pk_bf16_f32 v50, v188, v189
 v_cvt_pk_bf16_f32 v51, v190, v191
 ds_read_b128 v[28:31], v11 offset:5120
 v_add_f32 v208, v144, v77
 v_add_f32 v209, v145, v77
 v_add_f32 v210, v146, v77
 v_add_f32 v211, v147, v77
 v_add_f32 v212, v148, v77
 v_add_f32 v213, v149, v77
 v_add_f32 v214, v150, v77
 v_add_f32 v215, v151, v77
 v_add_f32 v216, v152, v77
 v_add_f32 v217, v153, v77
 v_add_f32 v218, v154, v77
 v_add_f32 v219, v155, v77
 v_add_f32 v220, v156, v77
 v_add_f32 v221, v157, v77
 v_add_f32 v222, v158, v77
 v_add_f32 v223, v159, v77
 s_cmp_gt_u32 s84, 1
 s_cbranch_scc1 CZA_104
 v_mov_b32 v192, v77
 v_mov_b32 v193, v77
 v_mov_b32 v194, v77
 v_mov_b32 v195, v77
 v_mov_b32 v196, v77
 v_mov_b32 v197, v77
 v_mov_b32 v198, v77
 v_mov_b32 v199, v77
 v_mov_b32 v200, v77
 v_mov_b32 v201, v77
 v_mov_b32 v202, v77
 v_mov_b32 v203, v77
 v_mov_b32 v204, v77
 v_mov_b32 v205, v77
 v_mov_b32 v206, v77
 v_mov_b32 v207, v77
 s_branch CZB_105
CZA_104:
 v_mov_b32 v192, v5
 v_mov_b32 v193, v5
 v_mov_b32 v194, v5
 v_mov_b32 v195, v5
 v_mov_b32 v196, v5
 v_mov_b32 v197, v5
 v_mov_b32 v198, v5
 v_mov_b32 v199, v5
 v_mov_b32 v200, v5
 v_mov_b32 v201, v5
 v_mov_b32 v202, v5
 v_mov_b32 v203, v5
 v_mov_b32 v204, v5
 v_mov_b32 v205, v5
 v_mov_b32 v206, v5
 v_mov_b32 v207, v5
CZB_105:
 s_waitcnt lgkmcnt(3)
 v_mfma_f32_32x32x16_bf16 v[176:191], v[24:27], v[20:23], v[208:223]
 v_exp_f32 v160, v160
 v_exp_f32 v161, v161
 v_exp_f32 v162, v162
 v_exp_f32 v163, v163
 v_exp_f32 v164, v164
 s_waitcnt lgkmcnt(1)
 v_mfma_f32_32x32x16_bf16 v[96:111], v[60:63], v[44:47], v[96:111]
 v_exp_f32 v165, v165
 v_cvt_pk_bf16_f32 v36, v160, v161
 v_exp_f32 v166, v166
 v_exp_f32 v167, v167
 v_cvt_pk_bf16_f32 v37, v162, v163
 v_exp_f32 v168, v168
 v_mfma_f32_32x32x16_bf16 v[96:111], v[64:67], v[48:51], v[96:111]
 v_exp_f32 v169, v169
 v_cvt_pk_bf16_f32 v38, v164, v165
 v_exp_f32 v170, v170
 s_mov_b32 exec_lo, 0x0000ffff
 s_mov_b32 exec_hi, 0x0000ffff
 ds_read_b128 v[52:55], v11 offset:34816
 ds_read_b128 v[56:59], v11 offset:35840
 s_mov_b64 exec, -1
 v_exp_f32 v171, v171
 v_cvt_pk_bf16_f32 v39, v166, v167
 v_exp_f32 v172, v172
 v_exp_f32 v173, v173
 v_cvt_pk_bf16_f32 v40, v168, v169
 v_exp_f32 v174, v174
 v_exp_f32 v175, v175
 v_cvt_pk_bf16_f32 v41, v170, v171
 v_cvt_pk_bf16_f32 v42, v172, v173
 v_cvt_pk_bf16_f32 v43, v174, v175
 ds_read_b128 v[32:35], v11 offset:9216
 s_waitcnt lgkmcnt(3)
 v_mfma_f32_32x32x16_bf16 v[160:175], v[28:31], v[20:23], v[192:207]
 v_exp_f32 v176, v176
 v_exp_f32 v177, v177
 v_exp_f32 v178, v178
 v_exp_f32 v179, v179
 v_exp_f32 v180, v180
 s_waitcnt lgkmcnt(1)
 v_mfma_f32_32x32x16_bf16 v[96:111], v[52:55], v[36:39], v[96:111]
 v_exp_f32 v181, v181
 v_cvt_pk_bf16_f32 v44, v176, v177
 v_exp_f32 v182, v182
 v_exp_f32 v183, v183
 v_cvt_pk_bf16_f32 v45, v178, v179
 v_exp_f32 v184, v184
 v_mfma_f32_32x32x16_bf16 v[96:111], v[56:59], v[40:43], v[96:111]
 v_exp_f32 v185, v185
 v_cvt_pk_bf16_f32 v46, v180, v181
 v_exp_f32 v186, v186
 s_mov_b32 exec_lo, 0xffff0000
 s_mov_b32 exec_hi, 0xffff0000
 ds_read_b128 v[88:91], v11 offset:2048
 ds_read_b128 v[92:95], v11 offset:3072
 s_mov_b64 exec, -1
 v_exp_f32 v187, v187
 v_cvt_pk_bf16_f32 v47, v182, v183
 v_exp_f32 v188, v188
 v_exp_f32 v189, v189
 v_cvt_pk_bf16_f32 v48, v184, v185
 v_exp_f32 v190, v190
 v_exp_f32 v191, v191
 v_cvt_pk_bf16_f32 v49, v186, v187
 v_cvt_pk_bf16_f32 v50, v188, v189
 v_cvt_pk_bf16_f32 v51, v190, v191
 ds_read_b128 v[24:27], v11 offset:13312
 s_cmp_eq_u32 s84, 2
 s_cbranch_scc0 CZS_106
 s_nop 7
 v_mov_b32 v192, v77
 v_mov_b32 v193, v77
 v_mov_b32 v194, v77
 v_mov_b32 v195, v77
 v_mov_b32 v196, v77
 v_mov_b32 v197, v77
 v_mov_b32 v198, v77
 v_mov_b32 v199, v77
 v_mov_b32 v200, v77
 v_mov_b32 v201, v77
 v_mov_b32 v202, v77
 v_mov_b32 v203, v77
 v_mov_b32 v204, v77
 v_mov_b32 v205, v77
 v_mov_b32 v206, v77
 v_mov_b32 v207, v77
 s_nop 1
CZS_106:
 s_waitcnt lgkmcnt(3)
 v_mfma_f32_32x32x16_bf16 v[176:191], v[32:35], v[20:23], v[192:207]
 v_exp_f32 v160, v160
 v_exp_f32 v161, v161
 v_exp_f32 v162, v162
 v_exp_f32 v163, v163
 v_exp_f32 v164, v164
 s_waitcnt lgkmcnt(1)
 v_mfma_f32_32x32x16_bf16 v[112:127], v[88:91], v[44:47], 0
 v_exp_f32 v165, v165
 v_cvt_pk_bf16_f32 v36, v160, v161
 v_exp_f32 v166, v166
 v_exp_f32 v167, v167
 v_cvt_pk_bf16_f32 v37, v162, v163
 v_exp_f32 v168, v168
 v_mfma_f32_32x32x16_bf16 v[112:127], v[92:95], v[48:51], v[112:127]
 v_exp_f32 v169, v169
 v_cvt_pk_bf16_f32 v38, v164, v165
 v_exp_f32 v170, v170
 s_mov_b32 exec_lo, 0xffff0000
 s_mov_b32 exec_hi, 0xffff0000
 ds_read_b128 v[80:83], v11 offset:6144
 ds_read_b128 v[84:87], v11 offset:7168
 s_mov_b64 exec, -1
 v_exp_f32 v171, v171
 v_cvt_pk_bf16_f32 v39, v166, v167
 v_exp_f32 v172, v172
 v_exp_f32 v173, v173
 v_cvt_pk_bf16_f32 v40, v168, v169
 v_exp_f32 v174, v174
 v_exp_f32 v175, v175
 v_cvt_pk_bf16_f32 v41, v170, v171
 v_cvt_pk_bf16_f32 v42, v172, v173
 v_cvt_pk_bf16_f32 v43, v174, v175
 ds_read_b128 v[28:31], v11 offset:17408
 s_cmp_eq_u32 s84, 3
 s_cbranch_scc0 CZS_107
 s_nop 7
 v_mov_b32 v192, v77
 v_mov_b32 v193, v77
 v_mov_b32 v194, v77
 v_mov_b32 v195, v77
 v_mov_b32 v196, v77
 v_mov_b32 v197, v77
 v_mov_b32 v198, v77
 v_mov_b32 v199, v77
 v_mov_b32 v200, v77
 v_mov_b32 v201, v77
 v_mov_b32 v202, v77
 v_mov_b32 v203, v77
 v_mov_b32 v204, v77
 v_mov_b32 v205, v77
 v_mov_b32 v206, v77
 v_mov_b32 v207, v77
 s_nop 1
CZS_107:
 s_waitcnt lgkmcnt(3)
 v_mfma_f32_32x32x16_bf16 v[160:175], v[24:27], v[20:23], v[192:207]
 v_exp_f32 v176, v176
 v_exp_f32 v177, v177
 v_exp_f32 v178, v178
 v_exp_f32 v179, v179
 v_exp_f32 v180, v180
 s_waitcnt lgkmcnt(1)
 v_mfma_f32_32x32x16_bf16 v[112:127], v[80:83], v[36:39], v[112:127]
 v_exp_f32 v181, v181
 v_cvt_pk_bf16_f32 v44, v176, v177
 v_exp_f32 v182, v182
 v_exp_f32 v183, v183
 v_cvt_pk_bf16_f32 v45, v178, v179
 v_exp_f32 v184, v184
 v_mfma_f32_32x32x16_bf16 v[112:127], v[84:87], v[40:43], v[112:127]
 v_exp_f32 v185, v185
 v_cvt_pk_bf16_f32 v46, v180, v181
 v_exp_f32 v186, v186
 s_mov_b32 exec_lo, 0xffff0000
 s_mov_b32 exec_hi, 0xffff0000
 ds_read_b128 v[88:91], v11 offset:10240
 ds_read_b128 v[92:95], v11 offset:11264
 s_mov_b64 exec, -1
 v_exp_f32 v187, v187
 v_cvt_pk_bf16_f32 v47, v182, v183
 v_exp_f32 v188, v188
 v_exp_f32 v189, v189
 v_cvt_pk_bf16_f32 v48, v184, v185
 v_exp_f32 v190, v190
 v_exp_f32 v191, v191
 v_cvt_pk_bf16_f32 v49, v186, v187
 v_cvt_pk_bf16_f32 v50, v188, v189
 v_cvt_pk_bf16_f32 v51, v190, v191
 ds_read_b128 v[32:35], v11 offset:21504
 s_cmp_eq_u32 s84, 4
 s_cbranch_scc0 CZS_108
 s_nop 7
 v_mov_b32 v192, v77
 v_mov_b32 v193, v77
 v_mov_b32 v194, v77
 v_mov_b32 v195, v77
 v_mov_b32 v196, v77
 v_mov_b32 v197, v77
 v_mov_b32 v198, v77
 v_mov_b32 v199, v77
 v_mov_b32 v200, v77
 v_mov_b32 v201, v77
 v_mov_b32 v202, v77
 v_mov_b32 v203, v77
 v_mov_b32 v204, v77
 v_mov_b32 v205, v77
 v_mov_b32 v206, v77
 v_mov_b32 v207, v77
 s_nop 1
CZS_108:
 s_waitcnt lgkmcnt(3)
 v_mfma_f32_32x32x16_bf16 v[176:191], v[28:31], v[20:23], v[192:207]
 v_exp_f32 v160, v160
 v_exp_f32 v161, v161
 v_exp_f32 v162, v162
 v_exp_f32 v163, v163
 v_exp_f32 v164, v164
 s_waitcnt lgkmcnt(1)
 v_mfma_f32_32x32x16_bf16 v[112:127], v[88:91], v[44:47], v[112:127]
 v_exp_f32 v165, v165
 v_cvt_pk_bf16_f32 v36, v160, v161
 v_exp_f32 v166, v166
 v_exp_f32 v167, v167
 v_cvt_pk_bf16_f32 v37, v162, v163
 v_exp_f32 v168, v168
 v_mfma_f32_32x32x16_bf16 v[112:127], v[92:95], v[48:51], v[112:127]
 v_exp_f32 v169, v169
 v_cvt_pk_bf16_f32 v38, v164, v165
 v_exp_f32 v170, v170
 s_mov_b32 exec_lo, 0xffff0000
 s_mov_b32 exec_hi, 0xffff0000
 ds_read_b128 v[80:83], v11 offset:14336
 ds_read_b128 v[84:87], v11 offset:15360
 s_mov_b64 exec, -1
 v_exp_f32 v171, v171
 v_cvt_pk_bf16_f32 v39, v166, v167
 v_exp_f32 v172, v172
 v_exp_f32 v173, v173
 v_cvt_pk_bf16_f32 v40, v168, v169
 v_exp_f32 v174, v174
 v_exp_f32 v175, v175
 v_cvt_pk_bf16_f32 v41, v170, v171
 v_cvt_pk_bf16_f32 v42, v172, v173
 v_cvt_pk_bf16_f32 v43, v174, v175
 ds_read_b128 v[24:27], v11 offset:25600
 s_cmp_eq_u32 s84, 5
 s_cbranch_scc0 CZS_109
 s_nop 7
 v_mov_b32 v192, v77
 v_mov_b32 v193, v77
 v_mov_b32 v194, v77
 v_mov_b32 v195, v77
 v_mov_b32 v196, v77
 v_mov_b32 v197, v77
 v_mov_b32 v198, v77
 v_mov_b32 v199, v77
 v_mov_b32 v200, v77
 v_mov_b32 v201, v77
 v_mov_b32 v202, v77
 v_mov_b32 v203, v77
 v_mov_b32 v204, v77
 v_mov_b32 v205, v77
 v_mov_b32 v206, v77
 v_mov_b32 v207, v77
 s_nop 1
CZS_109:
 s_waitcnt lgkmcnt(3)
 v_mfma_f32_32x32x16_bf16 v[160:175], v[32:35], v[20:23], v[192:207]
 v_exp_f32 v176, v176
 v_exp_f32 v177, v177
 v_exp_f32 v178, v178
 v_exp_f32 v179, v179
 v_exp_f32 v180, v180
 s_waitcnt lgkmcnt(1)
 v_mfma_f32_32x32x16_bf16 v[112:127], v[80:83], v[36:39], v[112:127]
 v_exp_f32 v181, v181
 v_cvt_pk_bf16_f32 v44, v176, v177
 v_exp_f32 v182, v182
 v_exp_f32 v183, v183
 v_cvt_pk_bf16_f32 v45, v178, v179
 v_exp_f32 v184, v184
 v_mfma_f32_32x32x16_bf16 v[112:127], v[84:87], v[40:43], v[112:127]
 v_exp_f32 v185, v185
 v_cvt_pk_bf16_f32 v46, v180, v181
 v_exp_f32 v186, v186
 s_mov_b32 exec_lo, 0xffff0000
 s_mov_b32 exec_hi, 0xffff0000
 ds_read_b128 v[88:91], v11 offset:18432
 ds_read_b128 v[92:95], v11 offset:19456
 s_mov_b64 exec, -1
 v_exp_f32 v187, v187
 v_cvt_pk_bf16_f32 v47, v182, v183
 v_exp_f32 v188, v188
 v_exp_f32 v189, v189
 v_cvt_pk_bf16_f32 v48, v184, v185
 v_exp_f32 v190, v190
 v_exp_f32 v191, v191
 v_cvt_pk_bf16_f32 v49, v186, v187
 v_cvt_pk_bf16_f32 v50, v188, v189
 v_cvt_pk_bf16_f32 v51, v190, v191
 ds_read_b128 v[28:31], v11 offset:29696
 s_cmp_eq_u32 s84, 6
 s_cbranch_scc0 CZS_110
 s_nop 7
 v_mov_b32 v192, v77
 v_mov_b32 v193, v77
 v_mov_b32 v194, v77
 v_mov_b32 v195, v77
 v_mov_b32 v196, v77
 v_mov_b32 v197, v77
 v_mov_b32 v198, v77
 v_mov_b32 v199, v77
 v_mov_b32 v200, v77
 v_mov_b32 v201, v77
 v_mov_b32 v202, v77
 v_mov_b32 v203, v77
 v_mov_b32 v204, v77
 v_mov_b32 v205, v77
 v_mov_b32 v206, v77
 v_mov_b32 v207, v77
 s_nop 1
CZS_110:
 s_waitcnt lgkmcnt(3)
 v_mfma_f32_32x32x16_bf16 v[176:191], v[24:27], v[20:23], v[192:207]
 v_exp_f32 v160, v160
 v_exp_f32 v161, v161
 v_exp_f32 v162, v162
 v_exp_f32 v163, v163
 v_exp_f32 v164, v164
 s_waitcnt lgkmcnt(1)
 v_mfma_f32_32x32x16_bf16 v[112:127], v[88:91], v[44:47], v[112:127]
 v_exp_f32 v165, v165
 v_cvt_pk_bf16_f32 v36, v160, v161
 v_exp_f32 v166, v166
 v_exp_f32 v167, v167
 v_cvt_pk_bf16_f32 v37, v162, v163
 v_exp_f32 v168, v168
 v_mfma_f32_32x32x16_bf16 v[112:127], v[92:95], v[48:51], v[112:127]
 v_exp_f32 v169, v169
 v_cvt_pk_bf16_f32 v38, v164, v165
 v_exp_f32 v170, v170
 s_mov_b32 exec_lo, 0xffff0000
 s_mov_b32 exec_hi, 0xffff0000
 ds_read_b128 v[80:83], v11 offset:22528
 ds_read_b128 v[84:87], v11 offset:23552
 s_mov_b64 exec, -1
 v_exp_f32 v171, v171
 v_cvt_pk_bf16_f32 v39, v166, v167
 v_exp_f32 v172, v172
 v_exp_f32 v173, v173
 v_cvt_pk_bf16_f32 v40, v168, v169
 v_exp_f32 v174, v174
 v_exp_f32 v175, v175
 v_cvt_pk_bf16_f32 v41, v170, v171
 v_cvt_pk_bf16_f32 v42, v172, v173
 v_cvt_pk_bf16_f32 v43, v174, v175
 ds_read_b128 v[32:35], v11 offset:33792
 s_cmp_eq_u32 s84, 7
 s_cbranch_scc0 CZS_111
 s_nop 7
 v_mov_b32 v192, v77
 v_mov_b32 v193, v77
 v_mov_b32 v194, v77
 v_mov_b32 v195, v77
 v_mov_b32 v196, v77
 v_mov_b32 v197, v77
 v_mov_b32 v198, v77
 v_mov_b32 v199, v77
 v_mov_b32 v200, v77
 v_mov_b32 v201, v77
 v_mov_b32 v202, v77
 v_mov_b32 v203, v77
 v_mov_b32 v204, v77
 v_mov_b32 v205, v77
 v_mov_b32 v206, v77
 v_mov_b32 v207, v77
 s_nop 1
CZS_111:
 s_waitcnt lgkmcnt(3)
 v_mfma_f32_32x32x16_bf16 v[160:175], v[28:31], v[20:23], v[192:207]
 v_exp_f32 v176, v176
 v_exp_f32 v177, v177
 v_exp_f32 v178, v178
 v_exp_f32 v179, v179
 v_exp_f32 v180, v180
 s_waitcnt lgkmcnt(1)
 v_mfma_f32_32x32x16_bf16 v[112:127], v[80:83], v[36:39], v[112:127]
 v_exp_f32 v181, v181
 v_cvt_pk_bf16_f32 v44, v176, v177
 v_exp_f32 v182, v182
 v_exp_f32 v183, v183
 v_cvt_pk_bf16_f32 v45, v178, v179
 v_exp_f32 v184, v184
 v_mfma_f32_32x32x16_bf16 v[112:127], v[84:87], v[40:43], v[112:127]
 v_exp_f32 v185, v185
 v_cvt_pk_bf16_f32 v46, v180, v181
 v_exp_f32 v186, v186
 s_mov_b32 exec_lo, 0xffff0000
 s_mov_b32 exec_hi, 0xffff0000
 ds_read_b128 v[88:91], v11 offset:26624
 ds_read_b128 v[92:95], v11 offset:27648
 s_mov_b64 exec, -1
 v_exp_f32 v187, v187
 v_cvt_pk_bf16_f32 v47, v182, v183
 v_exp_f32 v188, v188
 v_exp_f32 v189, v189
 v_cvt_pk_bf16_f32 v48, v184, v185
 v_exp_f32 v190, v190
 v_exp_f32 v191, v191
 v_cvt_pk_bf16_f32 v49, v186, v187
 v_cvt_pk_bf16_f32 v50, v188, v189
 v_cvt_pk_bf16_f32 v51, v190, v191
 v_add_f32 v208, v128, v77
 v_add_f32 v209, v129, v77
 v_add_f32 v210, v130, v77
 v_add_f32 v211, v131, v77
 v_add_f32 v212, v132, v77
 v_add_f32 v213, v133, v77
 v_add_f32 v214, v134, v77
 v_add_f32 v215, v135, v77
 v_add_f32 v216, v136, v77
 v_add_f32 v217, v137, v77
 v_add_f32 v218, v138, v77
 v_add_f32 v219, v139, v77
 v_add_f32 v220, v140, v77
 v_add_f32 v221, v141, v77
 v_add_f32 v222, v142, v77
 v_add_f32 v223, v143, v77
 s_nop 0
 s_waitcnt lgkmcnt(2)
 v_mfma_f32_32x32x16_bf16 v[176:191], v[32:35], v[20:23], v[208:223]
 v_exp_f32 v160, v160
 v_exp_f32 v161, v161
 v_exp_f32 v162, v162
 v_exp_f32 v163, v163
 v_exp_f32 v164, v164
 s_waitcnt lgkmcnt(0)
 v_mfma_f32_32x32x16_bf16 v[112:127], v[88:91], v[44:47], v[112:127]
 v_exp_f32 v165, v165
 v_cvt_pk_bf16_f32 v36, v160, v161
 v_exp_f32 v166, v166
 v_exp_f32 v167, v167
 v_cvt_pk_bf16_f32 v37, v162, v163
 v_exp_f32 v168, v168
 v_mfma_f32_32x32x16_bf16 v[112:127], v[92:95], v[48:51], v[112:127]
 v_exp_f32 v169, v169
 v_cvt_pk_bf16_f32 v38, v164, v165
 v_exp_f32 v170, v170
 s_mov_b32 exec_lo, 0xffff0000
 s_mov_b32 exec_hi, 0xffff0000
 ds_read_b128 v[80:83], v11 offset:30720
 ds_read_b128 v[84:87], v11 offset:31744
 s_mov_b64 exec, -1
 v_exp_f32 v171, v171
 v_cvt_pk_bf16_f32 v39, v166, v167
 v_exp_f32 v172, v172
 v_exp_f32 v173, v173
 v_cvt_pk_bf16_f32 v40, v168, v169
 v_exp_f32 v174, v174
 v_exp_f32 v175, v175
 v_cvt_pk_bf16_f32 v41, v170, v171
 v_cvt_pk_bf16_f32 v42, v172, v173
 v_cvt_pk_bf16_f32 v43, v174, v175
 v_exp_f32 v176, v176
 v_exp_f32 v177, v177
 v_exp_f32 v178, v178
 v_exp_f32 v179, v179
 v_exp_f32 v180, v180
 s_waitcnt lgkmcnt(0)
 v_mfma_f32_32x32x16_bf16 v[112:127], v[80:83], v[36:39], v[112:127]
 v_exp_f32 v181, v181
 v_cvt_pk_bf16_f32 v44, v176, v177
 v_exp_f32 v182, v182
 v_exp_f32 v183, v183
 v_cvt_pk_bf16_f32 v45, v178, v179
 v_exp_f32 v184, v184
 v_mfma_f32_32x32x16_bf16 v[112:127], v[84:87], v[40:43], v[112:127]
 v_exp_f32 v185, v185
 v_cvt_pk_bf16_f32 v46, v180, v181
 v_exp_f32 v186, v186
 s_mov_b32 exec_lo, 0xffff0000
 s_mov_b32 exec_hi, 0xffff0000
 ds_read_b128 v[88:91], v11 offset:34816
 ds_read_b128 v[92:95], v11 offset:35840
 s_mov_b64 exec, -1
 v_exp_f32 v187, v187
 v_cvt_pk_bf16_f32 v47, v182, v183
 v_exp_f32 v188, v188
 v_exp_f32 v189, v189
 v_cvt_pk_bf16_f32 v48, v184, v185
 v_exp_f32 v190, v190
 v_exp_f32 v191, v191
 v_cvt_pk_bf16_f32 v49, v186, v187
 v_cvt_pk_bf16_f32 v50, v188, v189
 v_cvt_pk_bf16_f32 v51, v190, v191
 s_waitcnt lgkmcnt(0)
 s_nop 1
 v_mfma_f32_32x32x16_bf16 v[112:127], v[88:91], v[44:47], v[112:127]
 v_mfma_f32_32x32x16_bf16 v[112:127], v[92:95], v[48:51], v[112:127]
ATF_63:
 s_nop 11
 v_rcp_f32 v72, v104
 v_rcp_f32 v73, v112
 s_nop 0
 v_mul_f32 v96, v96, v72
 v_mul_f32 v120, v120, v73
 v_mul_f32 v97, v97, v72
 v_mul_f32 v121, v121, v73
 v_mul_f32 v98, v98, v72
 v_mul_f32 v122, v122, v73
 v_mul_f32 v99, v99, v72
 v_mul_f32 v123, v123, v73
 v_mul_f32 v100, v100, v72
 v_mul_f32 v124, v124, v73
 v_mul_f32 v101, v101, v72
 v_mul_f32 v125, v125, v73
 v_mul_f32 v102, v102, v72
 v_mul_f32 v126, v126, v73
 v_mul_f32 v103, v103, v72
 v_mul_f32 v127, v127, v73
 v_cvt_pk_bf16_f32 v76, v96, v97
 v_cvt_pk_bf16_f32 v80, v120, v121
 v_cvt_pk_bf16_f32 v77, v98, v99
 v_cvt_pk_bf16_f32 v81, v122, v123
 v_cvt_pk_bf16_f32 v78, v100, v101
 v_cvt_pk_bf16_f32 v82, v124, v125
 v_cvt_pk_bf16_f32 v79, v102, v103
 v_cvt_pk_bf16_f32 v83, v126, v127
 s_lshl_b32 s81, s27, 2
 s_add_u32 s81, s81, s38
 s_mul_i32 s81, s81, 118
 s_lshl_b32 s82, s28, 1
 s_add_u32 s81, s81, s82
 s_add_u32 s81, s81, 86
 s_lshl_b32 s81, s81, 10
 s_add_u32 s81, s81, 8388608
 buffer_store_dwordx4 v[76:79], v7, s[64:67], s81 offen sc1
 buffer_store_dwordx4 v[80:83], v7, s[64:67], s81 offen offset:1024 sc1
 s_waitcnt vmcnt(0)
 v_mov_b32 v8, 147460
 v_mov_b32 v9, 1
 s_mov_b64 exec, 1
 ds_add_rtn_u32 v10, v8, v9
 s_waitcnt lgkmcnt(0)
 v_readfirstlane_b32 s81, v10
 s_mov_b64 exec, -1
 s_cmp_eq_u32 s81, 3
 s_cbranch_scc0 NOFO_112
 s_lshl_b32 s81, s27, 11
 s_lshl_b32 s82, s28, 2
 s_add_u32 s81, s81, s82
 s_add_u32 s81, s81, 163840
 v_lshlrev_b32 v3, 7, v0
 v_add_u32 v3, s81, v3
 v_mov_b32 v4, s31
 s_mov_b64 exec, 0xffff
 buffer_store_dword v4, v3, s[64:67], 0 offen sc1
 s_mov_b64 exec, -1
NOFO_112:
 s_or_b32 s81, s2, s38
 s_cmp_eq_u32 s81, 0
 s_cbranch_scc0 L_END
 v_lshrrev_b32 v3, 2, v0
 v_lshlrev_b32 v3, 11, v3
 v_and_b32 v4, 3, v0
 v_lshl_add_u32 v3, v4, 4, v3
 v_add_u32 v3, 65536, v3
 s_mov_b32 s39, 1048576
NB_113:
 buffer_load_dwordx4 v[12:15], v3, s[64:67], 0 offen sc1
 s_waitcnt vmcnt(0)
 v_xor_b32 v12, s31, v12
 v_xor_b32 v13, s31, v13
 v_xor_b32 v14, s31, v14
 v_xor_b32 v15, s31, v15
 v_or_b32 v12, v12, v13
 v_or_b32 v14, v14, v15
 v_or_b32 v12, v12, v14
 v_cmp_ne_u32 vcc, 0, v12
 s_nop 0
 s_cbranch_vccz NBD_114
 s_sub_u32 s39, s39, 1
 s_cbranch_scc0 NB_113
NBD_114:
 v_mov_b32 v3, 0
 v_mov_b32 v5, s31
 s_mov_b64 exec, 1
 buffer_store_dword v5, v3, s[64:67], 0 offen sc1
 s_waitcnt vmcnt(0)
 s_branch L_END
L_GWAVE:
 s_cmp_eq_u32 s26, 0
 s_cbranch_scc0 NOCPF_115
 s_mul_i32 s3, s30, 1664
 v_lshlrev_b32 v1, 7, v0
 v_add_u32 v1, s3, v1
 v_min_u32 v1, L_END-L_PCREF, v1
 s_mov_b64 exec, 0xffff
 global_load_dword v250, v1, s[4:5]
 s_mov_b64 exec, -1
NOCPF_115:
 s_load_dwordx2 s[52:53], s[0:1], 40
 s_load_dwordx2 s[56:57], s[0:1], 16
 s_load_dwordx2 s[60:61], s[0:1], 48
 s_load_dwordx2 s[68:69], s[0:1], 56
 v_lshlrev_b32 v7, 4, v0
 s_mov_b32 s54, 1409024
 s_mov_b32 s55, 0x20000
 s_mov_b32 s58, 524288
 s_mov_b32 s59, 0x20000
 s_mov_b32 s62, 2097152
 s_mov_b32 s63, 0x20000
 v_and_b32 v2, 31, v0
 v_lshrrev_b32 v3, 3, v2
 v_lshlrev_b32 v3, 10, v3
 v_and_b32 v4, 7, v2
 v_lshl_add_u32 v3, v4, 7, v3
 v_bfe_u32 v4, v0, 1, 3
 v_lshrrev_b32 v5, 5, v0
 v_xor_b32 v4, v4, v5
 v_lshl_add_u32 v3, v4, 4, v3
 s_lshl_b32 s72, s26, 12
 v_add_u32 v8, s72, v3
 v_xor_b32 v9, 32, v8
 v_xor_b32 v10, 64, v8
 v_xor_b32 v11, 96, v8
 v_lshrrev_b32 v3, 5, v0
 v_lshlrev_b32 v3, 3, v3
 v_bfe_u32 v4, v0, 2, 2
 v_add_u32 v3, v3, v4
 v_lshlrev_b32 v3, 6, v3
 v_bfe_u32 v4, v0, 4, 1
 v_lshl_add_u32 v3, v4, 5, v3
 v_and_b32 v4, 3, v0
 v_lshl_add_u32 v3, v4, 3, v3
 v_add_u32 v12, 16384, v3
 v_add_u32 v13, 73728, v3
 v_lshlrev_b32 v51, 3, v0
 v_add_u32 v51, 155904, v51
 v_lshrrev_b32 v6, 5, v0
 v_add_u32 v6, -1, v6
 s_add_u32 s73, s26, 8
 s_mul_i32 s73, s73, 4096
 v_add_u32 v14, s73, v7
 s_lshl_b32 s72, s26, 7
 v_lshlrev_b32 v4, 2, v2
 v_add_u32 v4, s72, v4
 v_add_u32 v4, 159744, v4
 v_lshrrev_b32 v3, 5, v0
 v_lshlrev_b32 v3, 4, v3
 s_add_u32 s72, s72, 160256
 v_add_u32 v3, s72, v3
 s_lshl_b32 s76, s26, 11
 s_add_u32 s76, s76, 49152
 v_add_u32 v15, s76, v7
 v_and_b32 v1, 1, v0
 v_lshlrev_b32 v1, 2, v1
 s_lshl_b32 s76, s26, 3
 s_add_u32 s76, s76, 147584
 v_add_u32 v1, s76, v1
 s_and_b32 s72, s30, 3
 s_lshl_b32 s35, s29, 3
 s_lshl_b32 s73, s72, 1
 s_add_u32 s35, s35, s73
 s_lshr_b32 s36, s30, 2
 s_lshr_b32 s37, s35, 2
 s_waitcnt lgkmcnt(0)
 v_mov_b32 v5, 0
 buffer_load_dword v28, v5, s[64:67], 0 offen sc1
 s_lshl_b32 s82, s26, 14
 s_add_u32 s82, s82, 73728
 s_lshr_b32 s95, s26, 1
 s_and_b32 s96, s26, 1
 s_mul_i32 s97, s95, 6
 s_add_u32 s97, s97, s96
 s_lshl_b32 s98, s95, 2
 s_add_u32 s98, s98, s96
 s_mul_i32 s99, s35, 118
 s_add_u32 s83, s99, s97
 s_lshl_b32 s83, s83, 10
 s_add_u32 s83, s83, 8388608
 s_lshl_b32 s86, s97, 14
 s_add_u32 s84, s99, s98
 s_lshl_b32 s84, s84, 10
 s_add_u32 s84, s84, 8388608
 s_lshl_b32 s87, s98, 14
 s_add_u32 s85, s99, s26
 s_add_u32 s85, s85, 86
 s_lshl_b32 s85, s85, 10
 s_add_u32 s85, s85, 8388608
 s_lshl_b32 s88, s26, 14
 s_lshl_b32 s89, s37, 4
 s_lshl_b32 s95, s36, 1
 s_add_u32 s89, s89, s95
 s_and_b32 s95, s30, 1
 s_add_u32 s89, s89, s95
 s_lshl_b32 s89, s89, 7
 s_add_u32 s94, s89, 163840
 s_add_u32 s89, s89, 65536
 s_lshl_b32 s72, s27, 2
 s_add_u32 s72, s72, s26
 s_lshl_b32 s74, s72, 4
 s_add_u32 s74, s74, s28
 s_mul_i32 s74, s74, 4096
 s_add_u32 s74, s74, 1048576
 s_mul_i32 s93, s72, 118
 s_lshl_b32 s73, s33, 1
 s_add_u32 s93, s93, s73
 s_lshl_b32 s93, s93, 10
 s_add_u32 s93, s93, 8388608
 s_waitcnt vmcnt(0)
 v_readfirstlane_b32 s31, v28
 s_nop 1
 s_add_u32 s31, s31, 2654435769
 s_mov_b32 s24, s31
 s_mov_b32 s25, s31
 s_barrier
 ds_read_b128 v[128:131], v8 offset:0
 ds_read_b64_tr_b16 v[16:17], v12 offset:0
 ds_read_b64_tr_b16 v[18:19], v12 offset:256
 ds_read_b64_tr_b16 v[20:21], v12 offset:4096
 ds_read_b64_tr_b16 v[22:23], v12 offset:4352
 ds_read_b128 v[132:135], v9 offset:0
 ds_read_b64_tr_b16 v[24:25], v12 offset:1024
 ds_read_b64_tr_b16 v[26:27], v12 offset:1280
 ds_read_b64_tr_b16 v[28:29], v12 offset:5120
 ds_read_b64_tr_b16 v[30:31], v12 offset:5376
 s_waitcnt lgkmcnt(5)
 v_mfma_f32_32x32x16_bf16 v[64:79], v[16:19], v[128:131], 0
 ds_read_b128 v[136:139], v10 offset:0
 ds_read_b64_tr_b16 v[32:33], v12 offset:2048
 v_mfma_f32_32x32x16_bf16 v[80:95], v[128:131], v[20:23], 0
 ds_read_b64_tr_b16 v[34:35], v12 offset:2304
 ds_read_b64_tr_b16 v[36:37], v12 offset:6144
 v_mfma_f32_32x32x16_bf16 v[112:127], v[128:131], v[128:131], 0
 ds_read_b64_tr_b16 v[38:39], v12 offset:6400
 ds_read_b128 v[140:143], v11 offset:0
 ds_read_b64_tr_b16 v[40:41], v12 offset:3072
 ds_read_b64_tr_b16 v[42:43], v12 offset:3328
 ds_read_b64_tr_b16 v[44:45], v12 offset:7168
 ds_read_b64_tr_b16 v[46:47], v12 offset:7424
 s_waitcnt lgkmcnt(10)
 v_mfma_f32_32x32x16_bf16 v[64:79], v[24:27], v[132:135], v[64:79]
 v_mfma_f32_32x32x16_bf16 v[80:95], v[132:135], v[28:31], v[80:95]
 v_mfma_f32_32x32x16_bf16 v[112:127], v[132:135], v[132:135], v[112:127]
 s_barrier
 ds_read_b128 v[144:147], v8 offset:24576
 ds_read_b64_tr_b16 v[16:17], v12 offset:24576
 ds_read_b64_tr_b16 v[18:19], v12 offset:24832
 ds_read_b64_tr_b16 v[20:21], v12 offset:28672
 ds_read_b64_tr_b16 v[22:23], v12 offset:28928
 s_waitcnt lgkmcnt(10)
 v_mfma_f32_32x32x16_bf16 v[64:79], v[32:35], v[136:139], v[64:79]
 ds_read_b128 v[148:151], v9 offset:24576
 ds_read_b64_tr_b16 v[24:25], v12 offset:25600
 v_mfma_f32_32x32x16_bf16 v[80:95], v[136:139], v[36:39], v[80:95]
 ds_read_b64_tr_b16 v[26:27], v12 offset:25856
 ds_read_b64_tr_b16 v[28:29], v12 offset:29696
 v_mfma_f32_32x32x16_bf16 v[112:127], v[136:139], v[136:139], v[112:127]
 ds_read_b64_tr_b16 v[30:31], v12 offset:29952
 s_waitcnt lgkmcnt(10)
 v_mfma_f32_32x32x16_bf16 v[64:79], v[40:43], v[140:143], v[64:79]
 ds_read_b128 v[152:155], v10 offset:24576
 ds_read_b64_tr_b16 v[32:33], v12 offset:26624
 v_mfma_f32_32x32x16_bf16 v[80:95], v[140:143], v[44:47], v[80:95]
 ds_read_b64_tr_b16 v[34:35], v12 offset:26880
 ds_read_b64_tr_b16 v[36:37], v12 offset:30720
 v_mfma_f32_32x32x16_bf16 v[112:127], v[140:143], v[140:143], v[112:127]
 ds_read_b64_tr_b16 v[38:39], v12 offset:30976
 s_waitcnt lgkmcnt(10)
 v_mfma_f32_32x32x16_bf16 v[64:79], v[16:19], v[144:147], v[64:79]
 ds_read_b128 v[156:159], v11 offset:24576
 ds_read_b64_tr_b16 v[40:41], v12 offset:27648
 v_mfma_f32_32x32x16_bf16 v[80:95], v[144:147], v[20:23], v[80:95]
 ds_read_b64_tr_b16 v[42:43], v12 offset:27904
 ds_read_b64_tr_b16 v[44:45], v12 offset:31744
 v_mfma_f32_32x32x16_bf16 v[112:127], v[144:147], v[144:147], v[112:127]
 ds_read_b64_tr_b16 v[46:47], v12 offset:32000
 s_waitcnt lgkmcnt(10)
 v_mfma_f32_32x32x16_bf16 v[64:79], v[24:27], v[148:151], v[64:79]
 v_mfma_f32_32x32x16_bf16 v[80:95], v[148:151], v[28:31], v[80:95]
 v_mfma_f32_32x32x16_bf16 v[112:127], v[148:151], v[148:151], v[112:127]
 s_barrier
 ds_read_b128 v[160:163], v8 offset:49152
 ds_read_b64_tr_b16 v[16:17], v12 offset:49152
 ds_read_b64_tr_b16 v[18:19], v12 offset:49408
 ds_read_b64_tr_b16 v[20:21], v12 offset:53248
 ds_read_b64_tr_b16 v[22:23], v12 offset:53504
 s_waitcnt lgkmcnt(10)
 v_mfma_f32_32x32x16_bf16 v[64:79], v[32:35], v[152:155], v[64:79]
 ds_read_b128 v[164:167], v9 offset:49152
 ds_read_b64_tr_b16 v[24:25], v12 offset:50176
 v_mfma_f32_32x32x16_bf16 v[80:95], v[152:155], v[36:39], v[80:95]
 ds_read_b64_tr_b16 v[26:27], v12 offset:50432
 ds_read_b64_tr_b16 v[28:29], v12 offset:54272
 v_mfma_f32_32x32x16_bf16 v[112:127], v[152:155], v[152:155], v[112:127]
 ds_read_b64_tr_b16 v[30:31], v12 offset:54528
 s_waitcnt lgkmcnt(10)
 v_mfma_f32_32x32x16_bf16 v[64:79], v[40:43], v[156:159], v[64:79]
 ds_read_b128 v[168:171], v10 offset:49152
 ds_read_b64_tr_b16 v[32:33], v12 offset:51200
 v_mfma_f32_32x32x16_bf16 v[80:95], v[156:159], v[44:47], v[80:95]
 ds_read_b64_tr_b16 v[34:35], v12 offset:51456
 ds_read_b64_tr_b16 v[36:37], v12 offset:55296
 v_mfma_f32_32x32x16_bf16 v[112:127], v[156:159], v[156:159], v[112:127]
 ds_read_b64_tr_b16 v[38:39], v12 offset:55552
 s_waitcnt lgkmcnt(10)
 v_mfma_f32_32x32x16_bf16 v[64:79], v[16:19], v[160:163], v[64:79]
 ds_read_b128 v[172:175], v11 offset:49152
 ds_read_b64_tr_b16 v[40:41], v12 offset:52224
 v_mfma_f32_32x32x16_bf16 v[80:95], v[160:163], v[20:23], v[80:95]
 ds_read_b64_tr_b16 v[42:43], v12 offset:52480
 ds_read_b64_tr_b16 v[44:45], v12 offset:56320
 v_mfma_f32_32x32x16_bf16 v[112:127], v[160:163], v[160:163], v[112:127]
 ds_read_b64_tr_b16 v[46:47], v12 offset:56576
 s_waitcnt lgkmcnt(10)
 v_mfma_f32_32x32x16_bf16 v[64:79], v[24:27], v[164:167], v[64:79]
 v_mfma_f32_32x32x16_bf16 v[80:95], v[164:167], v[28:31], v[80:95]
 v_mfma_f32_32x32x16_bf16 v[112:127], v[164:167], v[164:167], v[112:127]
 s_barrier
 v_add_u32 v8, 73728, v8
 v_add_u32 v9, 73728, v9
 v_add_u32 v10, 73728, v10
 v_add_u32 v11, 73728, v11
 v_add_u32 v12, 73728, v12
 ds_read_b128 v[176:179], v8 offset:0
 ds_read_b64_tr_b16 v[16:17], v12 offset:0
 ds_read_b64_tr_b16 v[18:19], v12 offset:256
 ds_read_b64_tr_b16 v[20:21], v12 offset:4096
 ds_read_b64_tr_b16 v[22:23], v12 offset:4352
 s_waitcnt lgkmcnt(10)
 v_mfma_f32_32x32x16_bf16 v[64:79], v[32:35], v[168:171], v[64:79]
 ds_read_b128 v[180:183], v9 offset:0
 ds_read_b64_tr_b16 v[24:25], v12 offset:1024
 v_mfma_f32_32x32x16_bf16 v[80:95], v[168:171], v[36:39], v[80:95]
 ds_read_b64_tr_b16 v[26:27], v12 offset:1280
 ds_read_b64_tr_b16 v[28:29], v12 offset:5120
 v_mfma_f32_32x32x16_bf16 v[112:127], v[168:171], v[168:171], v[112:127]
 ds_read_b64_tr_b16 v[30:31], v12 offset:5376
 s_waitcnt lgkmcnt(10)
 v_mfma_f32_32x32x16_bf16 v[64:79], v[40:43], v[172:175], v[64:79]
 ds_read_b128 v[184:187], v10 offset:0
 ds_read_b64_tr_b16 v[32:33], v12 offset:2048
 v_mfma_f32_32x32x16_bf16 v[80:95], v[172:175], v[44:47], v[80:95]
 ds_read_b64_tr_b16 v[34:35], v12 offset:2304
 ds_read_b64_tr_b16 v[36:37], v12 offset:6144
 v_mfma_f32_32x32x16_bf16 v[112:127], v[172:175], v[172:175], v[112:127]
 ds_read_b64_tr_b16 v[38:39], v12 offset:6400
 s_waitcnt lgkmcnt(10)
 v_mfma_f32_32x32x16_bf16 v[64:79], v[16:19], v[176:179], v[64:79]
 ds_read_b128 v[188:191], v11 offset:0
 ds_read_b64_tr_b16 v[40:41], v12 offset:3072
 v_mfma_f32_32x32x16_bf16 v[80:95], v[176:179], v[20:23], v[80:95]
 ds_read_b64_tr_b16 v[42:43], v12 offset:3328
 ds_read_b64_tr_b16 v[44:45], v12 offset:7168
 v_mfma_f32_32x32x16_bf16 v[112:127], v[176:179], v[176:179], v[112:127]
 ds_read_b64_tr_b16 v[46:47], v12 offset:7424
 s_waitcnt lgkmcnt(10)
 v_mfma_f32_32x32x16_bf16 v[64:79], v[24:27], v[180:183], v[64:79]
 v_mfma_f32_32x32x16_bf16 v[80:95], v[180:183], v[28:31], v[80:95]
 v_mfma_f32_32x32x16_bf16 v[112:127], v[180:183], v[180:183], v[112:127]
 s_barrier
 ds_read_b128 v[192:195], v8 offset:32768
 ds_read_b64_tr_b16 v[16:17], v12 offset:32768
 ds_read_b64_tr_b16 v[18:19], v12 offset:33024
 ds_read_b64_tr_b16 v[20:21], v12 offset:36864
 ds_read_b64_tr_b16 v[22:23], v12 offset:37120
 s_waitcnt lgkmcnt(10)
 v_mfma_f32_32x32x16_bf16 v[64:79], v[32:35], v[184:187], v[64:79]
 ds_read_b128 v[196:199], v9 offset:32768
 ds_read_b64_tr_b16 v[24:25], v12 offset:33792
 v_mfma_f32_32x32x16_bf16 v[80:95], v[184:187], v[36:39], v[80:95]
 ds_read_b64_tr_b16 v[26:27], v12 offset:34048
 ds_read_b64_tr_b16 v[28:29], v12 offset:37888
 v_mfma_f32_32x32x16_bf16 v[112:127], v[184:187], v[184:187], v[112:127]
 ds_read_b64_tr_b16 v[30:31], v12 offset:38144
 s_waitcnt lgkmcnt(10)
 v_mfma_f32_32x32x16_bf16 v[64:79], v[40:43], v[188:191], v[64:79]
 ds_read_b128 v[200:203], v10 offset:32768
 ds_read_b64_tr_b16 v[32:33], v12 offset:34816
 v_mfma_f32_32x32x16_bf16 v[80:95], v[188:191], v[44:47], v[80:95]
 ds_read_b64_tr_b16 v[34:35], v12 offset:35072
 ds_read_b64_tr_b16 v[36:37], v12 offset:38912
 v_mfma_f32_32x32x16_bf16 v[112:127], v[188:191], v[188:191], v[112:127]
 ds_read_b64_tr_b16 v[38:39], v12 offset:39168
 s_waitcnt lgkmcnt(10)
 v_mfma_f32_32x32x16_bf16 v[64:79], v[16:19], v[192:195], v[64:79]
 ds_read_b128 v[204:207], v11 offset:32768
 ds_read_b64_tr_b16 v[40:41], v12 offset:35840
 v_mfma_f32_32x32x16_bf16 v[80:95], v[192:195], v[20:23], v[80:95]
 ds_read_b64_tr_b16 v[42:43], v12 offset:36096
 ds_read_b64_tr_b16 v[44:45], v12 offset:39936
 v_mfma_f32_32x32x16_bf16 v[112:127], v[192:195], v[192:195], v[112:127]
 ds_read_b64_tr_b16 v[46:47], v12 offset:40192
 s_waitcnt lgkmcnt(10)
 v_mfma_f32_32x32x16_bf16 v[64:79], v[24:27], v[196:199], v[64:79]
 v_mfma_f32_32x32x16_bf16 v[80:95], v[196:199], v[28:31], v[80:95]
 v_mfma_f32_32x32x16_bf16 v[112:127], v[196:199], v[196:199], v[112:127]
 s_barrier
 v_subrev_u32 v8, 73728, v8
 v_subrev_u32 v9, 73728, v9
 v_subrev_u32 v10, 73728, v10
 v_subrev_u32 v11, 73728, v11
 v_subrev_u32 v12, 73728, v12
 ds_read_b128 v[208:211], v8 offset:0
 ds_read_b64_tr_b16 v[16:17], v12 offset:0
 ds_read_b64_tr_b16 v[18:19], v12 offset:256
 ds_read_b64_tr_b16 v[20:21], v12 offset:4096
 ds_read_b64_tr_b16 v[22:23], v12 offset:4352
 s_waitcnt lgkmcnt(10)
 v_mfma_f32_32x32x16_bf16 v[64:79], v[32:35], v[200:203], v[64:79]
 ds_read_b128 v[212:215], v9 offset:0
 ds_read_b64_tr_b16 v[24:25], v12 offset:1024
 v_mfma_f32_32x32x16_bf16 v[80:95], v[200:203], v[36:39], v[80:95]
 ds_read_b64_tr_b16 v[26:27], v12 offset:1280
 ds_read_b64_tr_b16 v[28:29], v12 offset:5120
 v_mfma_f32_32x32x16_bf16 v[112:127], v[200:203], v[200:203], v[112:127]
 ds_read_b64_tr_b16 v[30:31], v12 offset:5376
 s_waitcnt lgkmcnt(10)
 v_mfma_f32_32x32x16_bf16 v[64:79], v[40:43], v[204:207], v[64:79]
 ds_read_b128 v[216:219], v10 offset:0
 ds_read_b64_tr_b16 v[32:33], v12 offset:2048
 v_mfma_f32_32x32x16_bf16 v[80:95], v[204:207], v[44:47], v[80:95]
 ds_read_b64_tr_b16 v[34:35], v12 offset:2304
 ds_read_b64_tr_b16 v[36:37], v12 offset:6144
 v_mfma_f32_32x32x16_bf16 v[112:127], v[204:207], v[204:207], v[112:127]
 ds_read_b64_tr_b16 v[38:39], v12 offset:6400
 s_waitcnt lgkmcnt(10)
 v_mfma_f32_32x32x16_bf16 v[64:79], v[16:19], v[208:211], v[64:79]
 ds_read_b128 v[220:223], v11 offset:0
 ds_read_b64_tr_b16 v[40:41], v12 offset:3072
 v_mfma_f32_32x32x16_bf16 v[80:95], v[208:211], v[20:23], v[80:95]
 ds_read_b64_tr_b16 v[42:43], v12 offset:3328
 ds_read_b64_tr_b16 v[44:45], v12 offset:7168
 v_mfma_f32_32x32x16_bf16 v[112:127], v[208:211], v[208:211], v[112:127]
 ds_read_b64_tr_b16 v[46:47], v12 offset:7424
 s_waitcnt lgkmcnt(10)
 v_mfma_f32_32x32x16_bf16 v[64:79], v[24:27], v[212:215], v[64:79]
 v_mfma_f32_32x32x16_bf16 v[80:95], v[212:215], v[28:31], v[80:95]
 v_mfma_f32_32x32x16_bf16 v[112:127], v[212:215], v[212:215], v[112:127]
 s_barrier
 ds_read_b128 v[224:227], v8 offset:24576
 ds_read_b64_tr_b16 v[16:17], v12 offset:24576
 ds_read_b64_tr_b16 v[18:19], v12 offset:24832
 ds_read_b64_tr_b16 v[20:21], v12 offset:28672
 ds_read_b64_tr_b16 v[22:23], v12 offset:28928
 s_waitcnt lgkmcnt(10)
 v_mfma_f32_32x32x16_bf16 v[64:79], v[32:35], v[216:219], v[64:79]
 ds_read_b128 v[228:231], v9 offset:24576
 ds_read_b64_tr_b16 v[24:25], v12 offset:25600
 v_mfma_f32_32x32x16_bf16 v[80:95], v[216:219], v[36:39], v[80:95]
 ds_read_b64_tr_b16 v[26:27], v12 offset:25856
 ds_read_b64_tr_b16 v[28:29], v12 offset:29696
 v_mfma_f32_32x32x16_bf16 v[112:127], v[216:219], v[216:219], v[112:127]
 ds_read_b64_tr_b16 v[30:31], v12 offset:29952
 s_waitcnt lgkmcnt(10)
 v_mfma_f32_32x32x16_bf16 v[64:79], v[40:43], v[220:223], v[64:79]
 ds_read_b128 v[232:235], v10 offset:24576
 ds_read_b64_tr_b16 v[32:33], v12 offset:26624
 v_mfma_f32_32x32x16_bf16 v[80:95], v[220:223], v[44:47], v[80:95]
 ds_read_b64_tr_b16 v[34:35], v12 offset:26880
 ds_read_b64_tr_b16 v[36:37], v12 offset:30720
 v_mfma_f32_32x32x16_bf16 v[112:127], v[220:223], v[220:223], v[112:127]
 ds_read_b64_tr_b16 v[38:39], v12 offset:30976
 s_waitcnt lgkmcnt(10)
 v_mfma_f32_32x32x16_bf16 v[64:79], v[16:19], v[224:227], v[64:79]
 ds_read_b128 v[236:239], v11 offset:24576
 ds_read_b64_tr_b16 v[40:41], v12 offset:27648
 v_mfma_f32_32x32x16_bf16 v[80:95], v[224:227], v[20:23], v[80:95]
 ds_read_b64_tr_b16 v[42:43], v12 offset:27904
 ds_read_b64_tr_b16 v[44:45], v12 offset:31744
 v_mfma_f32_32x32x16_bf16 v[112:127], v[224:227], v[224:227], v[112:127]
 ds_read_b64_tr_b16 v[46:47], v12 offset:32000
 s_waitcnt lgkmcnt(10)
 v_mfma_f32_32x32x16_bf16 v[64:79], v[24:27], v[228:231], v[64:79]
 v_mfma_f32_32x32x16_bf16 v[80:95], v[228:231], v[28:31], v[80:95]
 v_mfma_f32_32x32x16_bf16 v[112:127], v[228:231], v[228:231], v[112:127]
 s_barrier
 ds_read_b128 v[240:243], v8 offset:49152
 ds_read_b64_tr_b16 v[16:17], v12 offset:49152
 ds_read_b64_tr_b16 v[18:19], v12 offset:49408
 ds_read_b64_tr_b16 v[20:21], v12 offset:53248
 ds_read_b64_tr_b16 v[22:23], v12 offset:53504
 s_waitcnt lgkmcnt(10)
 v_mfma_f32_32x32x16_bf16 v[64:79], v[32:35], v[232:235], v[64:79]
 ds_read_b128 v[244:247], v9 offset:49152
 ds_read_b64_tr_b16 v[24:25], v12 offset:50176
 v_mfma_f32_32x32x16_bf16 v[80:95], v[232:235], v[36:39], v[80:95]
 ds_read_b64_tr_b16 v[26:27], v12 offset:50432
 ds_read_b64_tr_b16 v[28:29], v12 offset:54272
 v_mfma_f32_32x32x16_bf16 v[112:127], v[232:235], v[232:235], v[112:127]
 ds_read_b64_tr_b16 v[30:31], v12 offset:54528
 s_waitcnt lgkmcnt(10)
 v_mfma_f32_32x32x16_bf16 v[64:79], v[40:43], v[236:239], v[64:79]
 ds_read_b128 v[248:251], v10 offset:49152
 ds_read_b64_tr_b16 v[32:33], v12 offset:51200
 v_mfma_f32_32x32x16_bf16 v[80:95], v[236:239], v[44:47], v[80:95]
 ds_read_b64_tr_b16 v[34:35], v12 offset:51456
 ds_read_b64_tr_b16 v[36:37], v12 offset:55296
 v_mfma_f32_32x32x16_bf16 v[112:127], v[236:239], v[236:239], v[112:127]
 ds_read_b64_tr_b16 v[38:39], v12 offset:55552
 s_waitcnt lgkmcnt(10)
 v_mfma_f32_32x32x16_bf16 v[64:79], v[16:19], v[240:243], v[64:79]
 ds_read_b128 v[252:255], v11 offset:49152
 ds_read_b64_tr_b16 v[40:41], v12 offset:52224
 v_mfma_f32_32x32x16_bf16 v[80:95], v[240:243], v[20:23], v[80:95]
 ds_read_b64_tr_b16 v[42:43], v12 offset:52480
 ds_read_b64_tr_b16 v[44:45], v12 offset:56320
 v_mfma_f32_32x32x16_bf16 v[112:127], v[240:243], v[240:243], v[112:127]
 ds_read_b64_tr_b16 v[46:47], v12 offset:56576
 s_waitcnt lgkmcnt(10)
 v_mfma_f32_32x32x16_bf16 v[64:79], v[24:27], v[244:247], v[64:79]
 v_mfma_f32_32x32x16_bf16 v[80:95], v[244:247], v[28:31], v[80:95]
 v_mfma_f32_32x32x16_bf16 v[112:127], v[244:247], v[244:247], v[112:127]
 s_waitcnt lgkmcnt(5)
 v_mfma_f32_32x32x16_bf16 v[64:79], v[32:35], v[248:251], v[64:79]
 v_mfma_f32_32x32x16_bf16 v[80:95], v[248:251], v[36:39], v[80:95]
 v_mfma_f32_32x32x16_bf16 v[112:127], v[248:251], v[248:251], v[112:127]
 s_waitcnt lgkmcnt(0)
 v_mfma_f32_32x32x16_bf16 v[64:79], v[40:43], v[252:255], v[64:79]
 v_mfma_f32_32x32x16_bf16 v[80:95], v[252:255], v[44:47], v[80:95]
 v_mfma_f32_32x32x16_bf16 v[112:127], v[252:255], v[252:255], v[112:127]
 v_bfe_i32 v60, v0, 0, 1
 v_bfe_i32 v61, v0, 1, 1
 v_bfe_i32 v62, v0, 3, 1
 v_bfe_i32 v63, v0, 4, 1
 v_bfe_u32 v52, v0, 2, 1
 v_lshrrev_b32 v53, 5, v0
 v_xor_b32 v52, v52, v53
 v_add_u32 v52, -1, v52
 s_nop 4
 v_bfi_b32 v112, v60, v113, v112
 v_bfi_b32 v113, v60, v115, v114
 v_bfi_b32 v114, v60, v117, v116
 v_bfi_b32 v115, v60, v119, v118
 v_bfi_b32 v116, v60, v121, v120
 v_bfi_b32 v117, v60, v123, v122
 v_bfi_b32 v118, v60, v125, v124
 v_bfi_b32 v119, v60, v127, v126
 v_bfi_b32 v112, v61, v113, v112
 v_bfi_b32 v113, v61, v115, v114
 v_bfi_b32 v114, v61, v117, v116
 v_bfi_b32 v115, v61, v119, v118
 v_bfi_b32 v112, v62, v113, v112
 v_bfi_b32 v113, v62, v115, v114
 v_bfi_b32 v112, v63, v113, v112
 v_and_b32 v50, v52, v112
 v_mov_b32 v61, v50
 v_mov_b32 v46, 0
 v_mov_b32 v47, 0
 v_permlane32_swap_b32 v50, v61
 v_mov_b32 v58, 0
 v_add_f32 v50, v50, v61
 v_mov_b32 v59, 0
 v_lshrrev_b32 v8, 3, v0
 v_lshlrev_b32 v8, 10, v8
 v_and_b32 v9, 7, v0
 v_bfe_u32 v10, v0, 4, 1
 v_lshlrev_b32 v10, 2, v10
 v_xor_b32 v10, v9, v10
 v_lshl_add_u32 v10, v10, 4, v8
 s_lshl_b32 s72, s36, 7
 v_add_u32 v10, s72, v10
 s_lshl_b32 s72, s26, 13
 v_add_u32 v8, s72, v8
 v_lshl_add_u32 v11, v9, 4, v8
 v_lshrrev_b32 v8, 5, v0
 v_lshlrev_b32 v8, 2, v8
 v_bfe_u32 v9, v0, 2, 2
 v_add_u32 v8, v8, v9
 v_lshlrev_b32 v8, 7, v8
 v_bfe_u32 v9, v0, 3, 1
 v_lshl_add_u32 v8, v9, 6, v8
 v_bfe_u32 v9, v0, 4, 1
 v_lshl_add_u32 v8, v9, 5, v8
 v_and_b32 v9, 3, v0
 v_lshl_add_u32 v8, v9, 3, v8
 v_add_u32 v12, s82, v8
 s_waitcnt lgkmcnt(0)
 s_barrier
 ds_read_b32 v49, v4
 ds_read_b64_tr_b16 v[32:33], v13 offset:0
 ds_read_b64_tr_b16 v[34:35], v13 offset:256
 ds_read_b64_tr_b16 v[36:37], v13 offset:4096
 ds_read_b64_tr_b16 v[38:39], v13 offset:4352
 s_waitcnt lgkmcnt(2)
 v_mfma_f32_32x32x16_bf16 v[96:111], v[32:35], v[128:131], 0
 ds_read_b64_tr_b16 v[40:41], v13 offset:1024
 ds_read_b64_tr_b16 v[42:43], v13 offset:1280
 ds_read_b64_tr_b16 v[16:17], v13 offset:5120
 ds_read_b64_tr_b16 v[18:19], v13 offset:5376
 s_waitcnt lgkmcnt(8)
 s_waitcnt lgkmcnt(4)
 v_mfma_f32_32x32x16_bf16 v[112:127], v[36:39], v[128:131], 0
 ds_read_b64_tr_b16 v[20:21], v13 offset:2048
 ds_read_b64_tr_b16 v[22:23], v13 offset:2304
 ds_read_b64_tr_b16 v[24:25], v13 offset:6144
 ds_read_b64_tr_b16 v[26:27], v13 offset:6400
 v_mul_f32 v49, 0x3b000000, v49
 v_mul_f32 v50, 0x3b000000, v50
 v_fma_f32 v50, -v49, v49, v50
 v_cvt_pk_bf16_f32 v44, -v49, -v49
 s_waitcnt lgkmcnt(6)
 v_mfma_f32_32x32x16_bf16 v[96:111], v[40:43], v[132:135], v[96:111]
 ds_read_b64_tr_b16 v[28:29], v13 offset:3072
 ds_read_b64_tr_b16 v[30:31], v13 offset:3328
 ds_read_b64_tr_b16 v[32:33], v13 offset:7168
 ds_read_b64_tr_b16 v[34:35], v13 offset:7424
 v_max_f32 v50, 0, v50
 v_mov_b32 v45, v44
 v_cvt_pk_bf16_f32 v50, v50, v50
 v_and_b32 v50, 0xffff0000, v50
 s_waitcnt lgkmcnt(8)
 v_mfma_f32_32x32x16_bf16 v[112:127], v[16:19], v[132:135], v[112:127]
 ds_read_b64_tr_b16 v[36:37], v13 offset:8192
 ds_read_b64_tr_b16 v[38:39], v13 offset:8448
 ds_read_b64_tr_b16 v[40:41], v13 offset:12288
 ds_read_b64_tr_b16 v[42:43], v13 offset:12544
 v_add_f32 v50, 0x3727c5ac, v50
 v_cvt_pk_bf16_f32 v50, v50, v50
 v_and_b32 v50, 0xffff0000, v50
 v_sqrt_f32 v50, v50
 s_waitcnt lgkmcnt(10)
 v_mfma_f32_32x32x16_bf16 v[96:111], v[20:23], v[136:139], v[96:111]
 ds_read_b64_tr_b16 v[16:17], v13 offset:9216
 ds_read_b64_tr_b16 v[18:19], v13 offset:9472
 s_nop 0
 v_cvt_pk_bf16_f32 v50, v50, v50
 v_and_b32 v50, 0xffff0000, v50
 v_rcp_f32 v48, v50
 s_waitcnt lgkmcnt(10)
 v_mfma_f32_32x32x16_bf16 v[112:127], v[24:27], v[136:139], v[112:127]
 ds_read_b64_tr_b16 v[20:21], v13 offset:13312
 ds_read_b64_tr_b16 v[22:23], v13 offset:13568
 s_nop 0
 ds_write_b32 v4, v48 offset:512
 v_mov_b32 v9, 147496
 s_mov_b32 s39, 1048576
LS_116:
 ds_read_b32 v8, v9 offset:0
 s_waitcnt lgkmcnt(0)
 v_cmp_gt_u32 vcc, 1, v8
 s_nop 0
 s_cbranch_vccz LD_117
 s_sub_u32 s39, s39, 1
 s_cbranch_scc0 LS_116
LD_117:
 ds_read_b64 v[56:57], v51 offset:0
 v_mfma_f32_32x32x16_bf16 v[96:111], v[28:31], v[140:143], v[96:111]
 ds_read_b64_tr_b16 v[24:25], v13 offset:10240
 ds_read_b64_tr_b16 v[26:27], v13 offset:10496
 v_mfma_f32_32x32x16_bf16 v[112:127], v[32:35], v[140:143], v[112:127]
 ds_read_b32 v2, v1
 ds_read_b64_tr_b16 v[28:29], v13 offset:14336
 ds_read_b64_tr_b16 v[30:31], v13 offset:14592
 v_mfma_f32_32x32x16_bf16 v[96:111], v[36:39], v[144:147], v[96:111]
 ds_read_b64_tr_b16 v[32:33], v13 offset:11264
 ds_read_b64_tr_b16 v[34:35], v13 offset:11520
 v_mfma_f32_32x32x16_bf16 v[112:127], v[40:43], v[144:147], v[112:127]
 ds_read_b64_tr_b16 v[36:37], v13 offset:15360
 ds_read_b64_tr_b16 v[38:39], v13 offset:15616
 s_waitcnt lgkmcnt(9)
 v_mfma_f32_32x32x16_bf16 v[64:79], v[56:59], v[44:47], v[64:79]
 v_mfma_f32_32x32x16_bf16 v[96:111], v[16:19], v[148:151], v[96:111]
 s_waitcnt lgkmcnt(6)
 v_cmp_gt_u32 vcc, 2, v2
 s_nop 0
 s_cbranch_vccz LD_119
 s_mov_b32 s39, 1048576
LS_118:
 ds_read_b32 v2, v1 offset:0
 s_waitcnt lgkmcnt(0)
 v_cmp_gt_u32 vcc, 2, v2
 s_nop 0
 s_cbranch_vccz LD_119
 s_sub_u32 s39, s39, 1
 s_cbranch_scc0 LS_118
LD_119:
 ds_read_b64_tr_b16 v[40:41], v13 offset:16384
 ds_read_b64_tr_b16 v[42:43], v13 offset:16640
 ds_read_b64 v[56:57], v51 offset:512
 v_mfma_f32_32x32x16_bf16 v[112:127], v[20:23], v[148:151], v[112:127]
 ds_read_b64_tr_b16 v[16:17], v13 offset:20480
 ds_read_b64_tr_b16 v[18:19], v13 offset:20736
 s_waitcnt lgkmcnt(12)
 v_mfma_f32_32x32x16_bf16 v[96:111], v[24:27], v[152:155], v[96:111]
 ds_read_b64_tr_b16 v[20:21], v13 offset:17408
 ds_read_b64_tr_b16 v[22:23], v13 offset:17664
 v_mul_f32 v64, v64, v48
 s_waitcnt lgkmcnt(11)
 v_mfma_f32_32x32x16_bf16 v[112:127], v[28:31], v[152:155], v[112:127]
 ds_read_b64_tr_b16 v[24:25], v13 offset:21504
 ds_read_b64_tr_b16 v[26:27], v13 offset:21760
 v_mul_f32 v65, v65, v48
 v_mul_f32 v66, v66, v48
 v_mul_f32 v67, v67, v48
 v_mul_f32 v68, v68, v48
 s_waitcnt lgkmcnt(11)
 v_mfma_f32_32x32x16_bf16 v[96:111], v[32:35], v[156:159], v[96:111]
 ds_read_b64_tr_b16 v[28:29], v13 offset:18432
 ds_read_b64_tr_b16 v[30:31], v13 offset:18688
 v_mul_f32 v69, v69, v48
 v_mul_f32 v70, v70, v48
 v_mul_f32 v71, v71, v48
 v_mul_f32 v72, v72, v48
 s_waitcnt lgkmcnt(11)
 v_mov_b32 v5, 1
 ds_write_b32 v1, v5 offset:64
 v_mfma_f32_32x32x16_bf16 v[112:127], v[36:39], v[156:159], v[112:127]
 ds_read_b64_tr_b16 v[32:33], v13 offset:22528
 ds_read_b64_tr_b16 v[34:35], v13 offset:22784
 v_mul_f32 v73, v73, v48
 v_mul_f32 v74, v74, v48
 v_mul_f32 v75, v75, v48
 v_mul_f32 v76, v76, v48
 s_waitcnt lgkmcnt(12)
 v_mfma_f32_32x32x16_bf16 v[96:111], v[40:43], v[160:163], v[96:111]
 ds_read_b64_tr_b16 v[36:37], v13 offset:19456
 ds_read_b64_tr_b16 v[38:39], v13 offset:19712
 v_mul_f32 v77, v77, v48
 v_mul_f32 v78, v78, v48
 v_mul_f32 v79, v79, v48
 v_cvt_pk_bf16_f32 v64, v64, v65
 s_waitcnt lgkmcnt(11)
 v_mfma_f32_32x32x16_bf16 v[112:127], v[16:19], v[160:163], v[112:127]
 ds_read_b64_tr_b16 v[40:41], v13 offset:23552
 ds_read_b64_tr_b16 v[42:43], v13 offset:23808
 v_cvt_pk_bf16_f32 v65, v66, v67
 v_cvt_pk_bf16_f32 v66, v68, v69
 v_cvt_pk_bf16_f32 v67, v70, v71
 v_cvt_pk_bf16_f32 v68, v72, v73
 s_waitcnt lgkmcnt(11)
 v_mfma_f32_32x32x16_bf16 v[96:111], v[20:23], v[164:167], v[96:111]
 ds_read_b64_tr_b16 v[16:17], v13 offset:24576
 ds_read_b64_tr_b16 v[18:19], v13 offset:24832
 v_cvt_pk_bf16_f32 v69, v74, v75
 v_cvt_pk_bf16_f32 v70, v76, v77
 v_cvt_pk_bf16_f32 v71, v78, v79
 ds_read_b128 v[72:75], v3 offset:0
 s_waitcnt lgkmcnt(12)
 v_mfma_f32_32x32x16_bf16 v[112:127], v[24:27], v[164:167], v[112:127]
 ds_read_b64_tr_b16 v[20:21], v13 offset:28672
 ds_read_b64_tr_b16 v[22:23], v13 offset:28928
 ds_read_b128 v[76:79], v3 offset:32
 ds_write_b128 v14, v[64:67] offset:0
 ds_write_b128 v14, v[68:71] offset:1024
 v_mov_b32 v5, 1
 ds_write_b32 v1, v5 offset:96
 s_waitcnt lgkmcnt(15)
 v_mfma_f32_32x32x16_bf16 v[96:111], v[28:31], v[168:171], v[96:111]
 ds_read_b64_tr_b16 v[24:25], v13 offset:25600
 ds_read_b64_tr_b16 v[26:27], v13 offset:25856
 s_waitcnt lgkmcnt(15)
 v_mfma_f32_32x32x16_bf16 v[80:95], v[44:47], v[56:59], v[80:95]
 s_waitcnt lgkmcnt(15)
 v_mfma_f32_32x32x16_bf16 v[112:127], v[32:35], v[168:171], v[112:127]
 ds_read_b64_tr_b16 v[28:29], v13 offset:29696
 ds_read_b64_tr_b16 v[30:31], v13 offset:29952
 s_waitcnt lgkmcnt(15)
 v_mfma_f32_32x32x16_bf16 v[96:111], v[36:39], v[172:175], v[96:111]
 ds_read_b64_tr_b16 v[32:33], v13 offset:26624
 ds_read_b64_tr_b16 v[34:35], v13 offset:26880
 s_waitcnt lgkmcnt(15)
 v_mfma_f32_32x32x16_bf16 v[112:127], v[40:43], v[172:175], v[112:127]
 ds_read_b32 v2, v1
 ds_read_b64_tr_b16 v[36:37], v13 offset:30720
 ds_read_b64_tr_b16 v[38:39], v13 offset:30976
 s_waitcnt lgkmcnt(15)
 v_mfma_f32_32x32x16_bf16 v[96:111], v[16:19], v[176:179], v[96:111]
 ds_read_b64_tr_b16 v[40:41], v13 offset:27648
 ds_read_b64_tr_b16 v[42:43], v13 offset:27904
 s_waitcnt lgkmcnt(14)
 v_mul_f32 v80, v80, v72
 v_mul_f32 v81, v81, v73
 v_mul_f32 v82, v82, v74
 s_waitcnt lgkmcnt(15)
 v_mfma_f32_32x32x16_bf16 v[112:127], v[20:23], v[176:179], v[112:127]
 ds_read_b64_tr_b16 v[16:17], v13 offset:31744
 ds_read_b64_tr_b16 v[18:19], v13 offset:32000
 v_mul_f32 v83, v83, v75
 v_mul_f32 v84, v84, v76
 v_mul_f32 v85, v85, v77
 v_mul_f32 v86, v86, v78
 s_waitcnt lgkmcnt(11)
 v_mfma_f32_32x32x16_bf16 v[96:111], v[24:27], v[180:183], v[96:111]
 s_waitcnt lgkmcnt(6)
 v_cmp_gt_u32 vcc, 3, v2
 s_nop 0
 s_cbranch_vccz LD_121
 s_mov_b32 s39, 1048576
LS_120:
 ds_read_b32 v2, v1 offset:0
 s_waitcnt lgkmcnt(0)
 v_cmp_gt_u32 vcc, 3, v2
 s_nop 0
 s_cbranch_vccz LD_121
 s_sub_u32 s39, s39, 1
 s_cbranch_scc0 LS_120
LD_121:
 ds_read_b64_tr_b16 v[20:21], v13 offset:32768
 ds_read_b64_tr_b16 v[22:23], v13 offset:33024
 v_mul_f32 v87, v87, v79
 ds_read_b128 v[72:75], v3 offset:64
 ds_read_b128 v[76:79], v3 offset:96
 v_cvt_pk_bf16_f32 v80, v80, v81
 s_waitcnt lgkmcnt(13)
 v_mfma_f32_32x32x16_bf16 v[112:127], v[28:31], v[180:183], v[112:127]
 ds_read_b64_tr_b16 v[24:25], v13 offset:36864
 ds_read_b64_tr_b16 v[26:27], v13 offset:37120
 v_cvt_pk_bf16_f32 v81, v82, v83
 v_cvt_pk_bf16_f32 v82, v84, v85
 v_cvt_pk_bf16_f32 v83, v86, v87
 s_waitcnt lgkmcnt(13)
 v_mfma_f32_32x32x16_bf16 v[96:111], v[32:35], v[184:187], v[96:111]
 ds_read_b64_tr_b16 v[28:29], v13 offset:33792
 ds_read_b64_tr_b16 v[30:31], v13 offset:34048
 s_waitcnt lgkmcnt(12)
 v_mfma_f32_32x32x16_bf16 v[112:127], v[36:39], v[184:187], v[112:127]
 ds_read_b64_tr_b16 v[32:33], v13 offset:37888
 ds_read_b64_tr_b16 v[34:35], v13 offset:38144
 s_waitcnt lgkmcnt(12)
 v_mfma_f32_32x32x16_bf16 v[96:111], v[40:43], v[188:191], v[96:111]
 ds_read_b64_tr_b16 v[36:37], v13 offset:34816
 ds_read_b64_tr_b16 v[38:39], v13 offset:35072
 s_waitcnt lgkmcnt(8)
 v_mul_f32 v88, v88, v72
 v_mul_f32 v89, v89, v73
 s_waitcnt lgkmcnt(12)
 v_mov_b32 v5, 2
 ds_write_b32 v1, v5 offset:64
 v_mfma_f32_32x32x16_bf16 v[112:127], v[16:19], v[188:191], v[112:127]
 ds_read_b64_tr_b16 v[40:41], v13 offset:38912
 ds_read_b64_tr_b16 v[42:43], v13 offset:39168
 v_mul_f32 v90, v90, v74
 v_mul_f32 v91, v91, v75
 v_mul_f32 v92, v92, v76
 v_mul_f32 v93, v93, v77
 s_waitcnt lgkmcnt(13)
 v_mfma_f32_32x32x16_bf16 v[96:111], v[20:23], v[192:195], v[96:111]
 ds_read_b64_tr_b16 v[16:17], v13 offset:35840
 ds_read_b64_tr_b16 v[18:19], v13 offset:36096
 v_mul_f32 v94, v94, v78
 v_mul_f32 v95, v95, v79
 v_cvt_pk_bf16_f32 v84, v88, v89
 v_cvt_pk_bf16_f32 v85, v90, v91
 s_waitcnt lgkmcnt(11)
 v_mfma_f32_32x32x16_bf16 v[112:127], v[24:27], v[192:195], v[112:127]
 ds_read_b64_tr_b16 v[20:21], v13 offset:39936
 ds_read_b64_tr_b16 v[22:23], v13 offset:40192
 v_cvt_pk_bf16_f32 v86, v92, v93
 v_cvt_pk_bf16_f32 v87, v94, v95
 ds_write_b128 v14, v[80:83] offset:2048
 ds_write_b128 v14, v[84:87] offset:3072
 s_waitcnt lgkmcnt(13)
 v_mfma_f32_32x32x16_bf16 v[96:111], v[28:31], v[196:199], v[96:111]
 ds_read_b64_tr_b16 v[24:25], v13 offset:40960
 ds_read_b64_tr_b16 v[26:27], v13 offset:41216
 v_mov_b32 v5, 2
 ds_write_b32 v1, v5 offset:96
 s_waitcnt lgkmcnt(14)
 v_mfma_f32_32x32x16_bf16 v[112:127], v[32:35], v[196:199], v[112:127]
 ds_read_b64_tr_b16 v[28:29], v13 offset:45056
 ds_read_b64_tr_b16 v[30:31], v13 offset:45312
 s_waitcnt lgkmcnt(14)
 v_mfma_f32_32x32x16_bf16 v[96:111], v[36:39], v[200:203], v[96:111]
 ds_read_b64_tr_b16 v[32:33], v13 offset:41984
 ds_read_b64_tr_b16 v[34:35], v13 offset:42240
 s_waitcnt lgkmcnt(13)
 v_mfma_f32_32x32x16_bf16 v[112:127], v[40:43], v[200:203], v[112:127]
 ds_read_b64_tr_b16 v[36:37], v13 offset:46080
 ds_read_b64_tr_b16 v[38:39], v13 offset:46336
 s_waitcnt lgkmcnt(13)
 v_mfma_f32_32x32x16_bf16 v[96:111], v[16:19], v[204:207], v[96:111]
 ds_read_b64_tr_b16 v[40:41], v13 offset:43008
 ds_read_b64_tr_b16 v[42:43], v13 offset:43264
 s_waitcnt lgkmcnt(13)
 v_mfma_f32_32x32x16_bf16 v[112:127], v[20:23], v[204:207], v[112:127]
 ds_read_b32 v2, v1
 ds_read_b64_tr_b16 v[16:17], v13 offset:47104
 ds_read_b64_tr_b16 v[18:19], v13 offset:47360
 s_waitcnt lgkmcnt(12)
 v_mfma_f32_32x32x16_bf16 v[96:111], v[24:27], v[208:211], v[96:111]
 ds_read_b64_tr_b16 v[20:21], v13 offset:44032
 ds_read_b64_tr_b16 v[22:23], v13 offset:44288
 s_waitcnt lgkmcnt(11)
 v_mfma_f32_32x32x16_bf16 v[112:127], v[28:31], v[208:211], v[112:127]
 ds_read_b64_tr_b16 v[24:25], v13 offset:48128
 ds_read_b64_tr_b16 v[26:27], v13 offset:48384
 s_waitcnt lgkmcnt(11)
 v_mfma_f32_32x32x16_bf16 v[96:111], v[32:35], v[212:215], v[96:111]
 s_waitcnt lgkmcnt(6)
 v_cmp_gt_u32 vcc, 4, v2
 s_nop 0
 s_cbranch_vccz LD_123
 s_mov_b32 s39, 1048576
LS_122:
 ds_read_b32 v2, v1 offset:0
 s_waitcnt lgkmcnt(0)
 v_cmp_gt_u32 vcc, 4, v2
 s_nop 0
 s_cbranch_vccz LD_123
 s_sub_u32 s39, s39, 1
 s_cbranch_scc0 LS_122
LD_123:
 ds_read_b64_tr_b16 v[28:29], v13 offset:49152
 ds_read_b64_tr_b16 v[30:31], v13 offset:49408
 s_waitcnt lgkmcnt(11)
 v_mfma_f32_32x32x16_bf16 v[112:127], v[36:39], v[212:215], v[112:127]
 ds_read_b64_tr_b16 v[32:33], v13 offset:53248
 ds_read_b64_tr_b16 v[34:35], v13 offset:53504
 s_waitcnt lgkmcnt(11)
 v_mfma_f32_32x32x16_bf16 v[96:111], v[40:43], v[216:219], v[96:111]
 ds_read_b64_tr_b16 v[36:37], v13 offset:50176
 ds_read_b64_tr_b16 v[38:39], v13 offset:50432
 s_waitcnt lgkmcnt(10)
 v_mfma_f32_32x32x16_bf16 v[112:127], v[16:19], v[216:219], v[112:127]
 ds_read_b64_tr_b16 v[40:41], v13 offset:54272
 ds_read_b64_tr_b16 v[42:43], v13 offset:54528
 s_waitcnt lgkmcnt(10)
 v_mfma_f32_32x32x16_bf16 v[96:111], v[20:23], v[220:223], v[96:111]
 ds_read_b64_tr_b16 v[16:17], v13 offset:51200
 ds_read_b64_tr_b16 v[18:19], v13 offset:51456
 s_waitcnt lgkmcnt(10)
 v_mov_b32 v5, 3
 ds_write_b32 v1, v5 offset:64
 v_mfma_f32_32x32x16_bf16 v[112:127], v[24:27], v[220:223], v[112:127]
 ds_read_b64_tr_b16 v[20:21], v13 offset:55296
 ds_read_b64_tr_b16 v[22:23], v13 offset:55552
 s_waitcnt lgkmcnt(11)
 v_mfma_f32_32x32x16_bf16 v[96:111], v[28:31], v[224:227], v[96:111]
 ds_read_b64_tr_b16 v[24:25], v13 offset:52224
 ds_read_b64_tr_b16 v[26:27], v13 offset:52480
 s_waitcnt lgkmcnt(11)
 v_mfma_f32_32x32x16_bf16 v[112:127], v[32:35], v[224:227], v[112:127]
 ds_read_b64_tr_b16 v[28:29], v13 offset:56320
 ds_read_b64_tr_b16 v[30:31], v13 offset:56576
 s_waitcnt lgkmcnt(11)
 v_mfma_f32_32x32x16_bf16 v[96:111], v[36:39], v[228:231], v[96:111]
 ds_read_b64_tr_b16 v[32:33], v13 offset:57344
 ds_read_b64_tr_b16 v[34:35], v13 offset:57600
 s_waitcnt lgkmcnt(11)
 v_mfma_f32_32x32x16_bf16 v[112:127], v[40:43], v[228:231], v[112:127]
 ds_read_b64_tr_b16 v[36:37], v13 offset:61440
 ds_read_b64_tr_b16 v[38:39], v13 offset:61696
 s_waitcnt lgkmcnt(11)
 v_mfma_f32_32x32x16_bf16 v[96:111], v[16:19], v[232:235], v[96:111]
 ds_read_b64_tr_b16 v[40:41], v13 offset:58368
 ds_read_b64_tr_b16 v[42:43], v13 offset:58624
 s_waitcnt lgkmcnt(10)
 v_mfma_f32_32x32x16_bf16 v[112:127], v[20:23], v[232:235], v[112:127]
 ds_read_b64_tr_b16 v[16:17], v13 offset:62464
 ds_read_b64_tr_b16 v[18:19], v13 offset:62720
 s_waitcnt lgkmcnt(10)
 v_mfma_f32_32x32x16_bf16 v[96:111], v[24:27], v[236:239], v[96:111]
 ds_read_b64_tr_b16 v[20:21], v13 offset:59392
 ds_read_b64_tr_b16 v[22:23], v13 offset:59648
 s_waitcnt lgkmcnt(10)
 v_mfma_f32_32x32x16_bf16 v[112:127], v[28:31], v[236:239], v[112:127]
 ds_read_b32 v2, v1
 ds_read_b64_tr_b16 v[24:25], v13 offset:63488
 ds_read_b64_tr_b16 v[26:27], v13 offset:63744
 s_waitcnt lgkmcnt(11)
 v_mfma_f32_32x32x16_bf16 v[96:111], v[32:35], v[240:243], v[96:111]
 ds_read_b64_tr_b16 v[28:29], v13 offset:60416
 ds_read_b64_tr_b16 v[30:31], v13 offset:60672
 s_waitcnt lgkmcnt(11)
 v_mfma_f32_32x32x16_bf16 v[112:127], v[36:39], v[240:243], v[112:127]
 ds_read_b64_tr_b16 v[32:33], v13 offset:64512
 ds_read_b64_tr_b16 v[34:35], v13 offset:64768
 s_waitcnt lgkmcnt(11)
 v_mfma_f32_32x32x16_bf16 v[96:111], v[40:43], v[244:247], v[96:111]
 s_waitcnt lgkmcnt(6)
 v_cmp_gt_u32 vcc, 5, v2
 s_nop 0
 s_cbranch_vccz LD_125
 s_mov_b32 s39, 1048576
LS_124:
 ds_read_b32 v2, v1 offset:0
 s_waitcnt lgkmcnt(0)
 v_cmp_gt_u32 vcc, 5, v2
 s_nop 0
 s_cbranch_vccz LD_125
 s_sub_u32 s39, s39, 1
 s_cbranch_scc0 LS_124
LD_125:
 ds_read_b64_tr_b16 v[36:37], v13 offset:0
 ds_read_b64_tr_b16 v[38:39], v13 offset:256
 s_waitcnt lgkmcnt(11)
 v_mfma_f32_32x32x16_bf16 v[112:127], v[16:19], v[244:247], v[112:127]
 ds_read_b64_tr_b16 v[40:41], v13 offset:1024
 ds_read_b64_tr_b16 v[42:43], v13 offset:1280
 s_waitcnt lgkmcnt(11)
 v_mfma_f32_32x32x16_bf16 v[96:111], v[20:23], v[248:251], v[96:111]
 ds_read_b64_tr_b16 v[16:17], v13 offset:2048
 ds_read_b64_tr_b16 v[18:19], v13 offset:2304
 s_waitcnt lgkmcnt(10)
 v_mfma_f32_32x32x16_bf16 v[112:127], v[24:27], v[248:251], v[112:127]
 ds_read_b64_tr_b16 v[20:21], v13 offset:3072
 ds_read_b64_tr_b16 v[22:23], v13 offset:3328
 s_waitcnt lgkmcnt(10)
 v_mfma_f32_32x32x16_bf16 v[96:111], v[28:31], v[252:255], v[96:111]
 ds_read_b64_tr_b16 v[24:25], v13 offset:4096
 ds_read_b64_tr_b16 v[26:27], v13 offset:4352
 s_waitcnt lgkmcnt(10)
 v_mov_b32 v5, 4
 ds_write_b32 v1, v5 offset:64
 v_mfma_f32_32x32x16_bf16 v[112:127], v[32:35], v[252:255], v[112:127]
 ds_read_b64_tr_b16 v[28:29], v13 offset:5120
 ds_read_b64_tr_b16 v[30:31], v13 offset:5376
 s_waitcnt lgkmcnt(11)
 v_mfma_f32_32x32x16_bf16 v[64:79], v[36:39], v[128:131], 0
 ds_read_b64_tr_b16 v[32:33], v13 offset:6144
 ds_read_b64_tr_b16 v[34:35], v13 offset:6400
 s_mov_b32 s39, 1048576
LS_126:
 ds_read_b32 v8, v1 offset:32
 s_waitcnt lgkmcnt(0)
 v_cmp_gt_u32 vcc, 1, v8
 s_nop 0
 s_cbranch_vccz LD_127
 s_sub_u32 s39, s39, 1
 s_cbranch_scc0 LS_126
LD_127:
 ds_read_b64 v[56:57], v51 offset:1024
 v_mfma_f32_32x32x16_bf16 v[80:95], v[40:43], v[132:135], 0
 ds_read_b64_tr_b16 v[36:37], v13 offset:7168
 ds_read_b64_tr_b16 v[38:39], v13 offset:7424
 v_mfma_f32_32x32x16_bf16 v[64:79], v[16:19], v[136:139], v[64:79]
 ds_read_b64_tr_b16 v[40:41], v13 offset:8192
 ds_read_b64_tr_b16 v[42:43], v13 offset:8448
 v_mfma_f32_32x32x16_bf16 v[80:95], v[20:23], v[140:143], v[80:95]
 ds_read_b64_tr_b16 v[16:17], v13 offset:9216
 ds_read_b64_tr_b16 v[18:19], v13 offset:9472
 v_mfma_f32_32x32x16_bf16 v[64:79], v[24:27], v[144:147], v[64:79]
 ds_read_b64_tr_b16 v[20:21], v13 offset:10240
 ds_read_b64_tr_b16 v[22:23], v13 offset:10496
 s_waitcnt lgkmcnt(8)
 v_mfma_f32_32x32x16_bf16 v[96:111], v[56:59], v[44:47], v[96:111]
 v_mfma_f32_32x32x16_bf16 v[80:95], v[28:31], v[148:151], v[80:95]
 ds_read_b64_tr_b16 v[24:25], v13 offset:11264
 ds_read_b64_tr_b16 v[26:27], v13 offset:11520
 ds_read_b64 v[56:57], v51 offset:1536
 v_mfma_f32_32x32x16_bf16 v[64:79], v[32:35], v[152:155], v[64:79]
 ds_read_b64_tr_b16 v[28:29], v13 offset:12288
 ds_read_b64_tr_b16 v[30:31], v13 offset:12544
 s_waitcnt lgkmcnt(11)
 v_mfma_f32_32x32x16_bf16 v[80:95], v[36:39], v[156:159], v[80:95]
 ds_read_b32 v2, v1
 ds_read_b64_tr_b16 v[32:33], v13 offset:13312
 ds_read_b64_tr_b16 v[34:35], v13 offset:13568
 s_waitcnt lgkmcnt(12)
 v_mfma_f32_32x32x16_bf16 v[64:79], v[40:43], v[160:163], v[64:79]
 ds_read_b64_tr_b16 v[36:37], v13 offset:14336
 ds_read_b64_tr_b16 v[38:39], v13 offset:14592
 s_waitcnt lgkmcnt(12)
 v_mfma_f32_32x32x16_bf16 v[80:95], v[16:19], v[164:167], v[80:95]
 ds_read_b64_tr_b16 v[40:41], v13 offset:15360
 ds_read_b64_tr_b16 v[42:43], v13 offset:15616
 s_waitcnt lgkmcnt(9)
 v_mfma_f32_32x32x16_bf16 v[112:127], v[56:59], v[44:47], v[112:127]
 s_waitcnt lgkmcnt(12)
 v_mfma_f32_32x32x16_bf16 v[64:79], v[20:23], v[168:171], v[64:79]
 s_waitcnt lgkmcnt(6)
 v_cmp_gt_u32 vcc, 6, v2
 s_nop 0
 s_cbranch_vccz LD_129
 s_mov_b32 s39, 1048576
LS_128:
 ds_read_b32 v2, v1 offset:0
 s_waitcnt lgkmcnt(0)
 v_cmp_gt_u32 vcc, 6, v2
 s_nop 0
 s_cbranch_vccz LD_129
 s_sub_u32 s39, s39, 1
 s_cbranch_scc0 LS_128
LD_129:
 ds_read_b64_tr_b16 v[16:17], v13 offset:16384
 ds_read_b64_tr_b16 v[18:19], v13 offset:16640
 v_max_f32 v96, 0, v96
 v_max_f32 v97, 0, v97
 s_waitcnt lgkmcnt(12)
 v_mfma_f32_32x32x16_bf16 v[80:95], v[24:27], v[172:175], v[80:95]
 ds_read_b64_tr_b16 v[20:21], v13 offset:17408
 ds_read_b64_tr_b16 v[22:23], v13 offset:17664
 v_max_f32 v98, 0, v98
 v_max_f32 v99, 0, v99
 v_max_f32 v100, 0, v100
 s_waitcnt lgkmcnt(11)
 v_mfma_f32_32x32x16_bf16 v[64:79], v[28:31], v[176:179], v[64:79]
 ds_read_b64_tr_b16 v[24:25], v13 offset:18432
 ds_read_b64_tr_b16 v[26:27], v13 offset:18688
 v_max_f32 v101, 0, v101
 v_max_f32 v102, 0, v102
 v_max_f32 v103, 0, v103
 s_waitcnt lgkmcnt(10)
 v_mfma_f32_32x32x16_bf16 v[80:95], v[32:35], v[180:183], v[80:95]
 ds_read_b64_tr_b16 v[28:29], v13 offset:19456
 ds_read_b64_tr_b16 v[30:31], v13 offset:19712
 v_max_f32 v104, 0, v104
 v_max_f32 v105, 0, v105
 v_max_f32 v106, 0, v106
 s_waitcnt lgkmcnt(10)
 v_mfma_f32_32x32x16_bf16 v[64:79], v[36:39], v[184:187], v[64:79]
 ds_read_b64_tr_b16 v[32:33], v13 offset:20480
 ds_read_b64_tr_b16 v[34:35], v13 offset:20736
 v_max_f32 v107, 0, v107
 v_max_f32 v108, 0, v108
 v_max_f32 v109, 0, v109
 s_waitcnt lgkmcnt(10)
 v_mov_b32 v5, 5
 ds_write_b32 v1, v5 offset:64
 v_mfma_f32_32x32x16_bf16 v[80:95], v[40:43], v[188:191], v[80:95]
 ds_read_b64_tr_b16 v[36:37], v13 offset:21504
 ds_read_b64_tr_b16 v[38:39], v13 offset:21760
 v_max_f32 v110, 0, v110
 v_max_f32 v111, 0, v111
 v_cvt_pk_bf16_f32 v96, v96, v97
 s_waitcnt lgkmcnt(11)
 v_mfma_f32_32x32x16_bf16 v[64:79], v[16:19], v[192:195], v[64:79]
 ds_read_b64_tr_b16 v[40:41], v13 offset:22528
 ds_read_b64_tr_b16 v[42:43], v13 offset:22784
 v_cvt_pk_bf16_f32 v97, v98, v99
 v_cvt_pk_bf16_f32 v98, v100, v101
 v_cvt_pk_bf16_f32 v99, v102, v103
 s_waitcnt lgkmcnt(11)
 v_mfma_f32_32x32x16_bf16 v[80:95], v[20:23], v[196:199], v[80:95]
 ds_read_b64_tr_b16 v[16:17], v13 offset:23552
 ds_read_b64_tr_b16 v[18:19], v13 offset:23808
 v_cvt_pk_bf16_f32 v100, v104, v105
 v_cvt_pk_bf16_f32 v101, v106, v107
 v_cvt_pk_bf16_f32 v102, v108, v109
 s_waitcnt lgkmcnt(11)
 v_mfma_f32_32x32x16_bf16 v[64:79], v[24:27], v[200:203], v[64:79]
 ds_read_b64_tr_b16 v[20:21], v13 offset:24576
 ds_read_b64_tr_b16 v[22:23], v13 offset:24832
 v_cvt_pk_bf16_f32 v103, v110, v111
 ds_write_b128 v15, v[96:99] offset:0
 ds_write_b128 v15, v[100:103] offset:1024
 s_waitcnt lgkmcnt(13)
 v_mfma_f32_32x32x16_bf16 v[80:95], v[28:31], v[204:207], v[80:95]
 ds_read_b64_tr_b16 v[24:25], v13 offset:25600
 ds_read_b64_tr_b16 v[26:27], v13 offset:25856
 v_mov_b32 v5, 3
 ds_write_b32 v1, v5 offset:96
 v_max_f32 v112, 0, v112
 v_max_f32 v113, 0, v113
 s_waitcnt lgkmcnt(14)
 v_mfma_f32_32x32x16_bf16 v[64:79], v[32:35], v[208:211], v[64:79]
 ds_read_b64_tr_b16 v[28:29], v13 offset:26624
 ds_read_b64_tr_b16 v[30:31], v13 offset:26880
 v_max_f32 v114, 0, v114
 v_max_f32 v115, 0, v115
 v_max_f32 v116, 0, v116
 s_waitcnt lgkmcnt(13)
 v_mfma_f32_32x32x16_bf16 v[80:95], v[36:39], v[212:215], v[80:95]
 ds_read_b64_tr_b16 v[32:33], v13 offset:27648
 ds_read_b64_tr_b16 v[34:35], v13 offset:27904
 v_max_f32 v117, 0, v117
 v_max_f32 v118, 0, v118
 v_max_f32 v119, 0, v119
 s_waitcnt lgkmcnt(13)
 v_mfma_f32_32x32x16_bf16 v[64:79], v[40:43], v[216:219], v[64:79]
 ds_read_b64_tr_b16 v[36:37], v13 offset:28672
 ds_read_b64_tr_b16 v[38:39], v13 offset:28928
 v_max_f32 v120, 0, v120
 v_max_f32 v121, 0, v121
 v_max_f32 v122, 0, v122
 s_waitcnt lgkmcnt(13)
 v_mfma_f32_32x32x16_bf16 v[80:95], v[16:19], v[220:223], v[80:95]
 ds_read_b32 v2, v1
 ds_read_b64_tr_b16 v[40:41], v13 offset:29696
 ds_read_b64_tr_b16 v[42:43], v13 offset:29952
 v_max_f32 v123, 0, v123
 v_max_f32 v124, 0, v124
 v_max_f32 v125, 0, v125
 s_waitcnt lgkmcnt(14)
 v_mfma_f32_32x32x16_bf16 v[64:79], v[20:23], v[224:227], v[64:79]
 ds_read_b64_tr_b16 v[16:17], v13 offset:30720
 ds_read_b64_tr_b16 v[18:19], v13 offset:30976
 v_max_f32 v126, 0, v126
 v_max_f32 v127, 0, v127
 v_cvt_pk_bf16_f32 v112, v112, v113
 s_waitcnt lgkmcnt(12)
 v_mfma_f32_32x32x16_bf16 v[80:95], v[24:27], v[228:231], v[80:95]
 ds_read_b64_tr_b16 v[20:21], v13 offset:31744
 ds_read_b64_tr_b16 v[22:23], v13 offset:32000
 v_cvt_pk_bf16_f32 v113, v114, v115
 v_cvt_pk_bf16_f32 v114, v116, v117
 v_cvt_pk_bf16_f32 v115, v118, v119
 s_waitcnt lgkmcnt(11)
 v_mfma_f32_32x32x16_bf16 v[64:79], v[28:31], v[232:235], v[64:79]
 s_waitcnt lgkmcnt(6)
 v_cmp_gt_u32 vcc, 7, v2
 s_nop 0
 s_cbranch_vccz LD_131
 s_mov_b32 s39, 1048576
LS_130:
 ds_read_b32 v2, v1 offset:0
 s_waitcnt lgkmcnt(0)
 v_cmp_gt_u32 vcc, 7, v2
 s_nop 0
 s_cbranch_vccz LD_131
 s_sub_u32 s39, s39, 1
 s_cbranch_scc0 LS_130
LD_131:
 ds_read_b64_tr_b16 v[24:25], v13 offset:32768
 ds_read_b64_tr_b16 v[26:27], v13 offset:33024
 v_cvt_pk_bf16_f32 v116, v120, v121
 v_cvt_pk_bf16_f32 v117, v122, v123
 v_cvt_pk_bf16_f32 v118, v124, v125
 s_waitcnt lgkmcnt(11)
 v_mfma_f32_32x32x16_bf16 v[80:95], v[32:35], v[236:239], v[80:95]
 ds_read_b64_tr_b16 v[28:29], v13 offset:33792
 ds_read_b64_tr_b16 v[30:31], v13 offset:34048
 v_cvt_pk_bf16_f32 v119, v126, v127
 ds_write_b128 v15, v[112:115] offset:8192
 ds_write_b128 v15, v[116:119] offset:9216
 s_waitcnt lgkmcnt(13)
 v_mfma_f32_32x32x16_bf16 v[64:79], v[36:39], v[240:243], v[64:79]
 ds_read_b64_tr_b16 v[32:33], v13 offset:34816
 ds_read_b64_tr_b16 v[34:35], v13 offset:35072
 v_mov_b32 v5, 4
 ds_write_b32 v1, v5 offset:96
 s_waitcnt lgkmcnt(13)
 v_mfma_f32_32x32x16_bf16 v[80:95], v[40:43], v[244:247], v[80:95]
 ds_read_b64_tr_b16 v[36:37], v13 offset:35840
 ds_read_b64_tr_b16 v[38:39], v13 offset:36096
 s_waitcnt lgkmcnt(13)
 v_mfma_f32_32x32x16_bf16 v[64:79], v[16:19], v[248:251], v[64:79]
 ds_read_b64_tr_b16 v[40:41], v13 offset:36864
 ds_read_b64_tr_b16 v[42:43], v13 offset:37120
 s_waitcnt lgkmcnt(13)
 v_mov_b32 v5, 6
 ds_write_b32 v1, v5 offset:64
 v_mfma_f32_32x32x16_bf16 v[80:95], v[20:23], v[252:255], v[80:95]
 ds_read_b64_tr_b16 v[16:17], v13 offset:37888
 ds_read_b64_tr_b16 v[18:19], v13 offset:38144
 s_waitcnt lgkmcnt(14)
 v_mfma_f32_32x32x16_bf16 v[96:111], v[24:27], v[128:131], 0
 ds_read_b64_tr_b16 v[20:21], v13 offset:38912
 ds_read_b64_tr_b16 v[22:23], v13 offset:39168
 s_waitcnt lgkmcnt(14)
 v_mfma_f32_32x32x16_bf16 v[112:127], v[28:31], v[132:135], 0
 ds_read_b64_tr_b16 v[24:25], v13 offset:39936
 ds_read_b64_tr_b16 v[26:27], v13 offset:40192
 s_waitcnt lgkmcnt(12)
 v_mfma_f32_32x32x16_bf16 v[96:111], v[32:35], v[136:139], v[96:111]
 ds_read_b64_tr_b16 v[28:29], v13 offset:40960
 ds_read_b64_tr_b16 v[30:31], v13 offset:41216
 s_mov_b32 s39, 1048576
LS_132:
 ds_read_b32 v8, v1 offset:32
 s_waitcnt lgkmcnt(0)
 v_cmp_gt_u32 vcc, 2, v8
 s_nop 0
 s_cbranch_vccz LD_133
 s_sub_u32 s39, s39, 1
 s_cbranch_scc0 LS_132
LD_133:
 ds_read_b64 v[56:57], v51 offset:2560
 v_mfma_f32_32x32x16_bf16 v[112:127], v[36:39], v[140:143], v[112:127]
 ds_read_b64_tr_b16 v[32:33], v13 offset:41984
 ds_read_b64_tr_b16 v[34:35], v13 offset:42240
 v_mfma_f32_32x32x16_bf16 v[96:111], v[40:43], v[144:147], v[96:111]
 ds_read_b64_tr_b16 v[36:37], v13 offset:43008
 ds_read_b64_tr_b16 v[38:39], v13 offset:43264
 v_mfma_f32_32x32x16_bf16 v[112:127], v[16:19], v[148:151], v[112:127]
 ds_read_b64_tr_b16 v[40:41], v13 offset:44032
 ds_read_b64_tr_b16 v[42:43], v13 offset:44288
 v_add_f32 v64, v64, v80
 v_add_f32 v65, v65, v81
 v_mfma_f32_32x32x16_bf16 v[96:111], v[20:23], v[152:155], v[96:111]
 ds_read_b64_tr_b16 v[16:17], v13 offset:45056
 ds_read_b64_tr_b16 v[18:19], v13 offset:45312
 v_add_f32 v66, v66, v82
 v_add_f32 v67, v67, v83
 v_add_f32 v68, v68, v84
 v_mfma_f32_32x32x16_bf16 v[112:127], v[24:27], v[156:159], v[112:127]
 ds_read_b32 v2, v1
 ds_read_b64_tr_b16 v[20:21], v13 offset:46080
 ds_read_b64_tr_b16 v[22:23], v13 offset:46336
 v_add_f32 v69, v69, v85
 v_add_f32 v70, v70, v86
 v_add_f32 v71, v71, v87
 v_mfma_f32_32x32x16_bf16 v[96:111], v[28:31], v[160:163], v[96:111]
 ds_read_b64_tr_b16 v[24:25], v13 offset:47104
 ds_read_b64_tr_b16 v[26:27], v13 offset:47360
 v_add_f32 v72, v72, v88
 v_add_f32 v73, v73, v89
 v_add_f32 v74, v74, v90
 s_waitcnt lgkmcnt(11)
 v_mfma_f32_32x32x16_bf16 v[112:127], v[32:35], v[164:167], v[112:127]
 ds_read_b64_tr_b16 v[28:29], v13 offset:48128
 ds_read_b64_tr_b16 v[30:31], v13 offset:48384
 v_add_f32 v75, v75, v91
 v_add_f32 v76, v76, v92
 v_add_f32 v77, v77, v93
 s_waitcnt lgkmcnt(11)
 v_mfma_f32_32x32x16_bf16 v[96:111], v[36:39], v[168:171], v[96:111]
 s_waitcnt lgkmcnt(6)
 v_cmp_gt_u32 vcc, 8, v2
 s_nop 0
 s_cbranch_vccz LD_135
 s_mov_b32 s39, 1048576
LS_134:
 ds_read_b32 v2, v1 offset:0
 s_waitcnt lgkmcnt(0)
 v_cmp_gt_u32 vcc, 8, v2
 s_nop 0
 s_cbranch_vccz LD_135
 s_sub_u32 s39, s39, 1
 s_cbranch_scc0 LS_134
LD_135:
 ds_read_b64_tr_b16 v[32:33], v13 offset:49152
 ds_read_b64_tr_b16 v[34:35], v13 offset:49408
 v_add_f32 v78, v78, v94
 v_add_f32 v79, v79, v95
 s_waitcnt lgkmcnt(15)
 s_waitcnt lgkmcnt(11)
 v_mfma_f32_32x32x16_bf16 v[112:127], v[40:43], v[172:175], v[112:127]
 ds_read_b64_tr_b16 v[36:37], v13 offset:50176
 ds_read_b64_tr_b16 v[38:39], v13 offset:50432
 v_mfma_f32_32x32x16_bf16 v[64:79], v[56:59], v[44:47], v[64:79]
 v_mov_b32 v60, 0x3eb8aa3b
 v_mul_f32 v60, v48, v60
 s_waitcnt lgkmcnt(11)
 v_mfma_f32_32x32x16_bf16 v[96:111], v[16:19], v[176:179], v[96:111]
 ds_read_b64_tr_b16 v[40:41], v13 offset:51200
 ds_read_b64_tr_b16 v[42:43], v13 offset:51456
 s_lshl_b32 s72, s26, 11
 s_add_u32 s72, s72, 139264
 v_add_u32 v9, s72, v7
 s_waitcnt lgkmcnt(10)
 v_mfma_f32_32x32x16_bf16 v[112:127], v[20:23], v[180:183], v[112:127]
 ds_read_b64_tr_b16 v[16:17], v13 offset:52224
 ds_read_b64_tr_b16 v[18:19], v13 offset:52480
 s_waitcnt lgkmcnt(10)
 v_mfma_f32_32x32x16_bf16 v[96:111], v[24:27], v[184:187], v[96:111]
 ds_read_b64_tr_b16 v[20:21], v13 offset:53248
 ds_read_b64_tr_b16 v[22:23], v13 offset:53504
 s_waitcnt lgkmcnt(10)
 v_mov_b32 v5, 7
 ds_write_b32 v1, v5 offset:64
 v_mfma_f32_32x32x16_bf16 v[112:127], v[28:31], v[188:191], v[112:127]
 ds_read_b64_tr_b16 v[24:25], v13 offset:54272
 ds_read_b64_tr_b16 v[26:27], v13 offset:54528
 s_waitcnt lgkmcnt(11)
 v_mfma_f32_32x32x16_bf16 v[96:111], v[32:35], v[192:195], v[96:111]
 ds_read_b64_tr_b16 v[28:29], v13 offset:55296
 ds_read_b64_tr_b16 v[30:31], v13 offset:55552
 v_mul_f32 v64, v64, v60
 v_mul_f32 v65, v65, v60
 s_waitcnt lgkmcnt(11)
 v_mfma_f32_32x32x16_bf16 v[112:127], v[36:39], v[196:199], v[112:127]
 ds_read_b64_tr_b16 v[32:33], v13 offset:56320
 ds_read_b64_tr_b16 v[34:35], v13 offset:56576
 v_mul_f32 v66, v66, v60
 v_mul_f32 v67, v67, v60
 v_mul_f32 v68, v68, v60
 s_waitcnt lgkmcnt(11)
 v_mfma_f32_32x32x16_bf16 v[96:111], v[40:43], v[200:203], v[96:111]
 ds_read_b64_tr_b16 v[36:37], v13 offset:57344
 ds_read_b64_tr_b16 v[38:39], v13 offset:57600
 v_mul_f32 v69, v69, v60
 v_mul_f32 v70, v70, v60
 v_mul_f32 v71, v71, v60
 s_waitcnt lgkmcnt(11)
 v_mfma_f32_32x32x16_bf16 v[112:127], v[16:19], v[204:207], v[112:127]
 ds_read_b64_tr_b16 v[40:41], v13 offset:58368
 ds_read_b64_tr_b16 v[42:43], v13 offset:58624
 v_mul_f32 v72, v72, v60
 v_mul_f32 v73, v73, v60
 v_mul_f32 v74, v74, v60
 s_waitcnt lgkmcnt(11)
 v_mfma_f32_32x32x16_bf16 v[96:111], v[20:23], v[208:211], v[96:111]
 ds_read_b64_tr_b16 v[16:17], v13 offset:59392
 ds_read_b64_tr_b16 v[18:19], v13 offset:59648
 v_mul_f32 v75, v75, v60
 v_mul_f32 v76, v76, v60
 v_mul_f32 v77, v77, v60
 s_waitcnt lgkmcnt(10)
 v_mfma_f32_32x32x16_bf16 v[112:127], v[24:27], v[212:215], v[112:127]
 ds_read_b64_tr_b16 v[20:21], v13 offset:60416
 ds_read_b64_tr_b16 v[22:23], v13 offset:60672
 v_mul_f32 v78, v78, v60
 v_mul_f32 v79, v79, v60
 v_cvt_pk_bf16_f32 v64, v64, v65
 s_waitcnt lgkmcnt(10)
 v_mfma_f32_32x32x16_bf16 v[96:111], v[28:31], v[216:219], v[96:111]
 ds_read_b64_tr_b16 v[24:25], v13 offset:61440
 ds_read_b64_tr_b16 v[26:27], v13 offset:61696
 v_cvt_pk_bf16_f32 v65, v66, v67
 v_cvt_pk_bf16_f32 v66, v68, v69
 v_cvt_pk_bf16_f32 v67, v70, v71
 s_waitcnt lgkmcnt(10)
 v_mfma_f32_32x32x16_bf16 v[112:127], v[32:35], v[220:223], v[112:127]
 ds_read_b64_tr_b16 v[28:29], v13 offset:62464
 ds_read_b64_tr_b16 v[30:31], v13 offset:62720
 v_cvt_pk_bf16_f32 v68, v72, v73
 v_cvt_pk_bf16_f32 v69, v74, v75
 v_cvt_pk_bf16_f32 v70, v76, v77
 s_waitcnt lgkmcnt(10)
 v_mfma_f32_32x32x16_bf16 v[96:111], v[36:39], v[224:227], v[96:111]
 ds_read_b64_tr_b16 v[32:33], v13 offset:63488
 ds_read_b64_tr_b16 v[34:35], v13 offset:63744
 v_cvt_pk_bf16_f32 v71, v78, v79
 ds_write_b128 v9, v[64:67] offset:0
 ds_write_b128 v9, v[68:71] offset:1024
 s_waitcnt lgkmcnt(12)
 v_mfma_f32_32x32x16_bf16 v[112:127], v[40:43], v[228:231], v[112:127]
 ds_read_b64_tr_b16 v[36:37], v13 offset:64512
 ds_read_b64_tr_b16 v[38:39], v13 offset:64768
 v_mov_b32 v5, 5
 ds_write_b32 v1, v5 offset:96
 s_waitcnt lgkmcnt(13)
 v_mfma_f32_32x32x16_bf16 v[96:111], v[16:19], v[232:235], v[96:111]
 s_waitcnt lgkmcnt(11)
 v_mfma_f32_32x32x16_bf16 v[112:127], v[20:23], v[236:239], v[112:127]
 s_waitcnt lgkmcnt(9)
 v_mfma_f32_32x32x16_bf16 v[96:111], v[24:27], v[240:243], v[96:111]
 s_waitcnt lgkmcnt(7)
 v_mfma_f32_32x32x16_bf16 v[112:127], v[28:31], v[244:247], v[112:127]
 s_waitcnt lgkmcnt(5)
 v_mfma_f32_32x32x16_bf16 v[96:111], v[32:35], v[248:251], v[96:111]
 s_waitcnt lgkmcnt(1)
 v_mov_b32 v5, 8
 ds_write_b32 v1, v5 offset:64
 v_mfma_f32_32x32x16_bf16 v[112:127], v[36:39], v[252:255], v[112:127]
 s_waitcnt lgkmcnt(0)
 v_and_b32 v8, 3, v0
 v_lshlrev_b32 v8, 3, v8
 v_add_u32 v8, 147648, v8
 s_mov_b32 s39, 1048576
LS_136:
 ds_read_b32 v2, v8 offset:0
 s_waitcnt lgkmcnt(0)
 v_cmp_gt_u32 vcc, 8, v2
 s_nop 0
 s_cbranch_vccz LD_137
 s_sub_u32 s39, s39, 1
 s_cbranch_scc0 LS_136
LD_137:
 s_mov_b32 s39, 1048576
LS_138:
 ds_read_b32 v2, v1 offset:32
 s_waitcnt lgkmcnt(0)
 v_cmp_gt_u32 vcc, 3, v2
 s_nop 0
 s_cbranch_vccz LD_139
 s_sub_u32 s39, s39, 1
 s_cbranch_scc0 LS_138
LD_139:
 s_load_dwordx16 s[8:23], s[64:65], s89 glc
 v_xor_b32 v9, 64, v12
 s_add_u32 m0, s82, 0
 s_add_u32 s80, s86, 0
 buffer_load_dwordx4 v10, s[52:55], s80 offen lds
 s_add_u32 m0, s82, 1024
 s_add_u32 s80, s86, 8192
 buffer_load_dwordx4 v10, s[52:55], s80 offen lds
 s_add_u32 m0, s82, 2048
 s_add_u32 s80, s86, 196608
 buffer_load_dwordx4 v10, s[52:55], s80 offen lds
 s_add_u32 m0, s82, 3072
 s_add_u32 s80, s86, 204800
 buffer_load_dwordx4 v10, s[52:55], s80 offen lds
 s_add_u32 m0, s82, 4096
 s_add_u32 s80, s86, 393216
 buffer_load_dwordx4 v10, s[52:55], s80 offen lds
 s_add_u32 m0, s82, 5120
 s_add_u32 s80, s86, 401408
 buffer_load_dwordx4 v10, s[52:55], s80 offen lds
 s_add_u32 m0, s82, 6144
 s_add_u32 s80, s86, 589824
 buffer_load_dwordx4 v10, s[52:55], s80 offen lds
 s_add_u32 m0, s82, 7168
 s_add_u32 s80, s86, 598016
 buffer_load_dwordx4 v10, s[52:55], s80 offen lds
 s_mov_b32 s39, 1048576
 s_branch SPF_142
SPL_140:
 s_load_dwordx16 s[8:23], s[64:65], s89 glc
SPF_142:
 s_waitcnt lgkmcnt(0)
 s_xor_b64 s[8:9], s[8:9], s[24:25]
 s_xor_b64 s[10:11], s[10:11], s[24:25]
 s_xor_b64 s[12:13], s[12:13], s[24:25]
 s_xor_b64 s[14:15], s[14:15], s[24:25]
 s_xor_b64 s[16:17], s[16:17], s[24:25]
 s_xor_b64 s[18:19], s[18:19], s[24:25]
 s_xor_b64 s[20:21], s[20:21], s[24:25]
 s_xor_b64 s[22:23], s[22:23], s[24:25]
 s_or_b64 s[8:9], s[8:9], s[10:11]
 s_or_b64 s[8:9], s[8:9], s[12:13]
 s_or_b64 s[8:9], s[8:9], s[14:15]
 s_or_b64 s[8:9], s[8:9], s[16:17]
 s_or_b64 s[8:9], s[8:9], s[18:19]
 s_or_b64 s[8:9], s[8:9], s[20:21]
 s_or_b64 s[8:9], s[8:9], s[22:23]
 s_or_b32 s8, s8, s9
 s_cbranch_scc0 SPD_141
 s_sub_u32 s39, s39, 1
 s_cbranch_scc0 SPL_140
 v_mov_b32 v13, 513
 v_mov_b32 v14, 0
 global_store_dword v14, v13, s[68:69]
 s_waitcnt vmcnt(0)
SPD_141:
 s_add_u32 s80, s83, 0
 buffer_load_dwordx4 v[128:131], v7, s[64:67], s80 offen sc1
 s_add_u32 s80, s83, 120832
 buffer_load_dwordx4 v[132:135], v7, s[64:67], s80 offen sc1
 s_add_u32 s80, s83, 12288
 buffer_load_dwordx4 v[136:139], v7, s[64:67], s80 offen sc1
 s_add_u32 s80, s83, 133120
 buffer_load_dwordx4 v[140:143], v7, s[64:67], s80 offen sc1
 s_add_u32 s80, s83, 24576
 buffer_load_dwordx4 v[144:147], v7, s[64:67], s80 offen sc1
 s_add_u32 s80, s83, 145408
 buffer_load_dwordx4 v[148:151], v7, s[64:67], s80 offen sc1
 s_add_u32 s80, s83, 36864
 buffer_load_dwordx4 v[152:155], v7, s[64:67], s80 offen sc1
 s_add_u32 s80, s83, 157696
 buffer_load_dwordx4 v[156:159], v7, s[64:67], s80 offen sc1
 v_and_b32 v5, 31, v0
 v_lshlrev_b32 v5, 2, v5
 s_lshl_b32 s81, s35, 7
 s_add_u32 s81, s81, 262144
 buffer_load_dword v72, v5, s[64:67], s81 offen sc1
 buffer_load_dword v73, v5, s[64:67], s81 offen offset:128 sc1
 s_lshl_b32 s78, s35, 15
 s_lshl_b32 s81, s36, 7
 s_add_u32 s78, s78, s81
 s_add_u32 s79, s78, 32768
 buffer_load_dwordx4 v[64:67], v11, s[40:43], s78 offen
 buffer_load_dwordx4 v[68:71], v11, s[40:43], s79 offen
 ds_read_b64 v[56:57], v51 offset:2048
 s_nop 0
 s_nop 0
 s_nop 0
 s_nop 0
 s_nop 0
 s_nop 0
 v_add_f32 v96, v96, v112
 v_add_f32 v97, v97, v113
 v_add_f32 v98, v98, v114
 v_add_f32 v99, v99, v115
 v_add_f32 v100, v100, v116
 v_add_f32 v101, v101, v117
 v_add_f32 v102, v102, v118
 v_add_f32 v103, v103, v119
 v_add_f32 v104, v104, v120
 v_add_f32 v105, v105, v121
 v_add_f32 v106, v106, v122
 v_add_f32 v107, v107, v123
 v_add_f32 v108, v108, v124
 v_add_f32 v109, v109, v125
 v_add_f32 v110, v110, v126
 v_add_f32 v111, v111, v127
 s_nop 1
 s_waitcnt lgkmcnt(0)
 v_mfma_f32_32x32x16_bf16 v[96:111], v[56:59], v[44:47], v[96:111]
 s_nop 0
 s_nop 0
 s_nop 0
 s_nop 0
 s_nop 0
 s_nop 0
 s_nop 0
 s_nop 0
 s_nop 0
 s_nop 0
 s_nop 0
 s_nop 0
 s_nop 0
 v_max_f32 v96, 0, v96
 v_max_f32 v97, 0, v97
 v_max_f32 v98, 0, v98
 v_max_f32 v99, 0, v99
 v_max_f32 v100, 0, v100
 v_max_f32 v101, 0, v101
 v_max_f32 v102, 0, v102
 v_max_f32 v103, 0, v103
 v_max_f32 v104, 0, v104
 v_max_f32 v105, 0, v105
 v_max_f32 v106, 0, v106
 v_max_f32 v107, 0, v107
 v_max_f32 v108, 0, v108
 v_max_f32 v109, 0, v109
 v_max_f32 v110, 0, v110
 v_max_f32 v111, 0, v111
 v_cvt_pk_bf16_f32 v96, v96, v97
 v_cvt_pk_bf16_f32 v97, v98, v99
 v_cvt_pk_bf16_f32 v98, v100, v101
 v_cvt_pk_bf16_f32 v99, v102, v103
 v_cvt_pk_bf16_f32 v100, v104, v105
 v_cvt_pk_bf16_f32 v101, v106, v107
 v_cvt_pk_bf16_f32 v102, v108, v109
 v_cvt_pk_bf16_f32 v103, v110, v111
 s_cmp_eq_u32 s34, 3
 s_cbranch_scc0 NOT2_143
 s_add_u32 s96, s93, 4096
 buffer_store_dwordx4 v[96:99], v7, s[64:67], s96 offen offset:0 sc1
 buffer_store_dwordx4 v[100:103], v7, s[64:67], s96 offen offset:1024 sc1
NOT2_143:
 s_waitcnt vmcnt(10)
 ds_read_b64_tr_b16 v[16:17], v12 offset:0
 ds_read_b64_tr_b16 v[18:19], v12 offset:1024
 ds_read_b64_tr_b16 v[20:21], v9 offset:0
 ds_read_b64_tr_b16 v[22:23], v9 offset:1024
 s_waitcnt vmcnt(8)
 ds_read_b64_tr_b16 v[24:25], v12 offset:2048
 ds_read_b64_tr_b16 v[26:27], v12 offset:3072
 ds_read_b64_tr_b16 v[28:29], v9 offset:2048
 ds_read_b64_tr_b16 v[30:31], v9 offset:3072
 s_waitcnt lgkmcnt(4)
 v_mfma_f32_32x32x16_bf16 v[192:207], v[16:19], v[128:131], 0
 s_add_u32 s80, s83, 49152
 buffer_load_dwordx4 v[160:163], v7, s[64:67], s80 offen sc1
 v_mfma_f32_32x32x16_bf16 v[208:223], v[16:19], v[132:135], 0
 s_add_u32 s80, s83, 169984
 buffer_load_dwordx4 v[164:167], v7, s[64:67], s80 offen sc1
 v_mfma_f32_32x32x16_bf16 v[224:239], v[20:23], v[128:131], 0
 s_add_u32 m0, s82, 8192
 s_add_u32 s80, s86, 786432
 buffer_load_dwordx4 v10, s[52:55], s80 offen lds
 v_mfma_f32_32x32x16_bf16 v[240:255], v[20:23], v[132:135], 0
 s_add_u32 m0, s82, 9216
 s_add_u32 s80, s86, 794624
 buffer_load_dwordx4 v10, s[52:55], s80 offen lds
 s_waitcnt vmcnt(10)
 ds_read_b64_tr_b16 v[16:17], v12 offset:4096
 ds_read_b64_tr_b16 v[18:19], v12 offset:5120
 ds_read_b64_tr_b16 v[20:21], v9 offset:4096
 ds_read_b64_tr_b16 v[22:23], v9 offset:5120
 s_waitcnt lgkmcnt(4)
 v_mfma_f32_32x32x16_bf16 v[192:207], v[24:27], v[136:139], v[192:207]
 s_add_u32 s80, s83, 61440
 buffer_load_dwordx4 v[168:171], v7, s[64:67], s80 offen sc1
 v_mfma_f32_32x32x16_bf16 v[208:223], v[24:27], v[140:143], v[208:223]
 s_add_u32 s80, s83, 182272
 buffer_load_dwordx4 v[172:175], v7, s[64:67], s80 offen sc1
 v_mfma_f32_32x32x16_bf16 v[224:239], v[28:31], v[136:139], v[224:239]
 s_add_u32 m0, s82, 10240
 s_add_u32 s80, s86, 983040
 buffer_load_dwordx4 v10, s[52:55], s80 offen lds
 v_mfma_f32_32x32x16_bf16 v[240:255], v[28:31], v[140:143], v[240:255]
 s_add_u32 m0, s82, 11264
 s_add_u32 s80, s86, 991232
 buffer_load_dwordx4 v10, s[52:55], s80 offen lds
 s_add_u32 s97, s89, 32768
 s_load_dwordx16 s[8:23], s[64:65], s97 glc
 s_waitcnt vmcnt(12)
 ds_read_b64_tr_b16 v[24:25], v12 offset:6144
 ds_read_b64_tr_b16 v[26:27], v12 offset:7168
 ds_read_b64_tr_b16 v[28:29], v9 offset:6144
 ds_read_b64_tr_b16 v[30:31], v9 offset:7168
 s_waitcnt lgkmcnt(4)
 v_mfma_f32_32x32x16_bf16 v[192:207], v[16:19], v[144:147], v[192:207]
 s_add_u32 s80, s84, 71680
 buffer_load_dwordx4 v[176:179], v7, s[64:67], s80 offen sc1
 v_mfma_f32_32x32x16_bf16 v[208:223], v[16:19], v[148:151], v[208:223]
 s_add_u32 s80, s84, 192512
 buffer_load_dwordx4 v[180:183], v7, s[64:67], s80 offen sc1
 v_mfma_f32_32x32x16_bf16 v[224:239], v[20:23], v[144:147], v[224:239]
 s_add_u32 m0, s82, 12288
 s_add_u32 s80, s87, 1146880
 buffer_load_dwordx4 v10, s[52:55], s80 offen lds
 v_mfma_f32_32x32x16_bf16 v[240:255], v[20:23], v[148:151], v[240:255]
 s_add_u32 m0, s82, 13312
 s_add_u32 s80, s87, 1155072
 buffer_load_dwordx4 v10, s[52:55], s80 offen lds
 s_waitcnt vmcnt(8)
 ds_read_b64_tr_b16 v[16:17], v12 offset:8192
 ds_read_b64_tr_b16 v[18:19], v12 offset:9216
 ds_read_b64_tr_b16 v[20:21], v9 offset:8192
 ds_read_b64_tr_b16 v[22:23], v9 offset:9216
 s_waitcnt lgkmcnt(4)
 v_mfma_f32_32x32x16_bf16 v[192:207], v[24:27], v[152:155], v[192:207]
 s_add_u32 s80, s84, 79872
 buffer_load_dwordx4 v[184:187], v7, s[64:67], s80 offen sc1
 v_mfma_f32_32x32x16_bf16 v[208:223], v[24:27], v[156:159], v[208:223]
 s_add_u32 s80, s84, 200704
 buffer_load_dwordx4 v[188:191], v7, s[64:67], s80 offen sc1
 v_mfma_f32_32x32x16_bf16 v[224:239], v[28:31], v[152:155], v[224:239]
 s_add_u32 m0, s82, 14336
 s_add_u32 s80, s87, 1277952
 buffer_load_dwordx4 v10, s[52:55], s80 offen lds
 v_mfma_f32_32x32x16_bf16 v[240:255], v[28:31], v[156:159], v[240:255]
 s_add_u32 m0, s82, 15360
 s_add_u32 s80, s87, 1286144
 buffer_load_dwordx4 v10, s[52:55], s80 offen lds
 s_waitcnt vmcnt(16)
 v_mov_b32 v3, 147456
 v_mov_b32 v4, 1
 s_mov_b64 exec, 1
 ds_add_rtn_u32 v5, v3, v4
 s_waitcnt lgkmcnt(0)
 v_readfirstlane_b32 s81, v5
 s_mov_b64 exec, -1
 s_cmp_eq_u32 s81, 3
 s_cbranch_scc0 NOFH_144
 s_lshl_b32 s98, s27, 11
 s_lshl_b32 s99, s28, 2
 s_add_u32 s98, s98, s99
 s_add_u32 s98, s98, 131072
 v_lshlrev_b32 v3, 7, v0
 v_add_u32 v3, s98, v3
 v_mov_b32 v4, s31
 s_mov_b64 exec, 0xffff
 buffer_store_dword v4, v3, s[64:67], 0 offen sc1
 s_mov_b64 exec, -1
NOFH_144:
 s_waitcnt lgkmcnt(0)
 s_xor_b64 s[8:9], s[8:9], s[24:25]
 s_xor_b64 s[10:11], s[10:11], s[24:25]
 s_xor_b64 s[12:13], s[12:13], s[24:25]
 s_xor_b64 s[14:15], s[14:15], s[24:25]
 s_xor_b64 s[16:17], s[16:17], s[24:25]
 s_xor_b64 s[18:19], s[18:19], s[24:25]
 s_xor_b64 s[20:21], s[20:21], s[24:25]
 s_xor_b64 s[22:23], s[22:23], s[24:25]
 s_or_b64 s[8:9], s[8:9], s[10:11]
 s_or_b64 s[8:9], s[8:9], s[12:13]
 s_or_b64 s[8:9], s[8:9], s[14:15]
 s_or_b64 s[8:9], s[8:9], s[16:17]
 s_or_b64 s[8:9], s[8:9], s[18:19]
 s_or_b64 s[8:9], s[8:9], s[20:21]
 s_or_b64 s[8:9], s[8:9], s[22:23]
 s_or_b32 s8, s8, s9
 s_cbranch_scc0 CLOK_145
 s_mov_b32 s39, 1048576
SPL_146:
 s_load_dwordx16 s[8:23], s[64:65], s97 glc
SPF_148:
 s_waitcnt lgkmcnt(0)
 s_xor_b64 s[8:9], s[8:9], s[24:25]
 s_xor_b64 s[10:11], s[10:11], s[24:25]
 s_xor_b64 s[12:13], s[12:13], s[24:25]
 s_xor_b64 s[14:15], s[14:15], s[24:25]
 s_xor_b64 s[16:17], s[16:17], s[24:25]
 s_xor_b64 s[18:19], s[18:19], s[24:25]
 s_xor_b64 s[20:21], s[20:21], s[24:25]
 s_xor_b64 s[22:23], s[22:23], s[24:25]
 s_or_b64 s[8:9], s[8:9], s[10:11]
 s_or_b64 s[8:9], s[8:9], s[12:13]
 s_or_b64 s[8:9], s[8:9], s[14:15]
 s_or_b64 s[8:9], s[8:9], s[16:17]
 s_or_b64 s[8:9], s[8:9], s[18:19]
 s_or_b64 s[8:9], s[8:9], s[20:21]
 s_or_b64 s[8:9], s[8:9], s[22:23]
 s_or_b32 s8, s8, s9
 s_cbranch_scc0 SPD_147
 s_sub_u32 s39, s39, 1
 s_cbranch_scc0 SPL_146
 v_mov_b32 v13, 529
 v_mov_b32 v14, 0
 global_store_dword v14, v13, s[68:69]
 s_waitcnt vmcnt(0)
SPD_147:
CLOK_145:
 s_waitcnt vmcnt(8)
 ds_read_b64_tr_b16 v[24:25], v12 offset:10240
 ds_read_b64_tr_b16 v[26:27], v12 offset:11264
 ds_read_b64_tr_b16 v[28:29], v9 offset:10240
 ds_read_b64_tr_b16 v[30:31], v9 offset:11264
 v_mfma_f32_32x32x16_bf16 v[192:207], v[16:19], v[160:163], v[192:207]
 s_add_u32 s80, s83, 2048
 buffer_load_dwordx4 v[128:131], v7, s[64:67], s80 offen sc1
 v_mfma_f32_32x32x16_bf16 v[208:223], v[16:19], v[164:167], v[208:223]
 s_add_u32 s80, s83, 122880
 buffer_load_dwordx4 v[132:135], v7, s[64:67], s80 offen sc1
 v_mfma_f32_32x32x16_bf16 v[224:239], v[20:23], v[160:163], v[224:239]
 s_add_u32 m0, s82, 0
 s_add_u32 s80, s86, 32768
 buffer_load_dwordx4 v10, s[52:55], s80 offen lds
 v_mfma_f32_32x32x16_bf16 v[240:255], v[20:23], v[164:167], v[240:255]
 s_add_u32 m0, s82, 1024
 s_add_u32 s80, s86, 40960
 buffer_load_dwordx4 v10, s[52:55], s80 offen lds
 s_waitcnt vmcnt(8)
 ds_read_b64_tr_b16 v[16:17], v12 offset:12288
 ds_read_b64_tr_b16 v[18:19], v12 offset:13312
 ds_read_b64_tr_b16 v[20:21], v9 offset:12288
 ds_read_b64_tr_b16 v[22:23], v9 offset:13312
 s_waitcnt lgkmcnt(4)
 v_mfma_f32_32x32x16_bf16 v[192:207], v[24:27], v[168:171], v[192:207]
 s_add_u32 s80, s83, 14336
 buffer_load_dwordx4 v[136:139], v7, s[64:67], s80 offen sc1
 v_and_b32 v2, 31, v0
 v_lshlrev_b32 v3, 8, v2
 v_add_u32 v3, s82, v3
 v_mfma_f32_32x32x16_bf16 v[208:223], v[24:27], v[172:175], v[208:223]
 s_add_u32 s80, s83, 135168
 buffer_load_dwordx4 v[140:143], v7, s[64:67], s80 offen sc1
 v_and_b32 v4, 7, v0
 v_lshrrev_b32 v5, 5, v0
 v_add_u32 v6, 0, v5
 v_mfma_f32_32x32x16_bf16 v[224:239], v[28:31], v[168:171], v[224:239]
 s_add_u32 m0, s82, 2048
 s_add_u32 s80, s86, 229376
 buffer_load_dwordx4 v10, s[52:55], s80 offen lds
 v_xor_b32 v6, v6, v4
 v_lshl_add_u32 v32, v6, 4, v3
 v_mfma_f32_32x32x16_bf16 v[240:255], v[28:31], v[172:175], v[240:255]
 s_add_u32 m0, s82, 3072
 s_add_u32 s80, s86, 237568
 buffer_load_dwordx4 v10, s[52:55], s80 offen lds
 v_add_u32 v6, 2, v5
 v_xor_b32 v6, v6, v4
 s_waitcnt vmcnt(8)
 ds_read_b64_tr_b16 v[24:25], v12 offset:14336
 ds_read_b64_tr_b16 v[26:27], v12 offset:15360
 ds_read_b64_tr_b16 v[28:29], v9 offset:14336
 ds_read_b64_tr_b16 v[30:31], v9 offset:15360
 s_waitcnt lgkmcnt(4)
 v_mfma_f32_32x32x16_bf16 v[192:207], v[16:19], v[176:179], v[192:207]
 s_add_u32 s80, s83, 26624
 buffer_load_dwordx4 v[144:147], v7, s[64:67], s80 offen sc1
 v_lshl_add_u32 v33, v6, 4, v3
 v_add_u32 v6, 4, v5
 v_xor_b32 v6, v6, v4
 v_mfma_f32_32x32x16_bf16 v[208:223], v[16:19], v[180:183], v[208:223]
 s_add_u32 s80, s83, 147456
 buffer_load_dwordx4 v[148:151], v7, s[64:67], s80 offen sc1
 v_lshl_add_u32 v34, v6, 4, v3
 v_add_u32 v6, 6, v5
 v_xor_b32 v6, v6, v4
 v_mfma_f32_32x32x16_bf16 v[224:239], v[20:23], v[176:179], v[224:239]
 s_add_u32 m0, s82, 4096
 s_add_u32 s80, s86, 425984
 buffer_load_dwordx4 v10, s[52:55], s80 offen lds
 v_lshl_add_u32 v35, v6, 4, v3
 s_lshl_b32 s81, s26, 3
 v_mfma_f32_32x32x16_bf16 v[240:255], v[20:23], v[180:183], v[240:255]
 s_add_u32 m0, s82, 5120
 s_add_u32 s80, s86, 434176
 buffer_load_dwordx4 v10, s[52:55], s80 offen lds
 v_lshrrev_b32 v3, 3, v0
 v_add_u32 v3, s81, v3
 s_waitcnt vmcnt(8)
 ds_read_b64_tr_b16 v[16:17], v12 offset:0
 ds_read_b64_tr_b16 v[18:19], v12 offset:1024
 ds_read_b64_tr_b16 v[20:21], v9 offset:0
 ds_read_b64_tr_b16 v[22:23], v9 offset:1024
 s_waitcnt lgkmcnt(4)
 v_mfma_f32_32x32x16_bf16 v[192:207], v[24:27], v[184:187], v[192:207]
 s_add_u32 s80, s83, 38912
 buffer_load_dwordx4 v[152:155], v7, s[64:67], s80 offen sc1
 v_and_b32 v4, 7, v3
 v_and_b32 v5, 7, v0
 v_lshlrev_b32 v5, 1, v5
 v_mfma_f32_32x32x16_bf16 v[208:223], v[24:27], v[188:191], v[208:223]
 s_add_u32 s80, s83, 159744
 buffer_load_dwordx4 v[156:159], v7, s[64:67], s80 offen sc1
 v_xor_b32 v6, v5, v4
 v_or_b32 v5, 1, v5
 v_xor_b32 v5, v5, v4
 v_mfma_f32_32x32x16_bf16 v[224:239], v[28:31], v[184:187], v[224:239]
 s_add_u32 m0, s82, 6144
 s_add_u32 s80, s86, 622592
 buffer_load_dwordx4 v10, s[52:55], s80 offen lds
 v_lshlrev_b32 v3, 8, v3
 v_add_u32 v3, 73728, v3
 v_mfma_f32_32x32x16_bf16 v[240:255], v[28:31], v[188:191], v[240:255]
 s_add_u32 m0, s82, 7168
 s_add_u32 s80, s86, 630784
 buffer_load_dwordx4 v10, s[52:55], s80 offen lds
 v_lshl_add_u32 v36, v6, 4, v3
 v_lshl_add_u32 v37, v5, 4, v3
 s_waitcnt vmcnt(8)
 ds_read_b64_tr_b16 v[24:25], v12 offset:2048
 ds_read_b64_tr_b16 v[26:27], v12 offset:3072
 ds_read_b64_tr_b16 v[28:29], v9 offset:2048
 ds_read_b64_tr_b16 v[30:31], v9 offset:3072
 s_waitcnt lgkmcnt(4)
 v_mfma_f32_32x32x16_bf16 v[192:207], v[16:19], v[128:131], v[192:207]
 s_add_u32 s80, s83, 51200
 buffer_load_dwordx4 v[160:163], v7, s[64:67], s80 offen sc1
 v_mfma_f32_32x32x16_bf16 v[208:223], v[16:19], v[132:135], v[208:223]
 s_add_u32 s80, s83, 172032
 buffer_load_dwordx4 v[164:167], v7, s[64:67], s80 offen sc1
 v_mfma_f32_32x32x16_bf16 v[224:239], v[20:23], v[128:131], v[224:239]
 s_add_u32 m0, s82, 8192
 s_add_u32 s80, s86, 819200
 buffer_load_dwordx4 v10, s[52:55], s80 offen lds
 v_mfma_f32_32x32x16_bf16 v[240:255], v[20:23], v[132:135], v[240:255]
 s_add_u32 m0, s82, 9216
 s_add_u32 s80, s86, 827392
 buffer_load_dwordx4 v10, s[52:55], s80 offen lds
 s_waitcnt vmcnt(8)
 ds_read_b64_tr_b16 v[16:17], v12 offset:4096
 ds_read_b64_tr_b16 v[18:19], v12 offset:5120
 ds_read_b64_tr_b16 v[20:21], v9 offset:4096
 ds_read_b64_tr_b16 v[22:23], v9 offset:5120
 s_waitcnt lgkmcnt(4)
 v_mfma_f32_32x32x16_bf16 v[192:207], v[24:27], v[136:139], v[192:207]
 s_add_u32 s80, s83, 63488
 buffer_load_dwordx4 v[168:171], v7, s[64:67], s80 offen sc1
 v_mfma_f32_32x32x16_bf16 v[208:223], v[24:27], v[140:143], v[208:223]
 s_add_u32 s80, s83, 184320
 buffer_load_dwordx4 v[172:175], v7, s[64:67], s80 offen sc1
 v_mfma_f32_32x32x16_bf16 v[224:239], v[28:31], v[136:139], v[224:239]
 s_add_u32 m0, s82, 10240
 s_add_u32 s80, s86, 1015808
 buffer_load_dwordx4 v10, s[52:55], s80 offen lds
 v_mfma_f32_32x32x16_bf16 v[240:255], v[28:31], v[140:143], v[240:255]
 s_add_u32 m0, s82, 11264
 s_add_u32 s80, s86, 1024000
 buffer_load_dwordx4 v10, s[52:55], s80 offen lds
 s_add_u32 s97, s89, 65536
 s_load_dwordx16 s[8:23], s[64:65], s97 glc
 s_waitcnt vmcnt(8)
 ds_read_b64_tr_b16 v[24:25], v12 offset:6144
 ds_read_b64_tr_b16 v[26:27], v12 offset:7168
 ds_read_b64_tr_b16 v[28:29], v9 offset:6144
 ds_read_b64_tr_b16 v[30:31], v9 offset:7168
 s_waitcnt lgkmcnt(4)
 v_mfma_f32_32x32x16_bf16 v[192:207], v[16:19], v[144:147], v[192:207]
 s_add_u32 s80, s84, 73728
 buffer_load_dwordx4 v[176:179], v7, s[64:67], s80 offen sc1
 v_mfma_f32_32x32x16_bf16 v[208:223], v[16:19], v[148:151], v[208:223]
 s_add_u32 s80, s84, 194560
 buffer_load_dwordx4 v[180:183], v7, s[64:67], s80 offen sc1
 v_mfma_f32_32x32x16_bf16 v[224:239], v[20:23], v[144:147], v[224:239]
 s_add_u32 m0, s82, 12288
 s_add_u32 s80, s87, 1179648
 buffer_load_dwordx4 v10, s[52:55], s80 offen lds
 v_mfma_f32_32x32x16_bf16 v[240:255], v[20:23], v[148:151], v[240:255]
 s_add_u32 m0, s82, 13312
 s_add_u32 s80, s87, 1187840
 buffer_load_dwordx4 v10, s[52:55], s80 offen lds
 s_waitcnt vmcnt(8)
 ds_read_b64_tr_b16 v[16:17], v12 offset:8192
 ds_read_b64_tr_b16 v[18:19], v12 offset:9216
 ds_read_b64_tr_b16 v[20:21], v9 offset:8192
 ds_read_b64_tr_b16 v[22:23], v9 offset:9216
 s_waitcnt lgkmcnt(4)
 v_mfma_f32_32x32x16_bf16 v[192:207], v[24:27], v[152:155], v[192:207]
 s_add_u32 s80, s84, 81920
 buffer_load_dwordx4 v[184:187], v7, s[64:67], s80 offen sc1
 v_mfma_f32_32x32x16_bf16 v[208:223], v[24:27], v[156:159], v[208:223]
 s_add_u32 s80, s84, 202752
 buffer_load_dwordx4 v[188:191], v7, s[64:67], s80 offen sc1
 v_mfma_f32_32x32x16_bf16 v[224:239], v[28:31], v[152:155], v[224:239]
 s_add_u32 m0, s82, 14336
 s_add_u32 s80, s87, 1310720
 buffer_load_dwordx4 v10, s[52:55], s80 offen lds
 v_mfma_f32_32x32x16_bf16 v[240:255], v[28:31], v[156:159], v[240:255]
 s_add_u32 m0, s82, 15360
 s_add_u32 s80, s87, 1318912
 buffer_load_dwordx4 v10, s[52:55], s80 offen lds
 s_waitcnt lgkmcnt(0)
 s_xor_b64 s[8:9], s[8:9], s[24:25]
 s_xor_b64 s[10:11], s[10:11], s[24:25]
 s_xor_b64 s[12:13], s[12:13], s[24:25]
 s_xor_b64 s[14:15], s[14:15], s[24:25]
 s_xor_b64 s[16:17], s[16:17], s[24:25]
 s_xor_b64 s[18:19], s[18:19], s[24:25]
 s_xor_b64 s[20:21], s[20:21], s[24:25]
 s_xor_b64 s[22:23], s[22:23], s[24:25]
 s_or_b64 s[8:9], s[8:9], s[10:11]
 s_or_b64 s[8:9], s[8:9], s[12:13]
 s_or_b64 s[8:9], s[8:9], s[14:15]
 s_or_b64 s[8:9], s[8:9], s[16:17]
 s_or_b64 s[8:9], s[8:9], s[18:19]
 s_or_b64 s[8:9], s[8:9], s[20:21]
 s_or_b64 s[8:9], s[8:9], s[22:23]
 s_or_b32 s8, s8, s9
 s_cbranch_scc0 CLOK_149
 s_mov_b32 s39, 1048576
SPL_150:
 s_load_dwordx16 s[8:23], s[64:65], s97 glc
SPF_152:
 s_waitcnt lgkmcnt(0)
 s_xor_b64 s[8:9], s[8:9], s[24:25]
 s_xor_b64 s[10:11], s[10:11], s[24:25]
 s_xor_b64 s[12:13], s[12:13], s[24:25]
 s_xor_b64 s[14:15], s[14:15], s[24:25]
 s_xor_b64 s[16:17], s[16:17], s[24:25]
 s_xor_b64 s[18:19], s[18:19], s[24:25]
 s_xor_b64 s[20:21], s[20:21], s[24:25]
 s_xor_b64 s[22:23], s[22:23], s[24:25]
 s_or_b64 s[8:9], s[8:9], s[10:11]
 s_or_b64 s[8:9], s[8:9], s[12:13]
 s_or_b64 s[8:9], s[8:9], s[14:15]
 s_or_b64 s[8:9], s[8:9], s[16:17]
 s_or_b64 s[8:9], s[8:9], s[18:19]
 s_or_b64 s[8:9], s[8:9], s[20:21]
 s_or_b64 s[8:9], s[8:9], s[22:23]
 s_or_b32 s8, s8, s9
 s_cbranch_scc0 SPD_151
 s_sub_u32 s39, s39, 1
 s_cbranch_scc0 SPL_150
 v_mov_b32 v13, 530
 v_mov_b32 v14, 0
 global_store_dword v14, v13, s[68:69]
 s_waitcnt vmcnt(0)
SPD_151:
CLOK_149:
 s_waitcnt vmcnt(8)
 ds_read_b64_tr_b16 v[24:25], v12 offset:10240
 ds_read_b64_tr_b16 v[26:27], v12 offset:11264
 ds_read_b64_tr_b16 v[28:29], v9 offset:10240
 ds_read_b64_tr_b16 v[30:31], v9 offset:11264
 v_mfma_f32_32x32x16_bf16 v[192:207], v[16:19], v[160:163], v[192:207]
 s_add_u32 s80, s83, 4096
 buffer_load_dwordx4 v[128:131], v7, s[64:67], s80 offen sc1
 v_mfma_f32_32x32x16_bf16 v[208:223], v[16:19], v[164:167], v[208:223]
 s_add_u32 s80, s83, 124928
 buffer_load_dwordx4 v[132:135], v7, s[64:67], s80 offen sc1
 v_mfma_f32_32x32x16_bf16 v[224:239], v[20:23], v[160:163], v[224:239]
 s_add_u32 m0, s82, 0
 s_add_u32 s80, s86, 65536
 buffer_load_dwordx4 v10, s[52:55], s80 offen lds
 v_mfma_f32_32x32x16_bf16 v[240:255], v[20:23], v[164:167], v[240:255]
 s_add_u32 m0, s82, 1024
 s_add_u32 s80, s86, 73728
 buffer_load_dwordx4 v10, s[52:55], s80 offen lds
 s_waitcnt vmcnt(8)
 ds_read_b64_tr_b16 v[16:17], v12 offset:12288
 ds_read_b64_tr_b16 v[18:19], v12 offset:13312
 ds_read_b64_tr_b16 v[20:21], v9 offset:12288
 ds_read_b64_tr_b16 v[22:23], v9 offset:13312
 s_waitcnt lgkmcnt(4)
 v_mfma_f32_32x32x16_bf16 v[192:207], v[24:27], v[168:171], v[192:207]
 s_add_u32 s80, s83, 16384
 buffer_load_dwordx4 v[136:139], v7, s[64:67], s80 offen sc1
 v_mfma_f32_32x32x16_bf16 v[208:223], v[24:27], v[172:175], v[208:223]
 s_add_u32 s80, s83, 137216
 buffer_load_dwordx4 v[140:143], v7, s[64:67], s80 offen sc1
 v_mfma_f32_32x32x16_bf16 v[224:239], v[28:31], v[168:171], v[224:239]
 s_add_u32 m0, s82, 2048
 s_add_u32 s80, s86, 262144
 buffer_load_dwordx4 v10, s[52:55], s80 offen lds
 v_mfma_f32_32x32x16_bf16 v[240:255], v[28:31], v[172:175], v[240:255]
 s_add_u32 m0, s82, 3072
 s_add_u32 s80, s86, 270336
 buffer_load_dwordx4 v10, s[52:55], s80 offen lds
 s_waitcnt vmcnt(8)
 ds_read_b64_tr_b16 v[24:25], v12 offset:14336
 ds_read_b64_tr_b16 v[26:27], v12 offset:15360
 ds_read_b64_tr_b16 v[28:29], v9 offset:14336
 ds_read_b64_tr_b16 v[30:31], v9 offset:15360
 s_waitcnt lgkmcnt(4)
 v_mfma_f32_32x32x16_bf16 v[192:207], v[16:19], v[176:179], v[192:207]
 s_add_u32 s80, s83, 28672
 buffer_load_dwordx4 v[144:147], v7, s[64:67], s80 offen sc1
 v_mfma_f32_32x32x16_bf16 v[208:223], v[16:19], v[180:183], v[208:223]
 s_add_u32 s80, s83, 149504
 buffer_load_dwordx4 v[148:151], v7, s[64:67], s80 offen sc1
 v_mfma_f32_32x32x16_bf16 v[224:239], v[20:23], v[176:179], v[224:239]
 s_add_u32 m0, s82, 4096
 s_add_u32 s80, s86, 458752
 buffer_load_dwordx4 v10, s[52:55], s80 offen lds
 v_mfma_f32_32x32x16_bf16 v[240:255], v[20:23], v[180:183], v[240:255]
 s_add_u32 m0, s82, 5120
 s_add_u32 s80, s86, 466944
 buffer_load_dwordx4 v10, s[52:55], s80 offen lds
 s_waitcnt vmcnt(8)
 ds_read_b64_tr_b16 v[16:17], v12 offset:0
 ds_read_b64_tr_b16 v[18:19], v12 offset:1024
 ds_read_b64_tr_b16 v[20:21], v9 offset:0
 ds_read_b64_tr_b16 v[22:23], v9 offset:1024
 s_waitcnt lgkmcnt(4)
 v_mfma_f32_32x32x16_bf16 v[192:207], v[24:27], v[184:187], v[192:207]
 s_add_u32 s80, s83, 40960
 buffer_load_dwordx4 v[152:155], v7, s[64:67], s80 offen sc1
 s_add_u32 s80, s83, 161792
 buffer_load_dwordx4 v[156:159], v7, s[64:67], s80 offen sc1
 s_add_u32 m0, s82, 6144
 s_add_u32 s80, s86, 655360
 buffer_load_dwordx4 v10, s[52:55], s80 offen lds
 v_mfma_f32_32x32x16_bf16 v[208:223], v[24:27], v[188:191], v[208:223]
 s_add_u32 m0, s82, 7168
 s_add_u32 s80, s86, 663552
 buffer_load_dwordx4 v10, s[52:55], s80 offen lds
 s_add_u32 m0, s82, 8192
 s_add_u32 s80, s86, 851968
 buffer_load_dwordx4 v10, s[52:55], s80 offen lds
 s_add_u32 m0, s82, 9216
 s_add_u32 s80, s86, 860160
 buffer_load_dwordx4 v10, s[52:55], s80 offen lds
 v_mfma_f32_32x32x16_bf16 v[224:239], v[28:31], v[184:187], v[224:239]
 s_add_u32 m0, s82, 10240
 s_add_u32 s80, s86, 1048576
 buffer_load_dwordx4 v10, s[52:55], s80 offen lds
 s_add_u32 m0, s82, 11264
 s_add_u32 s80, s86, 1056768
 buffer_load_dwordx4 v10, s[52:55], s80 offen lds
 s_add_u32 m0, s82, 12288
 s_add_u32 s80, s88, 0
 buffer_load_dwordx4 v10, s[56:59], s80 offen lds
 v_mfma_f32_32x32x16_bf16 v[240:255], v[28:31], v[188:191], v[240:255]
 s_add_u32 m0, s82, 13312
 s_add_u32 s80, s88, 8192
 buffer_load_dwordx4 v10, s[56:59], s80 offen lds
 s_add_u32 s97, s94, 0
 s_load_dwordx16 s[8:23], s[64:65], s97 glc
 s_waitcnt vmcnt(14)
 ds_read_b64_tr_b16 v[24:25], v12 offset:2048
 ds_read_b64_tr_b16 v[26:27], v12 offset:3072
 ds_read_b64_tr_b16 v[28:29], v9 offset:2048
 ds_read_b64_tr_b16 v[30:31], v9 offset:3072
 s_waitcnt lgkmcnt(4)
 v_mfma_f32_32x32x16_bf16 v[192:207], v[16:19], v[128:131], v[192:207]
 s_add_u32 s80, s83, 53248
 buffer_load_dwordx4 v[160:163], v7, s[64:67], s80 offen sc1
 v_mfma_f32_32x32x16_bf16 v[208:223], v[16:19], v[132:135], v[208:223]
 s_add_u32 s80, s83, 174080
 buffer_load_dwordx4 v[164:167], v7, s[64:67], s80 offen sc1
 v_mfma_f32_32x32x16_bf16 v[224:239], v[20:23], v[128:131], v[224:239]
 s_add_u32 m0, s82, 14336
 s_add_u32 s80, s88, 65536
 buffer_load_dwordx4 v10, s[56:59], s80 offen lds
 v_mfma_f32_32x32x16_bf16 v[240:255], v[20:23], v[132:135], v[240:255]
 s_add_u32 m0, s82, 15360
 s_add_u32 s80, s88, 73728
 buffer_load_dwordx4 v10, s[56:59], s80 offen lds
 s_waitcnt vmcnt(14)
 ds_read_b64_tr_b16 v[16:17], v12 offset:4096
 ds_read_b64_tr_b16 v[18:19], v12 offset:5120
 ds_read_b64_tr_b16 v[20:21], v9 offset:4096
 ds_read_b64_tr_b16 v[22:23], v9 offset:5120
 s_waitcnt lgkmcnt(4)
 v_mfma_f32_32x32x16_bf16 v[192:207], v[24:27], v[136:139], v[192:207]
 s_add_u32 s80, s83, 65536
 buffer_load_dwordx4 v[168:171], v7, s[64:67], s80 offen sc1
 v_mfma_f32_32x32x16_bf16 v[208:223], v[24:27], v[140:143], v[208:223]
 s_add_u32 s80, s83, 186368
 buffer_load_dwordx4 v[172:175], v7, s[64:67], s80 offen sc1
 v_mfma_f32_32x32x16_bf16 v[224:239], v[28:31], v[136:139], v[224:239]
 s_add_u32 m0, s82, 0
 s_add_u32 s80, s88, 131072
 buffer_load_dwordx4 v10, s[56:59], s80 offen lds
 v_mfma_f32_32x32x16_bf16 v[240:255], v[28:31], v[140:143], v[240:255]
 s_add_u32 m0, s82, 1024
 s_add_u32 s80, s88, 139264
 buffer_load_dwordx4 v10, s[56:59], s80 offen lds
 s_waitcnt lgkmcnt(0)
 s_xor_b64 s[8:9], s[8:9], s[24:25]
 s_xor_b64 s[10:11], s[10:11], s[24:25]
 s_xor_b64 s[12:13], s[12:13], s[24:25]
 s_xor_b64 s[14:15], s[14:15], s[24:25]
 s_xor_b64 s[16:17], s[16:17], s[24:25]
 s_xor_b64 s[18:19], s[18:19], s[24:25]
 s_xor_b64 s[20:21], s[20:21], s[24:25]
 s_xor_b64 s[22:23], s[22:23], s[24:25]
 s_or_b64 s[8:9], s[8:9], s[10:11]
 s_or_b64 s[8:9], s[8:9], s[12:13]
 s_or_b64 s[8:9], s[8:9], s[14:15]
 s_or_b64 s[8:9], s[8:9], s[16:17]
 s_or_b64 s[8:9], s[8:9], s[18:19]
 s_or_b64 s[8:9], s[8:9], s[20:21]
 s_or_b64 s[8:9], s[8:9], s[22:23]
 s_or_b32 s8, s8, s9
 s_cbranch_scc0 CLOK_153
 s_mov_b32 s39, 1048576
SPL_154:
 s_load_dwordx16 s[8:23], s[64:65], s97 glc
SPF_156:
 s_waitcnt lgkmcnt(0)
 s_xor_b64 s[8:9], s[8:9], s[24:25]
 s_xor_b64 s[10:11], s[10:11], s[24:25]
 s_xor_b64 s[12:13], s[12:13], s[24:25]
 s_xor_b64 s[14:15], s[14:15], s[24:25]
 s_xor_b64 s[16:17], s[16:17], s[24:25]
 s_xor_b64 s[18:19], s[18:19], s[24:25]
 s_xor_b64 s[20:21], s[20:21], s[24:25]
 s_xor_b64 s[22:23], s[22:23], s[24:25]
 s_or_b64 s[8:9], s[8:9], s[10:11]
 s_or_b64 s[8:9], s[8:9], s[12:13]
 s_or_b64 s[8:9], s[8:9], s[14:15]
 s_or_b64 s[8:9], s[8:9], s[16:17]
 s_or_b64 s[8:9], s[8:9], s[18:19]
 s_or_b64 s[8:9], s[8:9], s[20:21]
 s_or_b64 s[8:9], s[8:9], s[22:23]
 s_or_b32 s8, s8, s9
 s_cbranch_scc0 SPD_155
 s_sub_u32 s39, s39, 1
 s_cbranch_scc0 SPL_154
 v_mov_b32 v13, 531
 v_mov_b32 v14, 0
 global_store_dword v14, v13, s[68:69]
 s_waitcnt vmcnt(0)
SPD_155:
CLOK_153:
 s_waitcnt vmcnt(14)
 ds_read_b64_tr_b16 v[24:25], v12 offset:6144
 ds_read_b64_tr_b16 v[26:27], v12 offset:7168
 ds_read_b64_tr_b16 v[28:29], v9 offset:6144
 ds_read_b64_tr_b16 v[30:31], v9 offset:7168
 v_mfma_f32_32x32x16_bf16 v[192:207], v[16:19], v[144:147], v[192:207]
 s_add_u32 s80, s85, 0
 buffer_load_dwordx4 v[176:179], v7, s[64:67], s80 offen sc1
 s_add_u32 s80, s85, 120832
 buffer_load_dwordx4 v[180:183], v7, s[64:67], s80 offen sc1
 s_add_u32 s80, s85, 4096
 buffer_load_dwordx4 v[184:187], v7, s[64:67], s80 offen sc1
 v_mfma_f32_32x32x16_bf16 v[208:223], v[16:19], v[148:151], v[208:223]
 s_add_u32 s80, s85, 124928
 buffer_load_dwordx4 v[188:191], v7, s[64:67], s80 offen sc1
 s_add_u32 s80, s85, 8192
 buffer_load_dwordx4 v[128:131], v7, s[64:67], s80 offen sc1
 s_add_u32 s80, s85, 129024
 buffer_load_dwordx4 v[132:135], v7, s[64:67], s80 offen sc1
 v_mfma_f32_32x32x16_bf16 v[224:239], v[20:23], v[144:147], v[224:239]
 s_add_u32 s80, s85, 12288
 buffer_load_dwordx4 v[136:139], v7, s[64:67], s80 offen sc1
 s_add_u32 s80, s85, 133120
 buffer_load_dwordx4 v[140:143], v7, s[64:67], s80 offen sc1
 s_add_u32 m0, s82, 2048
 s_add_u32 s80, s88, 196608
 buffer_load_dwordx4 v10, s[56:59], s80 offen lds
 v_mfma_f32_32x32x16_bf16 v[240:255], v[20:23], v[148:151], v[240:255]
 s_add_u32 m0, s82, 3072
 s_add_u32 s80, s88, 204800
 buffer_load_dwordx4 v10, s[56:59], s80 offen lds
 s_waitcnt vmcnt(16)
 ds_read_b64_tr_b16 v[16:17], v12 offset:8192
 ds_read_b64_tr_b16 v[18:19], v12 offset:9216
 ds_read_b64_tr_b16 v[20:21], v9 offset:8192
 ds_read_b64_tr_b16 v[22:23], v9 offset:9216
 s_waitcnt lgkmcnt(4)
 v_mfma_f32_32x32x16_bf16 v[192:207], v[24:27], v[152:155], v[192:207]
 s_add_u32 s80, s85, 16384
 buffer_load_dwordx4 v[144:147], v7, s[64:67], s80 offen sc1
 v_mfma_f32_32x32x16_bf16 v[208:223], v[24:27], v[156:159], v[208:223]
 s_add_u32 s80, s85, 137216
 buffer_load_dwordx4 v[148:151], v7, s[64:67], s80 offen sc1
 v_mfma_f32_32x32x16_bf16 v[224:239], v[28:31], v[152:155], v[224:239]
 s_add_u32 m0, s82, 4096
 s_add_u32 s80, s88, 262144
 buffer_load_dwordx4 v10, s[56:59], s80 offen lds
 v_mfma_f32_32x32x16_bf16 v[240:255], v[28:31], v[156:159], v[240:255]
 s_add_u32 m0, s82, 5120
 s_add_u32 s80, s88, 270336
 buffer_load_dwordx4 v10, s[56:59], s80 offen lds
 s_waitcnt vmcnt(16)
 ds_read_b64_tr_b16 v[24:25], v12 offset:10240
 ds_read_b64_tr_b16 v[26:27], v12 offset:11264
 ds_read_b64_tr_b16 v[28:29], v9 offset:10240
 ds_read_b64_tr_b16 v[30:31], v9 offset:11264
 s_waitcnt lgkmcnt(4)
 v_mfma_f32_32x32x16_bf16 v[192:207], v[16:19], v[160:163], v[192:207]
 s_add_u32 s80, s85, 20480
 buffer_load_dwordx4 v[152:155], v7, s[64:67], s80 offen sc1
 v_mfma_f32_32x32x16_bf16 v[208:223], v[16:19], v[164:167], v[208:223]
 s_add_u32 s80, s85, 141312
 buffer_load_dwordx4 v[156:159], v7, s[64:67], s80 offen sc1
 v_mfma_f32_32x32x16_bf16 v[224:239], v[20:23], v[160:163], v[224:239]
 s_add_u32 m0, s82, 6144
 s_add_u32 s80, s88, 327680
 buffer_load_dwordx4 v10, s[56:59], s80 offen lds
 v_mfma_f32_32x32x16_bf16 v[240:255], v[20:23], v[164:167], v[240:255]
 s_add_u32 m0, s82, 7168
 s_add_u32 s80, s88, 335872
 buffer_load_dwordx4 v10, s[56:59], s80 offen lds
 s_waitcnt vmcnt(16)
 ds_read_b64_tr_b16 v[16:17], v12 offset:12288
 ds_read_b64_tr_b16 v[18:19], v12 offset:13312
 ds_read_b64_tr_b16 v[20:21], v9 offset:12288
 ds_read_b64_tr_b16 v[22:23], v9 offset:13312
 s_waitcnt lgkmcnt(4)
 s_cmp_ge_u32 s26, 2
 s_cbranch_scc1 SKIPM_157
 v_mfma_f32_32x32x16_bf16 v[192:207], v[24:27], v[168:171], v[192:207]
 v_mfma_f32_32x32x16_bf16 v[208:223], v[24:27], v[172:175], v[208:223]
 v_mfma_f32_32x32x16_bf16 v[224:239], v[28:31], v[168:171], v[224:239]
 v_mfma_f32_32x32x16_bf16 v[240:255], v[28:31], v[172:175], v[240:255]
SKIPM_157:
 s_add_u32 s80, s85, 24576
 buffer_load_dwordx4 v[160:163], v7, s[64:67], s80 offen sc1
 s_add_u32 s80, s85, 145408
 buffer_load_dwordx4 v[164:167], v7, s[64:67], s80 offen sc1
 s_add_u32 m0, s82, 8192
 s_add_u32 s80, s88, 393216
 buffer_load_dwordx4 v10, s[56:59], s80 offen lds
 s_add_u32 m0, s82, 9216
 s_add_u32 s80, s88, 401408
 buffer_load_dwordx4 v10, s[56:59], s80 offen lds
 s_waitcnt vmcnt(63)
 v_mov_b32 v74, v72
 v_mov_b32 v75, v72
 v_mov_b32 v76, v73
 v_mov_b32 v77, v73
 s_nop 5
 v_pk_mul_f32 v[192:193], v[192:193], v[74:75]
 v_pk_mul_f32 v[194:195], v[194:195], v[74:75]
 v_pk_mul_f32 v[196:197], v[196:197], v[74:75]
 v_pk_mul_f32 v[198:199], v[198:199], v[74:75]
 v_pk_mul_f32 v[200:201], v[200:201], v[74:75]
 v_pk_mul_f32 v[202:203], v[202:203], v[74:75]
 v_pk_mul_f32 v[204:205], v[204:205], v[74:75]
 v_pk_mul_f32 v[206:207], v[206:207], v[74:75]
 v_pk_mul_f32 v[208:209], v[208:209], v[76:77]
 v_pk_mul_f32 v[210:211], v[210:211], v[76:77]
 v_pk_mul_f32 v[212:213], v[212:213], v[76:77]
 v_pk_mul_f32 v[214:215], v[214:215], v[76:77]
 v_pk_mul_f32 v[216:217], v[216:217], v[76:77]
 v_pk_mul_f32 v[218:219], v[218:219], v[76:77]
 v_pk_mul_f32 v[220:221], v[220:221], v[76:77]
 v_pk_mul_f32 v[222:223], v[222:223], v[76:77]
 v_pk_mul_f32 v[224:225], v[224:225], v[74:75]
 v_pk_mul_f32 v[226:227], v[226:227], v[74:75]
 v_pk_mul_f32 v[228:229], v[228:229], v[74:75]
 v_pk_mul_f32 v[230:231], v[230:231], v[74:75]
 v_pk_mul_f32 v[232:233], v[232:233], v[74:75]
 v_pk_mul_f32 v[234:235], v[234:235], v[74:75]
 v_pk_mul_f32 v[236:237], v[236:237], v[74:75]
 v_pk_mul_f32 v[238:239], v[238:239], v[74:75]
 v_pk_mul_f32 v[240:241], v[240:241], v[76:77]
 v_pk_mul_f32 v[242:243], v[242:243], v[76:77]
 v_pk_mul_f32 v[244:245], v[244:245], v[76:77]
 v_pk_mul_f32 v[246:247], v[246:247], v[76:77]
 v_pk_mul_f32 v[248:249], v[248:249], v[76:77]
 v_pk_mul_f32 v[250:251], v[250:251], v[76:77]
 v_pk_mul_f32 v[252:253], v[252:253], v[76:77]
 v_pk_mul_f32 v[254:255], v[254:255], v[76:77]
 s_nop 1
 s_waitcnt vmcnt(18)
 ds_read_b64_tr_b16 v[24:25], v12 offset:14336
 ds_read_b64_tr_b16 v[26:27], v12 offset:15360
 ds_read_b64_tr_b16 v[28:29], v9 offset:14336
 ds_read_b64_tr_b16 v[30:31], v9 offset:15360
 s_waitcnt lgkmcnt(4)
 v_mfma_f32_32x32x16_bf16 v[192:207], v[16:19], v[176:179], v[192:207]
 s_add_u32 s80, s85, 28672
 buffer_load_dwordx4 v[168:171], v7, s[64:67], s80 offen sc1
 v_mfma_f32_32x32x16_bf16 v[208:223], v[16:19], v[180:183], v[208:223]
 s_add_u32 s80, s85, 149504
 buffer_load_dwordx4 v[172:175], v7, s[64:67], s80 offen sc1
 v_mfma_f32_32x32x16_bf16 v[224:239], v[20:23], v[176:179], v[224:239]
 s_add_u32 m0, s82, 10240
 s_add_u32 s80, s88, 458752
 buffer_load_dwordx4 v10, s[56:59], s80 offen lds
 v_mfma_f32_32x32x16_bf16 v[240:255], v[20:23], v[180:183], v[240:255]
 s_add_u32 m0, s82, 11264
 s_add_u32 s80, s88, 466944
 buffer_load_dwordx4 v10, s[56:59], s80 offen lds
 s_waitcnt vmcnt(20)
 ds_read_b64_tr_b16 v[16:17], v12 offset:0
 ds_read_b64_tr_b16 v[18:19], v12 offset:1024
 ds_read_b64_tr_b16 v[20:21], v9 offset:0
 ds_read_b64_tr_b16 v[22:23], v9 offset:1024
 s_waitcnt lgkmcnt(4)
 v_mfma_f32_32x32x16_bf16 v[192:207], v[24:27], v[184:187], v[192:207]
 v_mfma_f32_32x32x16_bf16 v[208:223], v[24:27], v[188:191], v[208:223]
 v_mfma_f32_32x32x16_bf16 v[224:239], v[28:31], v[184:187], v[224:239]
 v_mfma_f32_32x32x16_bf16 v[240:255], v[28:31], v[188:191], v[240:255]
 s_waitcnt vmcnt(16)
 ds_read_b64_tr_b16 v[24:25], v12 offset:2048
 ds_read_b64_tr_b16 v[26:27], v12 offset:3072
 ds_read_b64_tr_b16 v[28:29], v9 offset:2048
 ds_read_b64_tr_b16 v[30:31], v9 offset:3072
 s_waitcnt lgkmcnt(4)
 v_mfma_f32_32x32x16_bf16 v[192:207], v[16:19], v[128:131], v[192:207]
 v_mfma_f32_32x32x16_bf16 v[208:223], v[16:19], v[132:135], v[208:223]
 v_mfma_f32_32x32x16_bf16 v[224:239], v[20:23], v[128:131], v[224:239]
 v_mfma_f32_32x32x16_bf16 v[240:255], v[20:23], v[132:135], v[240:255]
 s_waitcnt vmcnt(12)
 ds_read_b64_tr_b16 v[16:17], v12 offset:4096
 ds_read_b64_tr_b16 v[18:19], v12 offset:5120
 ds_read_b64_tr_b16 v[20:21], v9 offset:4096
 ds_read_b64_tr_b16 v[22:23], v9 offset:5120
 s_waitcnt lgkmcnt(4)
 v_mfma_f32_32x32x16_bf16 v[192:207], v[24:27], v[136:139], v[192:207]
 v_mfma_f32_32x32x16_bf16 v[208:223], v[24:27], v[140:143], v[208:223]
 v_mfma_f32_32x32x16_bf16 v[224:239], v[28:31], v[136:139], v[224:239]
 v_mfma_f32_32x32x16_bf16 v[240:255], v[28:31], v[140:143], v[240:255]
 s_waitcnt vmcnt(8)
 ds_read_b64_tr_b16 v[24:25], v12 offset:6144
 ds_read_b64_tr_b16 v[26:27], v12 offset:7168
 ds_read_b64_tr_b16 v[28:29], v9 offset:6144
 ds_read_b64_tr_b16 v[30:31], v9 offset:7168
 s_waitcnt lgkmcnt(4)
 v_mfma_f32_32x32x16_bf16 v[192:207], v[16:19], v[144:147], v[192:207]
 v_mfma_f32_32x32x16_bf16 v[208:223], v[16:19], v[148:151], v[208:223]
 v_mfma_f32_32x32x16_bf16 v[224:239], v[20:23], v[144:147], v[224:239]
 v_mfma_f32_32x32x16_bf16 v[240:255], v[20:23], v[148:151], v[240:255]
 s_waitcnt vmcnt(4)
 ds_read_b64_tr_b16 v[16:17], v12 offset:8192
 ds_read_b64_tr_b16 v[18:19], v12 offset:9216
 ds_read_b64_tr_b16 v[20:21], v9 offset:8192
 ds_read_b64_tr_b16 v[22:23], v9 offset:9216
 s_waitcnt lgkmcnt(4)
 v_mfma_f32_32x32x16_bf16 v[192:207], v[24:27], v[152:155], v[192:207]
 v_mfma_f32_32x32x16_bf16 v[208:223], v[24:27], v[156:159], v[208:223]
 v_mfma_f32_32x32x16_bf16 v[224:239], v[28:31], v[152:155], v[224:239]
 v_mfma_f32_32x32x16_bf16 v[240:255], v[28:31], v[156:159], v[240:255]
 s_waitcnt vmcnt(0)
 ds_read_b64_tr_b16 v[24:25], v12 offset:10240
 ds_read_b64_tr_b16 v[26:27], v12 offset:11264
 ds_read_b64_tr_b16 v[28:29], v9 offset:10240
 ds_read_b64_tr_b16 v[30:31], v9 offset:11264
 s_waitcnt lgkmcnt(4)
 v_mfma_f32_32x32x16_bf16 v[192:207], v[16:19], v[160:163], v[192:207]
 v_mfma_f32_32x32x16_bf16 v[208:223], v[16:19], v[164:167], v[208:223]
 v_mfma_f32_32x32x16_bf16 v[224:239], v[20:23], v[160:163], v[224:239]
 v_mfma_f32_32x32x16_bf16 v[240:255], v[20:23], v[164:167], v[240:255]
 s_waitcnt lgkmcnt(0)
 v_mfma_f32_32x32x16_bf16 v[192:207], v[24:27], v[168:171], v[192:207]
 v_mfma_f32_32x32x16_bf16 v[208:223], v[24:27], v[172:175], v[208:223]
 v_mfma_f32_32x32x16_bf16 v[224:239], v[28:31], v[168:171], v[224:239]
 v_mfma_f32_32x32x16_bf16 v[240:255], v[28:31], v[172:175], v[240:255]
 s_nop 9
 ds_write_b128 v32, v[192:195] offset:0
 ds_write_b128 v33, v[196:199] offset:0
 ds_write_b128 v34, v[200:203] offset:0
 ds_write_b128 v35, v[204:207] offset:0
 ds_write_b128 v32, v[208:211] offset:8192
 ds_write_b128 v33, v[212:215] offset:8192
 ds_write_b128 v34, v[216:219] offset:8192
 ds_write_b128 v35, v[220:223] offset:8192
 ds_write_b128 v32, v[224:227] offset:128
 ds_write_b128 v33, v[228:231] offset:128
 ds_write_b128 v34, v[232:235] offset:128
 ds_write_b128 v35, v[236:239] offset:128
 ds_write_b128 v32, v[240:243] offset:8320
 ds_write_b128 v33, v[244:247] offset:8320
 ds_write_b128 v34, v[248:251] offset:8320
 ds_write_b128 v35, v[252:255] offset:8320
 s_waitcnt lgkmcnt(0)
 s_barrier
 ds_read_b128 v[128:131], v36 offset:0
 ds_read_b128 v[132:135], v37 offset:0
 ds_read_b128 v[136:139], v36 offset:16384
 ds_read_b128 v[140:143], v37 offset:16384
 ds_read_b128 v[144:147], v36 offset:32768
 ds_read_b128 v[148:151], v37 offset:32768
 ds_read_b128 v[152:155], v36 offset:49152
 ds_read_b128 v[156:159], v37 offset:49152
 ds_read_b128 v[160:163], v36 offset:8192
 ds_read_b128 v[164:167], v37 offset:8192
 ds_read_b128 v[168:171], v36 offset:24576
 ds_read_b128 v[172:175], v37 offset:24576
 ds_read_b128 v[176:179], v36 offset:40960
 ds_read_b128 v[180:183], v37 offset:40960
 ds_read_b128 v[184:187], v36 offset:57344
 ds_read_b128 v[188:191], v37 offset:57344
 s_waitcnt vmcnt(63)
 v_lshlrev_b32 v20, 16, v64
 v_and_b32 v21, 0xffff0000, v64
 v_lshlrev_b32 v22, 16, v65
 v_and_b32 v23, 0xffff0000, v65
 v_lshlrev_b32 v24, 16, v66
 v_and_b32 v25, 0xffff0000, v66
 v_lshlrev_b32 v26, 16, v67
 v_and_b32 v27, 0xffff0000, v67
 v_lshlrev_b32 v28, 16, v68
 v_and_b32 v29, 0xffff0000, v68
 v_lshlrev_b32 v30, 16, v69
 v_and_b32 v31, 0xffff0000, v69
 v_lshlrev_b32 v32, 16, v70
 v_and_b32 v33, 0xffff0000, v70
 v_lshlrev_b32 v34, 16, v71
 v_and_b32 v35, 0xffff0000, v71
 s_waitcnt lgkmcnt(8)
 v_pk_add_f32 v[128:129], v[128:129], v[136:137]
 v_pk_add_f32 v[144:145], v[144:145], v[152:153]
 v_pk_add_f32 v[130:131], v[130:131], v[138:139]
 v_pk_add_f32 v[146:147], v[146:147], v[154:155]
 v_pk_add_f32 v[132:133], v[132:133], v[140:141]
 v_pk_add_f32 v[148:149], v[148:149], v[156:157]
 v_pk_add_f32 v[134:135], v[134:135], v[142:143]
 v_pk_add_f32 v[150:151], v[150:151], v[158:159]
 v_pk_add_f32 v[144:145], v[144:145], v[20:21]
 v_pk_add_f32 v[146:147], v[146:147], v[22:23]
 v_pk_add_f32 v[148:149], v[148:149], v[24:25]
 v_pk_add_f32 v[150:151], v[150:151], v[26:27]
 v_pk_add_f32 v[128:129], v[128:129], v[144:145]
 v_pk_add_f32 v[130:131], v[130:131], v[146:147]
 v_pk_add_f32 v[132:133], v[132:133], v[148:149]
 v_pk_add_f32 v[134:135], v[134:135], v[150:151]
 v_cvt_pk_bf16_f32 v40, v128, v129
 v_cvt_pk_bf16_f32 v41, v130, v131
 v_cvt_pk_bf16_f32 v42, v132, v133
 v_cvt_pk_bf16_f32 v43, v134, v135
 buffer_store_dwordx4 v[40:43], v11, s[60:63], s78 offen
 s_waitcnt lgkmcnt(0)
 v_pk_add_f32 v[160:161], v[160:161], v[168:169]
 v_pk_add_f32 v[176:177], v[176:177], v[184:185]
 v_pk_add_f32 v[162:163], v[162:163], v[170:171]
 v_pk_add_f32 v[178:179], v[178:179], v[186:187]
 v_pk_add_f32 v[164:165], v[164:165], v[172:173]
 v_pk_add_f32 v[180:181], v[180:181], v[188:189]
 v_pk_add_f32 v[166:167], v[166:167], v[174:175]
 v_pk_add_f32 v[182:183], v[182:183], v[190:191]
 v_pk_add_f32 v[176:177], v[176:177], v[28:29]
 v_pk_add_f32 v[178:179], v[178:179], v[30:31]
 v_pk_add_f32 v[180:181], v[180:181], v[32:33]
 v_pk_add_f32 v[182:183], v[182:183], v[34:35]
 v_pk_add_f32 v[160:161], v[160:161], v[176:177]
 v_pk_add_f32 v[162:163], v[162:163], v[178:179]
 v_pk_add_f32 v[164:165], v[164:165], v[180:181]
 v_pk_add_f32 v[166:167], v[166:167], v[182:183]
 v_cvt_pk_bf16_f32 v44, v160, v161
 v_cvt_pk_bf16_f32 v45, v162, v163
 v_cvt_pk_bf16_f32 v46, v164, v165
 v_cvt_pk_bf16_f32 v47, v166, v167
 buffer_store_dwordx4 v[44:47], v11, s[60:63], s79 offen
L_END:
 s_endpgm
.section .rodata,"a"
.p2align 6
.amdhsa_kernel parallel_sum__sliding_block__dense_activation_relu__prompt_kernel
  .amdhsa_next_free_vgpr 256
  .amdhsa_next_free_sgpr 102
  .amdhsa_accum_offset 256
  .amdhsa_group_segment_fixed_size 0
  .amdhsa_kernarg_size 72
  .amdhsa_user_sgpr_count 2
  .amdhsa_user_sgpr_kernarg_segment_ptr 1
  .amdhsa_system_sgpr_workgroup_id_x 1
  .amdhsa_float_denorm_mode_32 3
.end_amdhsa_kernel
```
